```python
import torch

def _softmax(x, axis=-1):
    return torch.softmax(x, dim=axis)

def _gelu(x):
    return torch.nn.functional.gelu(x, approximate='tanh')

def _silu(x):
    return torch.nn.functional.silu(x)

def _sigmoid(x):
    return torch.sigmoid(x)

def _layernorm(x, axis=-1, eps=1e-05):
    m = x.mean(dim=axis, keepdim=True)
    v = x.var(dim=axis, keepdim=True, unbiased=False)
    return (x - m) / torch.sqrt(v + eps)

def _scatter_add(tgt, idx, src, axis=0):
    return tgt.clone().index_add_(axis, idx, src)

def _segment_sum(src, seg, n):
    out = torch.zeros((n,) + src.shape[1:], dtype=src.dtype)
    return out.index_add_(0, seg, src)

def _pad(x, pw):
    flat = tuple((v for pair in reversed(pw) for v in pair))
    return torch.nn.functional.pad(x, flat)
kernel_name = 'sequential_preLN__linear_attn_block__mixer_gmlp__prompt'

def setup_inputs():

    _w = lambda a: (lambda t: t.to(torch.bfloat16) if t.is_floating_point() else t)(torch.as_tensor(a))

    def _A_setup():
        B, S, D = (1, 2048, 512)
        return {'x': _w((lambda *s: torch.randn(*s, dtype=torch.bfloat16) * 0.05)(B, S, D)), 'wqkv': _w((lambda *s: torch.randn(*s, dtype=torch.bfloat16) * 0.05)(D, 3 * D)), 'wo': _w((lambda *s: torch.randn(*s, dtype=torch.bfloat16) * 0.05)(D, D))}
    _A_in = _A_setup()

    def _B_setup():
        B, S, D, F = (1, 2048, 512, 1792)
        Fh = F // 2
        return {'x': _w((lambda *s: torch.randn(*s, dtype=torch.bfloat16) * 0.05)(B, S, D)), 'w_in': _w((lambda *s: torch.randn(*s, dtype=torch.bfloat16) * 0.4)(D, 2 * Fh)), 'w_sp': _w(0.01 * (lambda *s: torch.randn(*s, dtype=torch.bfloat16) * 0.4)(S, S)), 'b_sp': _w(1.0 + 0.01 * (lambda *s: torch.randn(*s, dtype=torch.bfloat16) * 0.05)(S)), 'w_out': _w((lambda *s: torch.randn(*s, dtype=torch.bfloat16) * 0.05)(Fh, D))}
    _B_in = _B_setup()
    return {'A_x': _A_in['x'], 'A_wqkv': _A_in['wqkv'], 'A_wo': _A_in['wo'], 'B_x': _B_in['x'], 'B_w_in': _B_in['w_in'], 'B_w_sp': _B_in['w_sp'], 'B_b_sp': _B_in['b_sp'], 'B_w_out': _B_in['w_out']}

def reference(A_x, A_wqkv, A_wo, B_x, B_w_in, B_w_sp, B_b_sp, B_w_out):

    def _A_ref(x, wqkv, wo):
        B, S, D = x.shape
        H = 32
        Dh = D // H
        qkv = (lambda x, *d: x.permute(*d))((x @ wqkv).reshape(B, S, 3, H, Dh), 2, 0, 3, 1, 4)
        q, k, v = (qkv[0], qkv[1], qkv[2])
        phi = lambda t: torch.where(t > 0, t + 1, torch.exp(t)) + 1e-06
        pq, pk = (phi(q), phi(k))
        kv = torch.einsum('bhsd,bhse->bhde', pk, v)
        z = torch.einsum('bhsd->bhd', pk)
        num = torch.einsum('bhqd,bhde->bhqe', pq, kv)
        den = torch.einsum('bhqd,bhd->bhq', pq, z)[..., None] + 1e-06
        o = num / den
        return (lambda x, *d: x.permute(*d))(o, 0, 2, 1, 3).reshape(B, S, D) @ wo

    def _B_ref(x, w_in, w_sp, b_sp, w_out):
        B, S, D = x.shape
        F = w_in.shape[-1]
        Fh = F // 2
        z = _gelu(torch.einsum('bsd,df->bsf', x, w_in))
        z1 = z[..., :Fh].clone()
        z2 = _layernorm(z[..., Fh:], axis=-1)
        g = torch.einsum('ts,bsf->btf', w_sp, z2) + b_sp[None, :, None]
        return torch.einsum('bsf,fd->bsd', z1 * g, w_out)
    x = A_x
    h = x + _A_ref(_layernorm(x, axis=-1), A_wqkv, A_wo)
    h2 = h + _B_ref(_layernorm(h, axis=-1), B_w_in, B_w_sp, B_b_sp, B_w_out)
    return h2
```

```asm
; @launch grid=(256,1,1) block=(256,1,1) lds=163840
.amdgcn_target "amdgcn-amd-amdhsa--gfx950"
.text
.globl sequential_preLN__linear_attn_block__mixer_gmlp__prompt_kernel
.p2align 8
.type sequential_preLN__linear_attn_block__mixer_gmlp__prompt_kernel,@function
sequential_preLN__linear_attn_block__mixer_gmlp__prompt_kernel:
    s_cmp_ge_u32 s2, 256
    s_cbranch_scc1 L_end
    s_load_dwordx4 s[64:67], s[0:1], 0
    v_lshrrev_b32 v1, 6, v0
    v_and_b32 v0, 63, v0
    v_readfirstlane_b32 s50, v1
    s_and_b32 s48, s2, 7
    s_lshr_b32 s49, s2, 3
    v_lshrrev_b32 v3, 4, v0
    s_lshr_b32 s62, s48, 1
    s_lshl_b32 s62, s62, 3
    s_lshr_b32 s86, s49, 2
    s_add_u32 s62, s62, s86
    s_and_b32 s63, s48, 1
    s_lshl_b32 s63, s63, 2
    s_mov_b32 s86, s49
    s_and_b32 s86, s86, 3
    s_add_u32 s63, s63, s86
    s_lshl_b32 s88, s62, 16
    s_lshl_b32 s87, s50, 14
    s_add_u32 s88, s88, s87
    s_lshl_b32 s90, s63, 7
    s_mul_i32 s87, s50, 49152
    s_add_u32 s90, s90, s87
    s_lshl_b32 s91, s50, 11
    v_lshrrev_b32 v5, 3, v0
    v_and_b32 v6, 7, v0
    v_xor_b32 v12, v6, v3
    v_lshlrev_b32 v12, 4, v12
    v_lshl_add_u32 v216, v5, 10, v12
    v_xor_b32 v217, 64, v216
    v_add_u32 v217, 8192, v217
    v_and_b32 v12, 2, v5
    v_xor_b32 v12, v6, v12
    v_lshlrev_b32 v12, 4, v12
    v_mul_u32_u24 v13, 3072, v5
    v_add_u32 v218, v13, v12
    v_xor_b32 v219, 64, v218
    v_add_u32 v219, 24576, v219
    s_waitcnt lgkmcnt(0)
    s_load_dwordx2 s[84:85], s[0:1], 80
    s_load_dwordx2 s[68:69], s[0:1], 16
    s_load_dwordx8 s[72:79], s[0:1], 32
    s_load_dwordx2 s[80:81], s[0:1], 64
    s_mov_b32 s8, s64
    s_and_b32 s9, s65, 0xffff
    s_mov_b32 s10, 2097152
    s_mov_b32 s11, 0x20000
    s_mov_b32 s12, s66
    s_and_b32 s13, s67, 0xffff
    s_mov_b32 s14, 1572864
    s_mov_b32 s15, 0x20000
    s_lshr_b32 s92, s49, 2
    s_and_b32 s92, s92, 6
    s_add_u32 m0, s91, 0
    s_add_u32 s61, s92, 0
    s_and_b32 s61, s61, 7
    s_lshl_b32 s60, s61, 7
    s_add_u32 s60, s60, s88
    buffer_load_dwordx4 v216, s[8:11], s60 offen lds
    s_add_u32 m0, s91, 1024
    s_nop 0
    buffer_load_dwordx4 v217, s[8:11], s60 offen lds
    s_add_u32 m0, s91, 8192
    s_mul_i32 s61, s61, 196608
    s_add_u32 s61, s61, s90
    s_add_u32 s60, s61, 1024
    buffer_load_dwordx4 v218, s[12:15], s60 offen lds
    s_add_u32 m0, s91, 9216
    s_nop 0
    buffer_load_dwordx4 v219, s[12:15], s60 offen lds
    s_add_u32 m0, s91, 16384
    s_add_u32 s60, s61, 2048
    buffer_load_dwordx4 v218, s[12:15], s60 offen lds
    s_add_u32 m0, s91, 17408
    s_nop 0
    buffer_load_dwordx4 v219, s[12:15], s60 offen lds
    s_add_u32 m0, s91, 24576
    s_add_u32 s61, s92, 1
    s_and_b32 s61, s61, 7
    s_lshl_b32 s60, s61, 7
    s_add_u32 s60, s60, s88
    buffer_load_dwordx4 v216, s[8:11], s60 offen lds
    s_add_u32 m0, s91, 25600
    s_nop 0
    buffer_load_dwordx4 v217, s[8:11], s60 offen lds
    s_add_u32 m0, s91, 32768
    s_mul_i32 s61, s61, 196608
    s_add_u32 s61, s61, s90
    s_add_u32 s60, s61, 1024
    buffer_load_dwordx4 v218, s[12:15], s60 offen lds
    s_add_u32 m0, s91, 33792
    s_nop 0
    buffer_load_dwordx4 v219, s[12:15], s60 offen lds
    s_add_u32 m0, s91, 40960
    s_add_u32 s60, s61, 2048
    buffer_load_dwordx4 v218, s[12:15], s60 offen lds
    s_add_u32 m0, s91, 41984
    s_nop 0
    buffer_load_dwordx4 v219, s[12:15], s60 offen lds
    s_waitcnt lgkmcnt(0)
    s_mov_b32 s40, s84
    s_and_b32 s41, s85, 0xffff
    s_mov_b32 s42, 18874368
    s_mov_b32 s43, 0x20000
    s_mov_b32 s86, 36864
    buffer_load_dword v225, off, s[40:43], s86 sc1
    s_mov_b32 s16, s68
    s_and_b32 s17, s69, 0xffff
    s_mov_b32 s18, 524288
    s_mov_b32 s19, 0x20000
    s_mov_b32 s20, s72
    s_and_b32 s21, s73, 0xffff
    s_mov_b32 s22, 1835008
    s_mov_b32 s23, 0x20000
    s_mov_b32 s24, s74
    s_and_b32 s25, s75, 0xffff
    s_mov_b32 s26, 8388608
    s_mov_b32 s27, 0x20000
    s_mov_b32 s28, s76
    s_and_b32 s29, s77, 0xffff
    s_mov_b32 s30, 4096
    s_mov_b32 s31, 0x20000
    s_mov_b32 s32, s78
    s_and_b32 s33, s79, 0xffff
    s_mov_b32 s34, 917504
    s_mov_b32 s35, 0x20000
    s_mov_b32 s36, s80
    s_and_b32 s37, s81, 0xffff
    s_mov_b32 s38, 2097152
    s_mov_b32 s39, 0x20000
    v_lshlrev_b32 v1, 4, v0
    v_and_b32 v2, 15, v0
    s_getreg_b32 s7, hwreg(HW_REG_XCC_ID, 0, 4)
    s_lshr_b32 s100, s49, 4
    s_lshl_b32 s86, s48, 1
    s_add_u32 s100, s100, s86
    s_and_b32 s101, s49, 15
    s_lshr_b32 s3, s49, 3
    s_lshl_b32 s86, s48, 2
    s_add_u32 s3, s3, s86
    s_and_b32 s5, s49, 7
    s_lshl_b32 s86, s2, 2
    s_add_u32 s86, s86, 0
    v_lshl_add_u32 v4, v0, 10, s86
    s_lshl_b32 s86, s101, 4
    s_add_u32 s86, s86, s100
    s_lshl_b32 s86, s86, 2
    s_add_u32 s86, s86, 4294960128
    v_lshl_add_u32 v5, v0, 10, s86
    v_cmp_lt_u32 vcc, 16, v0
    s_nop 1
    v_cndmask_b32 v4, v4, v5, vcc
    s_lshl_b32 s86, s100, 7
    s_lshl_b32 s87, s101, 2
    s_add_u32 s86, s86, s87
    s_add_u32 s87, s86, 8192
    v_writelane_b32 v4, s87, 16
    s_add_u32 s87, s86, 18432
    v_writelane_b32 v4, s87, 25
    s_lshl_b32 s86, s62, 7
    s_lshl_b32 s87, s63, 2
    s_add_u32 s86, s86, s87
    s_add_u32 s87, s86, 20480
    v_writelane_b32 v4, s87, 26
    s_lshl_b32 s86, s62, 7
    s_lshl_b32 s87, s63, 2
    s_add_u32 s86, s86, s87
    s_add_u32 s87, s86, 24576
    v_writelane_b32 v4, s87, 27
    s_mov_b32 s52, 0x3fb8aa3b
    s_mov_b32 s53, 0x3fb8aa3b
    s_mov_b32 s54, 0x358637bd
    s_mov_b32 s55, 0x358637bd
    s_mov_b32 s56, 0xbdd2d3e8
    s_mov_b32 s57, 0xbdd2d3e8
    s_mov_b32 s58, 1.0
    s_mov_b32 s59, 1.0
    s_lshl_b32 s93, s63, 2
    s_add_u32 s93, s93, s50
    s_mul_i32 s94, s93, 1152
    s_add_u32 s94, s94, 40960
    s_lshl_b32 s95, s63, 2
    s_add_u32 s95, s95, 36992
    v_lshlrev_b32 v226, 7, v0
    s_cmp_lg_u32 s62, 0
    s_cbranch_scc1 Lz1
    v_mov_b32 v12, 0
    v_mov_b32 v13, 0
    v_mov_b32 v14, 0
    v_mov_b32 v15, 0
    buffer_store_dwordx4 v[12:15], v1, s[40:43], s94 offen sc1
    s_mov_b64 exec, 0xff
    buffer_store_dwordx4 v[12:15], v1, s[40:43], s94 offen offset:1024 sc1
    s_mov_b64 exec, -1
Lz1:
    s_cmp_lg_u32 s50, 0
    s_cbranch_scc1 Lw2
    s_getpc_b64 s[86:87]
L_pc:
    s_and_b32 s61, s49, 7
    s_lshl_b32 s61, s61, 13
    v_add_u32 v231, s61, v226
    v_min_u32 v231, L_end-L_pc, v231
    global_load_dword v239, v231, s[86:87]
Lw2:
    s_cmp_lg_u32 s50, 1
    s_cbranch_scc1 Lw3
    s_lshl_b32 s86, s2, 13
    s_mov_b32 exec_lo, 0xfcfcfcfc
    s_mov_b32 exec_hi, 0xfcfcfcfc
    buffer_load_dword v235, v226, s[8:11], s86 offen
    s_mov_b64 exec, -1
Lw3:
    s_cmp_lg_u32 s50, 2
    s_cbranch_scc1 Lw4
    s_mul_i32 s86, s2, 4608
    s_add_u32 s86, s86, 393216
    s_mov_b32 exec_hi, 15
    buffer_load_dword v236, v226, s[12:15], s86 offen
    s_mov_b64 exec, -1
Lw4:
    s_cmp_lg_u32 s50, 3
    s_cbranch_scc1 Lw5
    s_lshl_b32 s86, s48, 7
    s_lshl_b32 s87, s49, 2
    s_add_u32 s86, s86, s87
    s_add_u32 s86, s86, 37120
    v_mov_b32 v5, s7
    s_mov_b64 exec, 1
    buffer_store_dword v5, off, s[40:43], s86 sc1
    s_mov_b64 exec, -1
Lw5:
    s_add_u32 m0, s91, 49152
    s_add_u32 s61, s92, 2
    s_and_b32 s61, s61, 7
    s_lshl_b32 s60, s61, 7
    s_add_u32 s60, s60, s88
    buffer_load_dwordx4 v216, s[8:11], s60 offen lds
    s_add_u32 m0, s91, 50176
    s_nop 0
    buffer_load_dwordx4 v217, s[8:11], s60 offen lds
    s_add_u32 m0, s91, 57344
    s_mul_i32 s61, s61, 196608
    s_add_u32 s61, s61, s90
    s_add_u32 s60, s61, 1024
    buffer_load_dwordx4 v218, s[12:15], s60 offen lds
    s_add_u32 m0, s91, 58368
    s_nop 0
    buffer_load_dwordx4 v219, s[12:15], s60 offen lds
    s_add_u32 m0, s91, 65536
    s_add_u32 s60, s61, 2048
    buffer_load_dwordx4 v218, s[12:15], s60 offen lds
    s_add_u32 m0, s91, 66560
    s_nop 0
    buffer_load_dwordx4 v219, s[12:15], s60 offen lds
    v_lshrrev_b32 v12, 1, v2
    v_xor_b32 v12, v12, v3
    v_lshlrev_b32 v12, 4, v12
    v_lshl_add_u32 v220, v2, 7, v12
    v_xor_b32 v221, 64, v220
    v_add_u32 v222, s91, v220
    v_add_u32 v223, s91, v221
    v_lshrrev_b32 v12, 2, v2
    v_lshl_add_u32 v13, v3, 3, v12
    v_and_b32 v14, 2, v12
    v_and_b32 v15, 1, v3
    v_lshl_or_b32 v14, v15, 2, v14
    v_bfe_u32 v15, v0, 1, 1
    s_lshl_b32 s86, s50, 1
    v_add_u32 v15, s86, v15
    v_xor_b32 v14, v14, v15
    v_lshlrev_b32 v14, 4, v14
    v_lshl_add_u32 v14, v13, 7, v14
    v_and_b32 v15, 1, v0
    v_lshl_add_u32 v224, v15, 3, v14
    v_mov_b32 v40, 0x3f803f80
    v_mov_b32 v41, 0x3f803f80
    v_mov_b32 v42, 0x3f803f80
    v_mov_b32 v43, 0x3f803f80
    s_lshl_b32 s86, s50, 6
    s_add_u32 s86, s86, 147456
    v_lshl_add_u32 v212, v2, 2, s86
    v_lshlrev_b32 v213, 4, v3
    v_add_u32 v213, 147456, v213
    v_lshlrev_b32 v214, 2, v2
    v_add_u32 v214, 147456, v214
    s_add_u32 s86, s91, 148480
    v_add_u32 v227, s86, v1
    v_lshl_add_u32 v228, v3, 4, s86
    v_lshl_add_u32 v229, v0, 2, s86
    v_lshlrev_b32 v215, 2, v0
    v_and_b32 v12, 3, v0
    v_cmp_eq_u32 s[44:45], 1, v12
    v_cmp_eq_u32 s[46:47], 2, v12
    v_cmp_eq_u32 s[82:83], 3, v12
    s_lshr_b32 s86, s49, 2
    s_lshl_b32 s87, s48, 3
    s_add_u32 s86, s86, s87
    s_lshl_b32 s87, s86, 6
    s_add_u32 s87, s87, 28672
    v_mov_b32 v240, s87
    v_readlane_b32 s87, v4, 16
    s_lshl_b32 s86, s86, 12
    s_nop 0
    v_writelane_b32 v240, s87, 1
    s_and_b32 s87, s49, 3
    s_lshl_b32 s87, s87, 8
    s_add_u32 s86, s86, s87
    s_lshr_b32 s87, s50, 1
    s_lshl_b32 s87, s87, 10
    s_add_u32 s86, s86, s87
    s_add_u32 s86, s86, 786432
    v_writelane_b32 v240, s86, 2
    s_add_u32 s87, s86, 128
    v_writelane_b32 v240, s87, 3
    s_add_u32 s87, s86, 2048
    v_writelane_b32 v240, s87, 4
    s_add_u32 s87, s86, 2176
    v_writelane_b32 v240, s87, 5
    s_waitcnt vmcnt(14)
    s_barrier
    ds_read_b64_tr_b16 v[24:25], v224 offset:8192
    ds_read_b64_tr_b16 v[26:27], v224 offset:8704
    ds_read_b64_tr_b16 v[32:33], v224 offset:16384
    ds_read_b64_tr_b16 v[34:35], v224 offset:16896
    ds_read_b128 a[0:3], v220 offset:0
    ds_read_b128 a[4:7], v220 offset:2048
    ds_read_b128 a[8:11], v220 offset:4096
    ds_read_b128 a[12:15], v220 offset:6144
    ds_read_b128 v[16:19], v222 offset:0
    s_add_u32 m0, s91, 73728
    s_add_u32 s61, s92, 3
    s_and_b32 s61, s61, 7
    s_lshl_b32 s60, s61, 7
    s_add_u32 s60, s60, s88
    buffer_load_dwordx4 v216, s[8:11], s60 offen lds
    s_add_u32 m0, s91, 74752
    s_nop 0
    buffer_load_dwordx4 v217, s[8:11], s60 offen lds
    s_add_u32 m0, s91, 81920
    s_mul_i32 s61, s61, 196608
    s_add_u32 s61, s61, s90
    s_add_u32 s60, s61, 1024
    buffer_load_dwordx4 v218, s[12:15], s60 offen lds
    s_waitcnt lgkmcnt(0)
    v_mfma_f32_16x16x32_bf16 v[88:91], v[16:19], v[40:43], 0
    ds_read_b64_tr_b16 v[28:29], v224 offset:12288
    v_mfma_f32_16x16x32_bf16 v[92:95], v[16:19], v[16:19], 0
    ds_read_b64_tr_b16 v[30:31], v224 offset:12800
    ds_read_b64_tr_b16 v[36:37], v224 offset:20480
    v_mfma_f32_16x16x32_bf16 v[80:83], v[40:43], v[24:27], 0
    ds_read_b64_tr_b16 v[38:39], v224 offset:20992
    ds_read_b128 a[16:19], v221 offset:0
    v_mfma_f32_16x16x32_bf16 v[84:87], v[40:43], v[32:35], 0
    s_add_u32 m0, s91, 82944
    s_nop 0
    buffer_load_dwordx4 v219, s[12:15], s60 offen lds
    v_mfma_f32_16x16x32_bf16 v[48:51], a[0:3], v[24:27], 0
    ds_read_b128 a[20:23], v221 offset:2048
    v_mfma_f32_16x16x32_bf16 v[64:67], a[0:3], v[32:35], 0
    ds_read_b128 a[24:27], v221 offset:4096
    v_mfma_f32_16x16x32_bf16 v[52:55], a[4:7], v[24:27], 0
    ds_read_b128 a[28:31], v221 offset:6144
    ds_read_b128 v[20:23], v223 offset:0
    v_mfma_f32_16x16x32_bf16 v[68:71], a[4:7], v[32:35], 0
    s_add_u32 m0, s91, 90112
    v_mfma_f32_16x16x32_bf16 v[56:59], a[8:11], v[24:27], 0
    s_add_u32 s60, s61, 2048
    buffer_load_dwordx4 v218, s[12:15], s60 offen lds
    v_mfma_f32_16x16x32_bf16 v[72:75], a[8:11], v[32:35], 0
    v_mfma_f32_16x16x32_bf16 v[60:63], a[12:15], v[24:27], 0
    s_add_u32 m0, s91, 91136
    v_mfma_f32_16x16x32_bf16 v[76:79], a[12:15], v[32:35], 0
    buffer_load_dwordx4 v219, s[12:15], s60 offen lds
    s_waitcnt vmcnt(14) lgkmcnt(0)
    s_barrier
    v_mfma_f32_16x16x32_bf16 v[88:91], v[20:23], v[40:43], v[88:91]
    ds_read_b64_tr_b16 v[24:25], v224 offset:32768
    ds_read_b64_tr_b16 v[26:27], v224 offset:33280
    v_mfma_f32_16x16x32_bf16 v[92:95], v[20:23], v[20:23], v[92:95]
    ds_read_b64_tr_b16 v[32:33], v224 offset:40960
    ds_read_b64_tr_b16 v[34:35], v224 offset:41472
    ds_read_b128 a[32:35], v220 offset:24576
    v_mfma_f32_16x16x32_bf16 v[80:83], v[40:43], v[28:31], v[80:83]
    s_add_u32 m0, s91, 98304
    s_add_u32 s61, s92, 4
    s_and_b32 s61, s61, 7
    v_mfma_f32_16x16x32_bf16 v[84:87], v[40:43], v[36:39], v[84:87]
    s_lshl_b32 s60, s61, 7
    s_add_u32 s60, s60, s88
    buffer_load_dwordx4 v216, s[8:11], s60 offen lds
    v_mfma_f32_16x16x32_bf16 v[48:51], a[16:19], v[28:31], v[48:51]
    ds_read_b128 a[36:39], v220 offset:26624
    v_mfma_f32_16x16x32_bf16 v[64:67], a[16:19], v[36:39], v[64:67]
    ds_read_b128 a[40:43], v220 offset:28672
    v_mfma_f32_16x16x32_bf16 v[52:55], a[20:23], v[28:31], v[52:55]
    ds_read_b128 a[44:47], v220 offset:30720
    ds_read_b128 v[16:19], v222 offset:24576
    v_mfma_f32_16x16x32_bf16 v[68:71], a[20:23], v[36:39], v[68:71]
    s_add_u32 m0, s91, 99328
    v_mfma_f32_16x16x32_bf16 v[56:59], a[24:27], v[28:31], v[56:59]
    buffer_load_dwordx4 v217, s[8:11], s60 offen lds
    v_mfma_f32_16x16x32_bf16 v[72:75], a[24:27], v[36:39], v[72:75]
    v_mfma_f32_16x16x32_bf16 v[60:63], a[28:31], v[28:31], v[60:63]
    s_add_u32 m0, s91, 106496
    s_mul_i32 s61, s61, 196608
    v_mfma_f32_16x16x32_bf16 v[76:79], a[28:31], v[36:39], v[76:79]
    s_add_u32 s61, s61, s90
    s_add_u32 s60, s61, 1024
    buffer_load_dwordx4 v218, s[12:15], s60 offen lds
    s_waitcnt lgkmcnt(0)
    v_mfma_f32_16x16x32_bf16 v[88:91], v[16:19], v[40:43], v[88:91]
    ds_read_b64_tr_b16 v[28:29], v224 offset:36864
    v_mfma_f32_16x16x32_bf16 v[92:95], v[16:19], v[16:19], v[92:95]
    ds_read_b64_tr_b16 v[30:31], v224 offset:37376
    ds_read_b64_tr_b16 v[36:37], v224 offset:45056
    v_mfma_f32_16x16x32_bf16 v[80:83], v[40:43], v[24:27], v[80:83]
    ds_read_b64_tr_b16 v[38:39], v224 offset:45568
    ds_read_b128 a[48:51], v221 offset:24576
    v_mfma_f32_16x16x32_bf16 v[84:87], v[40:43], v[32:35], v[84:87]
    s_add_u32 m0, s91, 107520
    s_nop 0
    buffer_load_dwordx4 v219, s[12:15], s60 offen lds
    v_mfma_f32_16x16x32_bf16 v[48:51], a[32:35], v[24:27], v[48:51]
    ds_read_b128 a[52:55], v221 offset:26624
    v_mfma_f32_16x16x32_bf16 v[64:67], a[32:35], v[32:35], v[64:67]
    ds_read_b128 a[56:59], v221 offset:28672
    v_mfma_f32_16x16x32_bf16 v[52:55], a[36:39], v[24:27], v[52:55]
    ds_read_b128 a[60:63], v221 offset:30720
    ds_read_b128 v[20:23], v223 offset:24576
    v_mfma_f32_16x16x32_bf16 v[68:71], a[36:39], v[32:35], v[68:71]
    s_add_u32 m0, s91, 114688
    v_mfma_f32_16x16x32_bf16 v[56:59], a[40:43], v[24:27], v[56:59]
    s_add_u32 s60, s61, 2048
    buffer_load_dwordx4 v218, s[12:15], s60 offen lds
    v_mfma_f32_16x16x32_bf16 v[72:75], a[40:43], v[32:35], v[72:75]
    v_mfma_f32_16x16x32_bf16 v[60:63], a[44:47], v[24:27], v[60:63]
    s_add_u32 m0, s91, 115712
    v_mfma_f32_16x16x32_bf16 v[76:79], a[44:47], v[32:35], v[76:79]
    buffer_load_dwordx4 v219, s[12:15], s60 offen lds
    s_waitcnt vmcnt(12) lgkmcnt(0)
    s_barrier
    v_readfirstlane_b32 s4, v225
    s_nop 0
    s_mul_i32 s4, s4, 0x9e3779b1
    s_add_u32 s4, s4, 0x7f4a7c15
    s_or_b32 s86, s62, s50
    s_cmp_lg_u32 s86, 0
    s_cbranch_scc1 Lz6
    v_mov_b32 v5, s4
    s_mov_b64 exec, 1
    buffer_store_dword v5, off, s[40:43], s95 sc1
    s_mov_b64 exec, -1
Lz6:
    v_add_u32 v220, 49152, v220
    v_add_u32 v221, 49152, v221
    v_add_u32 v222, 49152, v222
    v_add_u32 v223, 49152, v223
    v_add_u32 v224, 49152, v224
    v_mfma_f32_16x16x32_bf16 v[88:91], v[20:23], v[40:43], v[88:91]
    ds_read_b64_tr_b16 v[24:25], v224 offset:8192
    ds_read_b64_tr_b16 v[26:27], v224 offset:8704
    v_mfma_f32_16x16x32_bf16 v[92:95], v[20:23], v[20:23], v[92:95]
    ds_read_b64_tr_b16 v[32:33], v224 offset:16384
    ds_read_b64_tr_b16 v[34:35], v224 offset:16896
    ds_read_b128 a[64:67], v220 offset:0
    v_mfma_f32_16x16x32_bf16 v[80:83], v[40:43], v[28:31], v[80:83]
    s_add_u32 m0, s91, 122880
    s_add_u32 s61, s92, 5
    s_and_b32 s61, s61, 7
    v_mfma_f32_16x16x32_bf16 v[84:87], v[40:43], v[36:39], v[84:87]
    s_lshl_b32 s60, s61, 7
    s_add_u32 s60, s60, s88
    buffer_load_dwordx4 v216, s[8:11], s60 offen lds
    v_mfma_f32_16x16x32_bf16 v[48:51], a[48:51], v[28:31], v[48:51]
    ds_read_b128 a[68:71], v220 offset:2048
    v_mfma_f32_16x16x32_bf16 v[64:67], a[48:51], v[36:39], v[64:67]
    ds_read_b128 a[72:75], v220 offset:4096
    v_mfma_f32_16x16x32_bf16 v[52:55], a[52:55], v[28:31], v[52:55]
    ds_read_b128 a[76:79], v220 offset:6144
    ds_read_b128 v[16:19], v222 offset:0
    v_mfma_f32_16x16x32_bf16 v[68:71], a[52:55], v[36:39], v[68:71]
    s_add_u32 m0, s91, 123904
    v_mfma_f32_16x16x32_bf16 v[56:59], a[56:59], v[28:31], v[56:59]
    buffer_load_dwordx4 v217, s[8:11], s60 offen lds
    v_mfma_f32_16x16x32_bf16 v[72:75], a[56:59], v[36:39], v[72:75]
    v_mfma_f32_16x16x32_bf16 v[60:63], a[60:63], v[28:31], v[60:63]
    s_add_u32 m0, s91, 131072
    s_mul_i32 s61, s61, 196608
    v_mfma_f32_16x16x32_bf16 v[76:79], a[60:63], v[36:39], v[76:79]
    s_add_u32 s61, s61, s90
    s_add_u32 s60, s61, 1024
    buffer_load_dwordx4 v218, s[12:15], s60 offen lds
    s_waitcnt lgkmcnt(0)
    v_mfma_f32_16x16x32_bf16 v[88:91], v[16:19], v[40:43], v[88:91]
    ds_read_b64_tr_b16 v[28:29], v224 offset:12288
    v_mfma_f32_16x16x32_bf16 v[92:95], v[16:19], v[16:19], v[92:95]
    ds_read_b64_tr_b16 v[30:31], v224 offset:12800
    ds_read_b64_tr_b16 v[36:37], v224 offset:20480
    v_mfma_f32_16x16x32_bf16 v[80:83], v[40:43], v[24:27], v[80:83]
    ds_read_b64_tr_b16 v[38:39], v224 offset:20992
    ds_read_b128 a[80:83], v221 offset:0
    v_mfma_f32_16x16x32_bf16 v[84:87], v[40:43], v[32:35], v[84:87]
    s_add_u32 m0, s91, 132096
    s_nop 0
    buffer_load_dwordx4 v219, s[12:15], s60 offen lds
    v_mfma_f32_16x16x32_bf16 v[48:51], a[64:67], v[24:27], v[48:51]
    ds_read_b128 a[84:87], v221 offset:2048
    v_mfma_f32_16x16x32_bf16 v[64:67], a[64:67], v[32:35], v[64:67]
    ds_read_b128 a[88:91], v221 offset:4096
    v_mfma_f32_16x16x32_bf16 v[52:55], a[68:71], v[24:27], v[52:55]
    ds_read_b128 a[92:95], v221 offset:6144
    ds_read_b128 v[20:23], v223 offset:0
    v_mfma_f32_16x16x32_bf16 v[68:71], a[68:71], v[32:35], v[68:71]
    s_add_u32 m0, s91, 139264
    v_mfma_f32_16x16x32_bf16 v[56:59], a[72:75], v[24:27], v[56:59]
    s_add_u32 s60, s61, 2048
    buffer_load_dwordx4 v218, s[12:15], s60 offen lds
    v_mfma_f32_16x16x32_bf16 v[72:75], a[72:75], v[32:35], v[72:75]
    v_mfma_f32_16x16x32_bf16 v[60:63], a[76:79], v[24:27], v[60:63]
    s_add_u32 m0, s91, 140288
    v_mfma_f32_16x16x32_bf16 v[76:79], a[76:79], v[32:35], v[76:79]
    buffer_load_dwordx4 v219, s[12:15], s60 offen lds
    s_waitcnt vmcnt(12) lgkmcnt(0)
    s_barrier
    s_mov_b64 exec, 0x3f
    buffer_load_dword v241, v240, s[40:43], 0 offen
    s_mov_b64 exec, -1
    v_mfma_f32_16x16x32_bf16 v[88:91], v[20:23], v[40:43], v[88:91]
    ds_read_b64_tr_b16 v[24:25], v224 offset:32768
    ds_read_b64_tr_b16 v[26:27], v224 offset:33280
    v_mfma_f32_16x16x32_bf16 v[92:95], v[20:23], v[20:23], v[92:95]
    ds_read_b64_tr_b16 v[32:33], v224 offset:40960
    ds_read_b64_tr_b16 v[34:35], v224 offset:41472
    ds_read_b128 a[96:99], v220 offset:24576
    v_mfma_f32_16x16x32_bf16 v[80:83], v[40:43], v[28:31], v[80:83]
    s_add_u32 m0, s91, 0
    s_add_u32 s61, s92, 6
    s_and_b32 s61, s61, 7
    v_mfma_f32_16x16x32_bf16 v[84:87], v[40:43], v[36:39], v[84:87]
    s_lshl_b32 s60, s61, 7
    s_add_u32 s60, s60, s88
    buffer_load_dwordx4 v216, s[8:11], s60 offen lds
    v_mfma_f32_16x16x32_bf16 v[48:51], a[80:83], v[28:31], v[48:51]
    ds_read_b128 a[100:103], v220 offset:26624
    v_mfma_f32_16x16x32_bf16 v[64:67], a[80:83], v[36:39], v[64:67]
    ds_read_b128 a[104:107], v220 offset:28672
    v_mfma_f32_16x16x32_bf16 v[52:55], a[84:87], v[28:31], v[52:55]
    ds_read_b128 a[108:111], v220 offset:30720
    ds_read_b128 v[16:19], v222 offset:24576
    v_mfma_f32_16x16x32_bf16 v[68:71], a[84:87], v[36:39], v[68:71]
    s_add_u32 m0, s91, 1024
    v_mfma_f32_16x16x32_bf16 v[56:59], a[88:91], v[28:31], v[56:59]
    buffer_load_dwordx4 v217, s[8:11], s60 offen lds
    v_mfma_f32_16x16x32_bf16 v[72:75], a[88:91], v[36:39], v[72:75]
    v_mfma_f32_16x16x32_bf16 v[60:63], a[92:95], v[28:31], v[60:63]
    s_add_u32 m0, s91, 8192
    s_mul_i32 s61, s61, 196608
    v_mfma_f32_16x16x32_bf16 v[76:79], a[92:95], v[36:39], v[76:79]
    s_add_u32 s61, s61, s90
    s_add_u32 s60, s61, 1024
    buffer_load_dwordx4 v218, s[12:15], s60 offen lds
    s_waitcnt lgkmcnt(0)
    v_mfma_f32_16x16x32_bf16 v[88:91], v[16:19], v[40:43], v[88:91]
    ds_read_b64_tr_b16 v[28:29], v224 offset:36864
    v_mfma_f32_16x16x32_bf16 v[92:95], v[16:19], v[16:19], v[92:95]
    ds_read_b64_tr_b16 v[30:31], v224 offset:37376
    ds_read_b64_tr_b16 v[36:37], v224 offset:45056
    v_mfma_f32_16x16x32_bf16 v[80:83], v[40:43], v[24:27], v[80:83]
    ds_read_b64_tr_b16 v[38:39], v224 offset:45568
    ds_read_b128 a[112:115], v221 offset:24576
    v_mfma_f32_16x16x32_bf16 v[84:87], v[40:43], v[32:35], v[84:87]
    s_add_u32 m0, s91, 9216
    s_nop 0
    buffer_load_dwordx4 v219, s[12:15], s60 offen lds
    v_mfma_f32_16x16x32_bf16 v[48:51], a[96:99], v[24:27], v[48:51]
    ds_read_b128 a[116:119], v221 offset:26624
    v_mfma_f32_16x16x32_bf16 v[64:67], a[96:99], v[32:35], v[64:67]
    ds_read_b128 a[120:123], v221 offset:28672
    v_mfma_f32_16x16x32_bf16 v[52:55], a[100:103], v[24:27], v[52:55]
    ds_read_b128 a[124:127], v221 offset:30720
    ds_read_b128 v[20:23], v223 offset:24576
    v_mfma_f32_16x16x32_bf16 v[68:71], a[100:103], v[32:35], v[68:71]
    s_add_u32 m0, s91, 16384
    v_mfma_f32_16x16x32_bf16 v[56:59], a[104:107], v[24:27], v[56:59]
    s_add_u32 s60, s61, 2048
    buffer_load_dwordx4 v218, s[12:15], s60 offen lds
    v_mfma_f32_16x16x32_bf16 v[72:75], a[104:107], v[32:35], v[72:75]
    v_mfma_f32_16x16x32_bf16 v[60:63], a[108:111], v[24:27], v[60:63]
    s_add_u32 m0, s91, 17408
    v_mfma_f32_16x16x32_bf16 v[76:79], a[108:111], v[32:35], v[76:79]
    buffer_load_dwordx4 v219, s[12:15], s60 offen lds
    s_waitcnt vmcnt(13) lgkmcnt(0)
    s_barrier
    v_add_u32 v220, 49152, v220
    v_add_u32 v221, 49152, v221
    v_add_u32 v222, 49152, v222
    v_add_u32 v223, 49152, v223
    v_add_u32 v224, 49152, v224
    v_mfma_f32_16x16x32_bf16 v[88:91], v[20:23], v[40:43], v[88:91]
    ds_read_b64_tr_b16 v[24:25], v224 offset:8192
    ds_read_b64_tr_b16 v[26:27], v224 offset:8704
    v_mfma_f32_16x16x32_bf16 v[92:95], v[20:23], v[20:23], v[92:95]
    ds_read_b64_tr_b16 v[32:33], v224 offset:16384
    ds_read_b64_tr_b16 v[34:35], v224 offset:16896
    ds_read_b128 a[128:131], v220 offset:0
    v_mfma_f32_16x16x32_bf16 v[80:83], v[40:43], v[28:31], v[80:83]
    s_add_u32 m0, s91, 24576
    s_add_u32 s61, s92, 7
    s_and_b32 s61, s61, 7
    v_mfma_f32_16x16x32_bf16 v[84:87], v[40:43], v[36:39], v[84:87]
    s_lshl_b32 s60, s61, 7
    s_add_u32 s60, s60, s88
    buffer_load_dwordx4 v216, s[8:11], s60 offen lds
    v_mfma_f32_16x16x32_bf16 v[48:51], a[112:115], v[28:31], v[48:51]
    ds_read_b128 a[132:135], v220 offset:2048
    v_mfma_f32_16x16x32_bf16 v[64:67], a[112:115], v[36:39], v[64:67]
    ds_read_b128 a[136:139], v220 offset:4096
    v_mfma_f32_16x16x32_bf16 v[52:55], a[116:119], v[28:31], v[52:55]
    ds_read_b128 a[140:143], v220 offset:6144
    ds_read_b128 v[16:19], v222 offset:0
    v_mfma_f32_16x16x32_bf16 v[68:71], a[116:119], v[36:39], v[68:71]
    s_add_u32 m0, s91, 25600
    v_mfma_f32_16x16x32_bf16 v[56:59], a[120:123], v[28:31], v[56:59]
    buffer_load_dwordx4 v217, s[8:11], s60 offen lds
    v_mfma_f32_16x16x32_bf16 v[72:75], a[120:123], v[36:39], v[72:75]
    v_mfma_f32_16x16x32_bf16 v[60:63], a[124:127], v[28:31], v[60:63]
    s_add_u32 m0, s91, 32768
    s_mul_i32 s61, s61, 196608
    v_mfma_f32_16x16x32_bf16 v[76:79], a[124:127], v[36:39], v[76:79]
    s_add_u32 s61, s61, s90
    s_add_u32 s60, s61, 1024
    buffer_load_dwordx4 v218, s[12:15], s60 offen lds
    s_waitcnt lgkmcnt(0)
    v_mfma_f32_16x16x32_bf16 v[88:91], v[16:19], v[40:43], v[88:91]
    ds_read_b64_tr_b16 v[28:29], v224 offset:12288
    v_mfma_f32_16x16x32_bf16 v[92:95], v[16:19], v[16:19], v[92:95]
    ds_read_b64_tr_b16 v[30:31], v224 offset:12800
    ds_read_b64_tr_b16 v[36:37], v224 offset:20480
    v_mfma_f32_16x16x32_bf16 v[80:83], v[40:43], v[24:27], v[80:83]
    ds_read_b64_tr_b16 v[38:39], v224 offset:20992
    ds_read_b128 a[144:147], v221 offset:0
    v_mfma_f32_16x16x32_bf16 v[84:87], v[40:43], v[32:35], v[84:87]
    s_add_u32 m0, s91, 33792
    s_nop 0
    buffer_load_dwordx4 v219, s[12:15], s60 offen lds
    v_mfma_f32_16x16x32_bf16 v[48:51], a[128:131], v[24:27], v[48:51]
    ds_read_b128 a[148:151], v221 offset:2048
    v_mfma_f32_16x16x32_bf16 v[64:67], a[128:131], v[32:35], v[64:67]
    ds_read_b128 a[152:155], v221 offset:4096
    v_mfma_f32_16x16x32_bf16 v[52:55], a[132:135], v[24:27], v[52:55]
    ds_read_b128 a[156:159], v221 offset:6144
    ds_read_b128 v[20:23], v223 offset:0
    v_mfma_f32_16x16x32_bf16 v[68:71], a[132:135], v[32:35], v[68:71]
    s_add_u32 m0, s91, 40960
    v_mfma_f32_16x16x32_bf16 v[56:59], a[136:139], v[24:27], v[56:59]
    s_add_u32 s60, s61, 2048
    buffer_load_dwordx4 v218, s[12:15], s60 offen lds
    v_mfma_f32_16x16x32_bf16 v[72:75], a[136:139], v[32:35], v[72:75]
    v_mfma_f32_16x16x32_bf16 v[60:63], a[140:143], v[24:27], v[60:63]
    s_add_u32 m0, s91, 41984
    v_mfma_f32_16x16x32_bf16 v[76:79], a[140:143], v[32:35], v[76:79]
    buffer_load_dwordx4 v219, s[12:15], s60 offen lds
    s_waitcnt vmcnt(13) lgkmcnt(0)
    s_barrier
    v_mfma_f32_16x16x32_bf16 v[88:91], v[20:23], v[40:43], v[88:91]
    ds_read_b64_tr_b16 v[24:25], v224 offset:32768
    ds_read_b64_tr_b16 v[26:27], v224 offset:33280
    v_mfma_f32_16x16x32_bf16 v[92:95], v[20:23], v[20:23], v[92:95]
    ds_read_b64_tr_b16 v[32:33], v224 offset:40960
    ds_read_b64_tr_b16 v[34:35], v224 offset:41472
    ds_read_b128 a[160:163], v220 offset:24576
    v_mfma_f32_16x16x32_bf16 v[80:83], v[40:43], v[28:31], v[80:83]
    s_add_u32 m0, s91, 49152
    s_add_u32 s61, s92, 0
    s_and_b32 s61, s61, 7
    v_mfma_f32_16x16x32_bf16 v[84:87], v[40:43], v[36:39], v[84:87]
    s_mul_i32 s61, s61, 196608
    s_add_u32 s60, s61, s90
    buffer_load_dwordx4 v218, s[12:15], s60 offen lds
    v_mfma_f32_16x16x32_bf16 v[48:51], a[144:147], v[28:31], v[48:51]
    ds_read_b128 a[164:167], v220 offset:26624
    v_mfma_f32_16x16x32_bf16 v[64:67], a[144:147], v[36:39], v[64:67]
    ds_read_b128 a[168:171], v220 offset:28672
    v_mfma_f32_16x16x32_bf16 v[52:55], a[148:151], v[28:31], v[52:55]
    ds_read_b128 a[172:175], v220 offset:30720
    ds_read_b128 v[16:19], v222 offset:24576
    v_mfma_f32_16x16x32_bf16 v[68:71], a[148:151], v[36:39], v[68:71]
    s_add_u32 m0, s91, 50176
    v_mfma_f32_16x16x32_bf16 v[56:59], a[152:155], v[28:31], v[56:59]
    buffer_load_dwordx4 v219, s[12:15], s60 offen lds
    v_mfma_f32_16x16x32_bf16 v[72:75], a[152:155], v[36:39], v[72:75]
    v_mfma_f32_16x16x32_bf16 v[60:63], a[156:159], v[28:31], v[60:63]
    s_add_u32 m0, s91, 57344
    s_add_u32 s61, s92, 1
    s_and_b32 s61, s61, 7
    v_mfma_f32_16x16x32_bf16 v[76:79], a[156:159], v[36:39], v[76:79]
    s_mul_i32 s61, s61, 196608
    s_add_u32 s60, s61, s90
    buffer_load_dwordx4 v218, s[12:15], s60 offen lds
    s_waitcnt lgkmcnt(0)
    v_mfma_f32_16x16x32_bf16 v[88:91], v[16:19], v[40:43], v[88:91]
    ds_read_b64_tr_b16 v[28:29], v224 offset:36864
    v_mfma_f32_16x16x32_bf16 v[92:95], v[16:19], v[16:19], v[92:95]
    ds_read_b64_tr_b16 v[30:31], v224 offset:37376
    ds_read_b64_tr_b16 v[36:37], v224 offset:45056
    v_mfma_f32_16x16x32_bf16 v[80:83], v[40:43], v[24:27], v[80:83]
    ds_read_b64_tr_b16 v[38:39], v224 offset:45568
    ds_read_b128 a[176:179], v221 offset:24576
    v_mfma_f32_16x16x32_bf16 v[84:87], v[40:43], v[32:35], v[84:87]
    s_add_u32 m0, s91, 58368
    s_nop 0
    buffer_load_dwordx4 v219, s[12:15], s60 offen lds
    v_mfma_f32_16x16x32_bf16 v[48:51], a[160:163], v[24:27], v[48:51]
    ds_read_b128 a[180:183], v221 offset:26624
    v_mfma_f32_16x16x32_bf16 v[64:67], a[160:163], v[32:35], v[64:67]
    ds_read_b128 a[184:187], v221 offset:28672
    v_mfma_f32_16x16x32_bf16 v[52:55], a[164:167], v[24:27], v[52:55]
    ds_read_b128 a[188:191], v221 offset:30720
    ds_read_b128 v[20:23], v223 offset:24576
    v_mfma_f32_16x16x32_bf16 v[68:71], a[164:167], v[32:35], v[68:71]
    s_add_u32 m0, s91, 65536
    s_add_u32 s61, s92, 2
    s_and_b32 s61, s61, 7
    v_mfma_f32_16x16x32_bf16 v[56:59], a[168:171], v[24:27], v[56:59]
    s_mul_i32 s61, s61, 196608
    s_add_u32 s60, s61, s90
    buffer_load_dwordx4 v218, s[12:15], s60 offen lds
    v_mfma_f32_16x16x32_bf16 v[72:75], a[168:171], v[32:35], v[72:75]
    v_mfma_f32_16x16x32_bf16 v[60:63], a[172:175], v[24:27], v[60:63]
    s_add_u32 m0, s91, 66560
    v_mfma_f32_16x16x32_bf16 v[76:79], a[172:175], v[32:35], v[76:79]
    buffer_load_dwordx4 v219, s[12:15], s60 offen lds
    s_waitcnt vmcnt(12) lgkmcnt(0)
    s_barrier
    buffer_load_dword v230, off, s[40:43], s95 sc1
    v_subrev_u32 v220, 98304, v220
    v_subrev_u32 v221, 98304, v221
    v_subrev_u32 v222, 98304, v222
    v_subrev_u32 v223, 98304, v223
    v_subrev_u32 v224, 98304, v224
    v_mfma_f32_16x16x32_bf16 v[88:91], v[20:23], v[40:43], v[88:91]
    ds_read_b64_tr_b16 v[24:25], v224 offset:8192
    ds_read_b64_tr_b16 v[26:27], v224 offset:8704
    v_mfma_f32_16x16x32_bf16 v[92:95], v[20:23], v[20:23], v[92:95]
    ds_read_b64_tr_b16 v[32:33], v224 offset:16384
    ds_read_b64_tr_b16 v[34:35], v224 offset:16896
    ds_read_b128 a[192:195], v220 offset:0
    v_mfma_f32_16x16x32_bf16 v[80:83], v[40:43], v[28:31], v[80:83]
    s_add_u32 m0, s91, 73728
    s_add_u32 s61, s92, 3
    s_and_b32 s61, s61, 7
    v_mfma_f32_16x16x32_bf16 v[84:87], v[40:43], v[36:39], v[84:87]
    s_mul_i32 s61, s61, 196608
    s_add_u32 s60, s61, s90
    buffer_load_dwordx4 v218, s[12:15], s60 offen lds
    v_mfma_f32_16x16x32_bf16 v[48:51], a[176:179], v[28:31], v[48:51]
    ds_read_b128 a[196:199], v220 offset:2048
    v_mfma_f32_16x16x32_bf16 v[64:67], a[176:179], v[36:39], v[64:67]
    ds_read_b128 a[200:203], v220 offset:4096
    v_mfma_f32_16x16x32_bf16 v[52:55], a[180:183], v[28:31], v[52:55]
    ds_read_b128 a[204:207], v220 offset:6144
    ds_read_b128 v[16:19], v222 offset:0
    v_mfma_f32_16x16x32_bf16 v[68:71], a[180:183], v[36:39], v[68:71]
    s_add_u32 m0, s91, 74752
    v_mfma_f32_16x16x32_bf16 v[56:59], a[184:187], v[28:31], v[56:59]
    buffer_load_dwordx4 v219, s[12:15], s60 offen lds
    v_mfma_f32_16x16x32_bf16 v[72:75], a[184:187], v[36:39], v[72:75]
    v_mfma_f32_16x16x32_bf16 v[60:63], a[188:191], v[28:31], v[60:63]
    s_add_u32 m0, s91, 81920
    s_add_u32 s61, s92, 4
    s_and_b32 s61, s61, 7
    v_mfma_f32_16x16x32_bf16 v[76:79], a[188:191], v[36:39], v[76:79]
    s_mul_i32 s61, s61, 196608
    s_add_u32 s60, s61, s90
    buffer_load_dwordx4 v218, s[12:15], s60 offen lds
    s_waitcnt lgkmcnt(0)
    v_mfma_f32_16x16x32_bf16 v[88:91], v[16:19], v[40:43], v[88:91]
    ds_read_b64_tr_b16 v[28:29], v224 offset:12288
    v_mfma_f32_16x16x32_bf16 v[92:95], v[16:19], v[16:19], v[92:95]
    ds_read_b64_tr_b16 v[30:31], v224 offset:12800
    ds_read_b64_tr_b16 v[36:37], v224 offset:20480
    v_mfma_f32_16x16x32_bf16 v[80:83], v[40:43], v[24:27], v[80:83]
    ds_read_b64_tr_b16 v[38:39], v224 offset:20992
    ds_read_b128 a[208:211], v221 offset:0
    v_mfma_f32_16x16x32_bf16 v[84:87], v[40:43], v[32:35], v[84:87]
    s_add_u32 m0, s91, 82944
    s_nop 0
    buffer_load_dwordx4 v219, s[12:15], s60 offen lds
    v_mfma_f32_16x16x32_bf16 v[48:51], a[192:195], v[24:27], v[48:51]
    ds_read_b128 a[212:215], v221 offset:2048
    v_mfma_f32_16x16x32_bf16 v[64:67], a[192:195], v[32:35], v[64:67]
    ds_read_b128 a[216:219], v221 offset:4096
    v_mfma_f32_16x16x32_bf16 v[52:55], a[196:199], v[24:27], v[52:55]
    ds_read_b128 a[220:223], v221 offset:6144
    ds_read_b128 v[20:23], v223 offset:0
    v_mfma_f32_16x16x32_bf16 v[68:71], a[196:199], v[32:35], v[68:71]
    s_add_u32 m0, s91, 90112
    s_add_u32 s61, s92, 5
    s_and_b32 s61, s61, 7
    v_mfma_f32_16x16x32_bf16 v[56:59], a[200:203], v[24:27], v[56:59]
    s_mul_i32 s61, s61, 196608
    s_add_u32 s60, s61, s90
    buffer_load_dwordx4 v218, s[12:15], s60 offen lds
    v_mfma_f32_16x16x32_bf16 v[72:75], a[200:203], v[32:35], v[72:75]
    v_mfma_f32_16x16x32_bf16 v[60:63], a[204:207], v[24:27], v[60:63]
    s_add_u32 m0, s91, 91136
    v_mfma_f32_16x16x32_bf16 v[76:79], a[204:207], v[32:35], v[76:79]
    buffer_load_dwordx4 v219, s[12:15], s60 offen lds
    s_waitcnt vmcnt(13) lgkmcnt(0)
    s_barrier
    s_lshl_b32 s86, s2, 2
    s_add_u32 s86, s86, s50
    s_mul_i32 s86, s86, 512
    s_mov_b64 exec, 15
    buffer_load_dword v232, v226, s[16:19], s86 offen
    s_mov_b64 exec, -1
    s_lshl_b32 s86, s2, 2
    s_add_u32 s86, s86, s50
    s_mul_i32 s86, s86, 1792
    s_mov_b64 exec, 16383
    buffer_load_dword v233, v226, s[20:23], s86 offen
    s_mov_b64 exec, -1
    s_lshl_b32 s86, s2, 2
    s_add_u32 s86, s86, s50
    s_mul_i32 s86, s86, 896
    s_mov_b64 exec, 127
    buffer_load_dword v234, v226, s[32:35], s86 offen
    s_mov_b64 exec, -1
    v_mfma_f32_16x16x32_bf16 v[88:91], v[20:23], v[40:43], v[88:91]
    ds_read_b64_tr_b16 v[24:25], v224 offset:32768
    ds_read_b64_tr_b16 v[26:27], v224 offset:33280
    v_mfma_f32_16x16x32_bf16 v[92:95], v[20:23], v[20:23], v[92:95]
    ds_read_b64_tr_b16 v[32:33], v224 offset:40960
    ds_read_b64_tr_b16 v[34:35], v224 offset:41472
    ds_read_b128 a[224:227], v220 offset:24576
    v_mfma_f32_16x16x32_bf16 v[80:83], v[40:43], v[28:31], v[80:83]
    s_add_u32 m0, s91, 98304
    s_add_u32 s61, s92, 6
    s_and_b32 s61, s61, 7
    v_mfma_f32_16x16x32_bf16 v[84:87], v[40:43], v[36:39], v[84:87]
    s_mul_i32 s61, s61, 196608
    s_add_u32 s60, s61, s90
    buffer_load_dwordx4 v218, s[12:15], s60 offen lds
    v_mfma_f32_16x16x32_bf16 v[48:51], a[208:211], v[28:31], v[48:51]
    ds_read_b128 a[228:231], v220 offset:26624
    v_mfma_f32_16x16x32_bf16 v[64:67], a[208:211], v[36:39], v[64:67]
    ds_read_b128 a[232:235], v220 offset:28672
    v_mfma_f32_16x16x32_bf16 v[52:55], a[212:215], v[28:31], v[52:55]
    ds_read_b128 a[236:239], v220 offset:30720
    ds_read_b128 v[16:19], v222 offset:24576
    v_mfma_f32_16x16x32_bf16 v[68:71], a[212:215], v[36:39], v[68:71]
    s_add_u32 m0, s91, 99328
    v_mfma_f32_16x16x32_bf16 v[56:59], a[216:219], v[28:31], v[56:59]
    buffer_load_dwordx4 v219, s[12:15], s60 offen lds
    v_mfma_f32_16x16x32_bf16 v[72:75], a[216:219], v[36:39], v[72:75]
    v_mfma_f32_16x16x32_bf16 v[60:63], a[220:223], v[28:31], v[60:63]
    v_mfma_f32_16x16x32_bf16 v[76:79], a[220:223], v[36:39], v[76:79]
    s_waitcnt lgkmcnt(0)
    v_mfma_f32_16x16x32_bf16 v[88:91], v[16:19], v[40:43], v[88:91]
    ds_read_b64_tr_b16 v[28:29], v224 offset:36864
    ds_read_b64_tr_b16 v[30:31], v224 offset:37376
    v_mfma_f32_16x16x32_bf16 v[92:95], v[16:19], v[16:19], v[92:95]
    ds_read_b64_tr_b16 v[36:37], v224 offset:45056
    ds_read_b64_tr_b16 v[38:39], v224 offset:45568
    ds_read_b128 a[240:243], v221 offset:24576
    v_mfma_f32_16x16x32_bf16 v[80:83], v[40:43], v[24:27], v[80:83]
    s_add_u32 m0, s91, 106496
    s_add_u32 s61, s92, 7
    s_and_b32 s61, s61, 7
    v_mfma_f32_16x16x32_bf16 v[84:87], v[40:43], v[32:35], v[84:87]
    s_mul_i32 s61, s61, 196608
    s_add_u32 s60, s61, s90
    buffer_load_dwordx4 v218, s[12:15], s60 offen lds
    v_mfma_f32_16x16x32_bf16 v[48:51], a[224:227], v[24:27], v[48:51]
    ds_read_b128 a[244:247], v221 offset:26624
    v_mfma_f32_16x16x32_bf16 v[64:67], a[224:227], v[32:35], v[64:67]
    ds_read_b128 a[248:251], v221 offset:28672
    v_mfma_f32_16x16x32_bf16 v[52:55], a[228:231], v[24:27], v[52:55]
    ds_read_b128 a[252:255], v221 offset:30720
    ds_read_b128 v[20:23], v223 offset:24576
    v_mfma_f32_16x16x32_bf16 v[68:71], a[228:231], v[32:35], v[68:71]
    s_add_u32 m0, s91, 107520
    v_mfma_f32_16x16x32_bf16 v[56:59], a[232:235], v[24:27], v[56:59]
    buffer_load_dwordx4 v219, s[12:15], s60 offen lds
    v_mfma_f32_16x16x32_bf16 v[72:75], a[232:235], v[32:35], v[72:75]
    v_mfma_f32_16x16x32_bf16 v[60:63], a[236:239], v[24:27], v[60:63]
    v_mfma_f32_16x16x32_bf16 v[76:79], a[236:239], v[32:35], v[76:79]
    s_waitcnt lgkmcnt(0)
    v_mfma_f32_16x16x32_bf16 v[88:91], v[20:23], v[40:43], v[88:91]
    v_mfma_f32_16x16x32_bf16 v[92:95], v[20:23], v[20:23], v[92:95]
    v_mfma_f32_16x16x32_bf16 v[80:83], v[40:43], v[28:31], v[80:83]
    v_mfma_f32_16x16x32_bf16 v[84:87], v[40:43], v[36:39], v[84:87]
    v_mfma_f32_16x16x32_bf16 v[48:51], a[240:243], v[28:31], v[48:51]
    v_mfma_f32_16x16x32_bf16 v[64:67], a[240:243], v[36:39], v[64:67]
    v_mfma_f32_16x16x32_bf16 v[52:55], a[244:247], v[28:31], v[52:55]
    s_nop 1
    v_cndmask_b32 v88, v88, v89, s[44:45]
    v_cndmask_b32 v92, v92, v93, s[44:45]
    v_mfma_f32_16x16x32_bf16 v[68:71], a[244:247], v[36:39], v[68:71]
    v_cndmask_b32 v88, v88, v90, s[46:47]
    v_cndmask_b32 v92, v92, v94, s[46:47]
    v_mfma_f32_16x16x32_bf16 v[56:59], a[248:251], v[28:31], v[56:59]
    v_cndmask_b32 v88, v88, v91, s[82:83]
    v_cndmask_b32 v92, v92, v95, s[82:83]
    v_mfma_f32_16x16x32_bf16 v[72:75], a[248:251], v[36:39], v[72:75]
    v_mul_f32 v88, 0xbb000000, v88
    v_mul_f32 v92, 0x3b000000, v92
    v_mfma_f32_16x16x32_bf16 v[60:63], a[252:255], v[28:31], v[60:63]
    v_fma_f32 v92, -v88, v88, v92
    v_max_f32 v92, 0, v92
    v_mfma_f32_16x16x32_bf16 v[76:79], a[252:255], v[36:39], v[76:79]
    v_add_f32 v92, 0x3727c5ac, v92
    v_rsq_f32 v89, v92
    s_nop 0
    v_mul_f32 v90, v88, v89
    s_mov_b32 exec_lo, 0x00f0000f
    s_mov_b32 exec_hi, 0xf0000f00
    ds_write_b32 v212, v89
    ds_write_b32 v212, v90 offset:256
    s_mov_b64 exec, -1
    s_waitcnt lgkmcnt(0)
    s_barrier
    ds_read_b128 v[120:123], v213 offset:0
    ds_read_b128 v[124:127], v213 offset:256
    ds_read_b128 v[128:131], v213 offset:64
    ds_read_b128 v[132:135], v213 offset:320
    ds_read_b128 v[136:139], v213 offset:128
    ds_read_b128 v[140:143], v213 offset:384
    ds_read_b128 v[144:147], v213 offset:192
    ds_read_b128 v[148:151], v213 offset:448
    ds_read_b32 v152, v214 offset:0
    ds_read_b32 v153, v214 offset:256
    ds_read_b32 v154, v214 offset:64
    ds_read_b32 v155, v214 offset:320
    ds_read_b32 v156, v214 offset:128
    ds_read_b32 v157, v214 offset:384
    ds_read_b32 v158, v214 offset:192
    ds_read_b32 v159, v214 offset:448
    s_waitcnt lgkmcnt(14)
    v_pk_mul_f32 v[176:177], v[124:125], v[80:81] op_sel:[0,0] op_sel_hi:[1,0]
    v_pk_mul_f32 v[180:181], v[124:125], v[84:85] op_sel:[0,0] op_sel_hi:[1,0]
    v_pk_mul_f32 v[178:179], v[126:127], v[80:81] op_sel:[0,0] op_sel_hi:[1,0]
    v_pk_mul_f32 v[182:183], v[126:127], v[84:85] op_sel:[0,0] op_sel_hi:[1,0]
    v_pk_fma_f32 v[48:49], v[48:49], v[120:121], v[176:177]
    v_pk_fma_f32 v[64:65], v[64:65], v[120:121], v[180:181]
    v_pk_fma_f32 v[50:51], v[50:51], v[122:123], v[178:179]
    v_pk_fma_f32 v[66:67], v[66:67], v[122:123], v[182:183]
    v_pk_mul_f32 v[176:177], v[48:49], s[52:53]
    v_cvt_pk_bf16_f32 v168, v64, v65
    v_pk_mul_f32 v[178:179], v[50:51], s[52:53]
    v_cvt_pk_bf16_f32 v169, v66, v67
    v_max_f32 v48, 0, v48
    v_max_f32 v50, 0, v50
    v_max_f32 v49, 0, v49
    v_max_f32 v51, 0, v51
    v_min_f32 v176, 0, v176
    v_min_f32 v178, 0, v178
    v_min_f32 v177, 0, v177
    v_min_f32 v179, 0, v179
    v_exp_f32 v176, v176
    v_exp_f32 v178, v178
    v_exp_f32 v177, v177
    v_exp_f32 v179, v179
    v_pk_add_f32 v[48:49], v[48:49], s[54:55]
    v_pk_add_f32 v[50:51], v[50:51], s[54:55]
    v_pk_add_f32 v[48:49], v[48:49], v[176:177]
    v_pk_add_f32 v[50:51], v[50:51], v[178:179]
    v_cvt_pk_bf16_f32 v160, v48, v49
    v_cvt_pk_bf16_f32 v161, v50, v51
    s_waitcnt lgkmcnt(12)
    v_pk_mul_f32 v[176:177], v[132:133], v[80:81] op_sel:[0,0] op_sel_hi:[1,0]
    v_pk_mul_f32 v[180:181], v[132:133], v[84:85] op_sel:[0,0] op_sel_hi:[1,0]
    v_pk_mul_f32 v[178:179], v[134:135], v[80:81] op_sel:[0,0] op_sel_hi:[1,0]
    v_pk_mul_f32 v[182:183], v[134:135], v[84:85] op_sel:[0,0] op_sel_hi:[1,0]
    v_pk_fma_f32 v[52:53], v[52:53], v[128:129], v[176:177]
    v_pk_fma_f32 v[68:69], v[68:69], v[128:129], v[180:181]
    v_pk_fma_f32 v[54:55], v[54:55], v[130:131], v[178:179]
    v_pk_fma_f32 v[70:71], v[70:71], v[130:131], v[182:183]
    v_pk_mul_f32 v[176:177], v[52:53], s[52:53]
    v_cvt_pk_bf16_f32 v170, v68, v69
    v_pk_mul_f32 v[178:179], v[54:55], s[52:53]
    v_cvt_pk_bf16_f32 v171, v70, v71
    v_max_f32 v52, 0, v52
    v_max_f32 v54, 0, v54
    v_max_f32 v53, 0, v53
    v_max_f32 v55, 0, v55
    v_min_f32 v176, 0, v176
    v_min_f32 v178, 0, v178
    v_min_f32 v177, 0, v177
    v_min_f32 v179, 0, v179
    v_exp_f32 v176, v176
    v_exp_f32 v178, v178
    v_exp_f32 v177, v177
    v_exp_f32 v179, v179
    v_pk_add_f32 v[52:53], v[52:53], s[54:55]
    v_pk_add_f32 v[54:55], v[54:55], s[54:55]
    v_pk_add_f32 v[52:53], v[52:53], v[176:177]
    v_pk_add_f32 v[54:55], v[54:55], v[178:179]
    v_cvt_pk_bf16_f32 v162, v52, v53
    v_cvt_pk_bf16_f32 v163, v54, v55
    s_waitcnt lgkmcnt(10)
    v_pk_mul_f32 v[176:177], v[140:141], v[80:81] op_sel:[0,0] op_sel_hi:[1,0]
    v_pk_mul_f32 v[180:181], v[140:141], v[84:85] op_sel:[0,0] op_sel_hi:[1,0]
    v_pk_mul_f32 v[178:179], v[142:143], v[80:81] op_sel:[0,0] op_sel_hi:[1,0]
    v_pk_mul_f32 v[182:183], v[142:143], v[84:85] op_sel:[0,0] op_sel_hi:[1,0]
    v_pk_fma_f32 v[56:57], v[56:57], v[136:137], v[176:177]
    v_pk_fma_f32 v[72:73], v[72:73], v[136:137], v[180:181]
    v_pk_fma_f32 v[58:59], v[58:59], v[138:139], v[178:179]
    v_pk_fma_f32 v[74:75], v[74:75], v[138:139], v[182:183]
    v_pk_mul_f32 v[176:177], v[56:57], s[52:53]
    v_cvt_pk_bf16_f32 v172, v72, v73
    v_pk_mul_f32 v[178:179], v[58:59], s[52:53]
    v_cvt_pk_bf16_f32 v173, v74, v75
    v_max_f32 v56, 0, v56
    v_max_f32 v58, 0, v58
    v_max_f32 v57, 0, v57
    v_max_f32 v59, 0, v59
    v_min_f32 v176, 0, v176
    v_min_f32 v178, 0, v178
    v_min_f32 v177, 0, v177
    v_min_f32 v179, 0, v179
    v_exp_f32 v176, v176
    v_exp_f32 v178, v178
    v_exp_f32 v177, v177
    v_exp_f32 v179, v179
    v_pk_add_f32 v[56:57], v[56:57], s[54:55]
    v_pk_add_f32 v[58:59], v[58:59], s[54:55]
    v_pk_add_f32 v[56:57], v[56:57], v[176:177]
    v_pk_add_f32 v[58:59], v[58:59], v[178:179]
    v_cvt_pk_bf16_f32 v164, v56, v57
    v_cvt_pk_bf16_f32 v165, v58, v59
    s_waitcnt lgkmcnt(8)
    v_pk_mul_f32 v[176:177], v[148:149], v[80:81] op_sel:[0,0] op_sel_hi:[1,0]
    v_pk_mul_f32 v[180:181], v[148:149], v[84:85] op_sel:[0,0] op_sel_hi:[1,0]
    v_pk_mul_f32 v[178:179], v[150:151], v[80:81] op_sel:[0,0] op_sel_hi:[1,0]
    v_pk_mul_f32 v[182:183], v[150:151], v[84:85] op_sel:[0,0] op_sel_hi:[1,0]
    v_pk_fma_f32 v[60:61], v[60:61], v[144:145], v[176:177]
    v_pk_fma_f32 v[76:77], v[76:77], v[144:145], v[180:181]
    v_pk_fma_f32 v[62:63], v[62:63], v[146:147], v[178:179]
    v_pk_fma_f32 v[78:79], v[78:79], v[146:147], v[182:183]
    v_pk_mul_f32 v[176:177], v[60:61], s[52:53]
    v_cvt_pk_bf16_f32 v174, v76, v77
    v_pk_mul_f32 v[178:179], v[62:63], s[52:53]
    v_cvt_pk_bf16_f32 v175, v78, v79
    v_max_f32 v60, 0, v60
    v_max_f32 v62, 0, v62
    v_max_f32 v61, 0, v61
    v_max_f32 v63, 0, v63
    v_min_f32 v176, 0, v176
    v_min_f32 v178, 0, v178
    v_min_f32 v177, 0, v177
    v_min_f32 v179, 0, v179
    v_exp_f32 v176, v176
    v_exp_f32 v178, v178
    v_exp_f32 v177, v177
    v_exp_f32 v179, v179
    v_pk_add_f32 v[60:61], v[60:61], s[54:55]
    v_pk_add_f32 v[62:63], v[62:63], s[54:55]
    v_pk_add_f32 v[60:61], v[60:61], v[176:177]
    v_pk_add_f32 v[62:63], v[62:63], v[178:179]
    v_cvt_pk_bf16_f32 v166, v60, v61
    v_cvt_pk_bf16_f32 v167, v62, v63
    v_mfma_f32_16x16x32_bf16 v[184:187], v[160:163], v[168:171], 0
    v_mfma_f32_16x16x32_bf16 v[188:191], v[160:163], v[40:43], 0
    v_mfma_f32_16x16x32_bf16 v[184:187], v[164:167], v[172:175], v[184:187]
    v_mfma_f32_16x16x32_bf16 v[188:191], v[164:167], v[40:43], v[188:191]
    s_lshr_b32 s88, s49, 2
    s_lshl_b32 s86, s48, 3
    s_add_u32 s88, s88, s86
    s_and_b32 s89, s49, 3
    v_lshrrev_b32 v12, 3, v0
    v_and_b32 v13, 6, v12
    v_and_b32 v14, 7, v0
    v_xor_b32 v13, v13, v14
    ds_write_b128 v227, v[184:187]
    ds_write_b128 v228, v[188:191] offset:1024
    v_lshlrev_b32 v6, 4, v13
    v_lshl_add_u32 v200, v12, 10, v6
    s_lshl_b32 s90, s50, 17
    s_lshl_b32 s86, s89, 8
    s_add_u32 s90, s90, s86
    s_lshl_b32 s91, s50, 14
    s_add_u32 s96, s91, 65536
    s_cmp_eq_u32 s50, 3
    s_cselect_b32 s91, 131072, s91
    s_waitcnt lgkmcnt(0)
    ds_read_b32 v192, v229 offset:0
    ds_read_b32 v193, v229 offset:256
    ds_read_b32 v194, v229 offset:512
    ds_read_b32 v195, v229 offset:768
    ds_read_b32 v196, v229 offset:1024
    s_mov_b32 s51, 0
    s_waitcnt vmcnt(13)
    v_cmp_ne_u32 vcc, s4, v230
    s_nop 0
    s_cbranch_vccz Le8
Lk7:
    buffer_load_dword v230, off, s[40:43], s95 sc1
    s_waitcnt vmcnt(0)
    v_cmp_ne_u32 vcc, s4, v230
    s_add_u32 s51, s51, 1
    s_cbranch_vccz Le8
    s_cmp_lt_u32 s51, 65536
    s_cbranch_scc1 Lk7
Le8:
    s_waitcnt lgkmcnt(4)
    buffer_atomic_add_f32 v192, v215, s[40:43], s94 offen offset:0 sc1
    s_waitcnt lgkmcnt(3)
    buffer_atomic_add_f32 v193, v215, s[40:43], s94 offen offset:256 sc1
    s_waitcnt lgkmcnt(2)
    buffer_atomic_add_f32 v194, v215, s[40:43], s94 offen offset:512 sc1
    s_waitcnt lgkmcnt(1)
    buffer_atomic_add_f32 v195, v215, s[40:43], s94 offen offset:768 sc1
    s_mov_b64 exec, 0xffff
    s_waitcnt lgkmcnt(0)
    buffer_atomic_add_f32 v196, v215, s[40:43], s94 offen offset:1024 sc1
    s_mov_b64 exec, -1
    s_waitcnt vmcnt(5)
    s_barrier
    v_add_u32 v224, 49152, v224
    ds_read_b64_tr_b16 v[24:25], v224 offset:0
    ds_read_b64_tr_b16 v[26:27], v224 offset:512
    ds_read_b64_tr_b16 v[28:29], v224 offset:4096
    ds_read_b64_tr_b16 v[30:31], v224 offset:4608
    s_waitcnt lgkmcnt(2)
    v_mfma_f32_16x16x32_bf16 v[96:99], v[24:27], a[0:3], 0
    ds_read_b64_tr_b16 v[32:33], v224 offset:8192
    v_mfma_f32_16x16x32_bf16 v[100:103], v[24:27], a[4:7], 0
    ds_read_b64_tr_b16 v[34:35], v224 offset:8704
    s_add_u32 m0, s91, 0
    v_mfma_f32_16x16x32_bf16 v[104:107], v[24:27], a[8:11], 0
    s_add_u32 s60, s90, 0
    buffer_load_dwordx4 v200, s[16:19], s60 offen lds
    v_mfma_f32_16x16x32_bf16 v[108:111], v[24:27], a[12:15], 0
    v_lshrrev_b32 v12, 2, v2
    v_lshl_add_u32 v12, v3, 2, v12
    v_mfma_f32_16x16x32_bf16 v[112:115], v[24:27], v[40:43], 0
    v_and_b32 v13, 6, v12
    v_bfe_u32 v14, v0, 1, 1
    s_waitcnt lgkmcnt(2)
    v_mfma_f32_16x16x32_bf16 v[96:99], v[28:31], a[16:19], v[96:99]
    ds_read_b64_tr_b16 v[36:37], v224 offset:12288
    v_mfma_f32_16x16x32_bf16 v[100:103], v[28:31], a[20:23], v[100:103]
    ds_read_b64_tr_b16 v[38:39], v224 offset:12800
    s_add_u32 m0, s91, 8192
    v_mfma_f32_16x16x32_bf16 v[104:107], v[28:31], a[24:27], v[104:107]
    s_add_u32 s60, s90, 128
    buffer_load_dwordx4 v200, s[16:19], s60 offen lds
    v_mfma_f32_16x16x32_bf16 v[108:111], v[28:31], a[28:31], v[108:111]
    v_xor_b32 v13, v13, v14
    v_and_b32 v14, 1, v0
    v_mfma_f32_16x16x32_bf16 v[112:115], v[28:31], v[40:43], v[112:115]
    v_lshlrev_b32 v14, 3, v14
    v_lshl_add_u32 v14, v12, 7, v14
    s_waitcnt lgkmcnt(2)
    v_mfma_f32_16x16x32_bf16 v[96:99], v[32:35], a[32:35], v[96:99]
    ds_read_b64_tr_b16 v[24:25], v224 offset:16384
    v_mfma_f32_16x16x32_bf16 v[100:103], v[32:35], a[36:39], v[100:103]
    ds_read_b64_tr_b16 v[26:27], v224 offset:16896
    s_add_u32 m0, s91, 1024
    v_mfma_f32_16x16x32_bf16 v[104:107], v[32:35], a[40:43], v[104:107]
    s_add_u32 s60, s90, 8192
    buffer_load_dwordx4 v200, s[16:19], s60 offen lds
    v_mfma_f32_16x16x32_bf16 v[108:111], v[32:35], a[44:47], v[108:111]
    v_lshl_add_u32 v8, v13, 4, v14
    v_xor_b32 v9, 32, v8
    v_mfma_f32_16x16x32_bf16 v[112:115], v[32:35], v[40:43], v[112:115]
    v_xor_b32 v10, 64, v8
    v_xor_b32 v11, 96, v8
    s_waitcnt lgkmcnt(2)
    v_mfma_f32_16x16x32_bf16 v[96:99], v[36:39], a[48:51], v[96:99]
    ds_read_b64_tr_b16 v[28:29], v224 offset:20480
    v_mfma_f32_16x16x32_bf16 v[100:103], v[36:39], a[52:55], v[100:103]
    ds_read_b64_tr_b16 v[30:31], v224 offset:20992
    s_add_u32 m0, s91, 9216
    v_mfma_f32_16x16x32_bf16 v[104:107], v[36:39], a[56:59], v[104:107]
    s_add_u32 s60, s90, 8320
    buffer_load_dwordx4 v200, s[16:19], s60 offen lds
    v_mfma_f32_16x16x32_bf16 v[108:111], v[36:39], a[60:63], v[108:111]
    s_and_b32 s86, s50, 1
    s_lshl_b32 s86, s86, 6
    v_mfma_f32_16x16x32_bf16 v[112:115], v[36:39], v[40:43], v[112:115]
    s_add_u32 s87, s50, 0
    s_and_b32 s87, s87, 2
    s_waitcnt lgkmcnt(2)
    v_mfma_f32_16x16x32_bf16 v[96:99], v[24:27], a[64:67], v[96:99]
    ds_read_b64_tr_b16 v[32:33], v224 offset:24576
    v_mfma_f32_16x16x32_bf16 v[100:103], v[24:27], a[68:71], v[100:103]
    ds_read_b64_tr_b16 v[34:35], v224 offset:25088
    s_add_u32 m0, s91, 2048
    v_mfma_f32_16x16x32_bf16 v[104:107], v[24:27], a[72:75], v[104:107]
    s_add_u32 s60, s90, 16384
    buffer_load_dwordx4 v200, s[16:19], s60 offen lds
    v_mfma_f32_16x16x32_bf16 v[108:111], v[24:27], a[76:79], v[108:111]
    s_lshl_b32 s87, s87, 12
    s_add_u32 s87, s87, s91
    v_mfma_f32_16x16x32_bf16 v[112:115], v[24:27], v[40:43], v[112:115]
    v_xor_b32 v204, s86, v8
    v_add_u32 v204, s87, v204
    s_waitcnt lgkmcnt(2)
    v_mfma_f32_16x16x32_bf16 v[96:99], v[28:31], a[80:83], v[96:99]
    ds_read_b64_tr_b16 v[36:37], v224 offset:28672
    v_mfma_f32_16x16x32_bf16 v[100:103], v[28:31], a[84:87], v[100:103]
    ds_read_b64_tr_b16 v[38:39], v224 offset:29184
    s_add_u32 m0, s91, 10240
    v_mfma_f32_16x16x32_bf16 v[104:107], v[28:31], a[88:91], v[104:107]
    s_add_u32 s60, s90, 16512
    buffer_load_dwordx4 v200, s[16:19], s60 offen lds
    v_mfma_f32_16x16x32_bf16 v[108:111], v[28:31], a[92:95], v[108:111]
    v_xor_b32 v205, s86, v9
    v_add_u32 v205, s87, v205
    v_mfma_f32_16x16x32_bf16 v[112:115], v[28:31], v[40:43], v[112:115]
    s_add_u32 s87, s50, 1
    s_and_b32 s87, s87, 2
    s_waitcnt lgkmcnt(2)
    v_mfma_f32_16x16x32_bf16 v[96:99], v[32:35], a[96:99], v[96:99]
    ds_read_b64_tr_b16 v[24:25], v224 offset:32768
    v_mfma_f32_16x16x32_bf16 v[100:103], v[32:35], a[100:103], v[100:103]
    ds_read_b64_tr_b16 v[26:27], v224 offset:33280
    s_add_u32 m0, s91, 3072
    v_mfma_f32_16x16x32_bf16 v[104:107], v[32:35], a[104:107], v[104:107]
    s_add_u32 s60, s90, 24576
    buffer_load_dwordx4 v200, s[16:19], s60 offen lds
    v_mfma_f32_16x16x32_bf16 v[108:111], v[32:35], a[108:111], v[108:111]
    s_lshl_b32 s87, s87, 12
    s_add_u32 s87, s87, s91
    v_mfma_f32_16x16x32_bf16 v[112:115], v[32:35], v[40:43], v[112:115]
    v_xor_b32 v206, s86, v10
    v_add_u32 v206, s87, v206
    s_waitcnt lgkmcnt(2)
    v_mfma_f32_16x16x32_bf16 v[96:99], v[36:39], a[112:115], v[96:99]
    ds_read_b64_tr_b16 v[28:29], v224 offset:36864
    v_mfma_f32_16x16x32_bf16 v[100:103], v[36:39], a[116:119], v[100:103]
    ds_read_b64_tr_b16 v[30:31], v224 offset:37376
    s_add_u32 m0, s91, 11264
    v_mfma_f32_16x16x32_bf16 v[104:107], v[36:39], a[120:123], v[104:107]
    s_add_u32 s60, s90, 24704
    buffer_load_dwordx4 v200, s[16:19], s60 offen lds
    v_mfma_f32_16x16x32_bf16 v[108:111], v[36:39], a[124:127], v[108:111]
    v_xor_b32 v207, s86, v11
    v_add_u32 v207, s87, v207
    v_mfma_f32_16x16x32_bf16 v[112:115], v[36:39], v[40:43], v[112:115]
    s_add_u32 s87, s50, 2
    s_and_b32 s87, s87, 2
    s_waitcnt lgkmcnt(2)
    v_mfma_f32_16x16x32_bf16 v[96:99], v[24:27], a[128:131], v[96:99]
    ds_read_b64_tr_b16 v[32:33], v224 offset:40960
    v_mfma_f32_16x16x32_bf16 v[100:103], v[24:27], a[132:135], v[100:103]
    ds_read_b64_tr_b16 v[34:35], v224 offset:41472
    s_add_u32 m0, s91, 4096
    v_mfma_f32_16x16x32_bf16 v[104:107], v[24:27], a[136:139], v[104:107]
    s_add_u32 s60, s90, 32768
    buffer_load_dwordx4 v200, s[16:19], s60 offen lds
    v_mfma_f32_16x16x32_bf16 v[108:111], v[24:27], a[140:143], v[108:111]
    s_lshl_b32 s87, s87, 12
    s_add_u32 s87, s87, s91
    v_mfma_f32_16x16x32_bf16 v[112:115], v[24:27], v[40:43], v[112:115]
    v_xor_b32 v208, s86, v8
    v_add_u32 v208, s87, v208
    s_waitcnt lgkmcnt(2)
    v_mfma_f32_16x16x32_bf16 v[96:99], v[28:31], a[144:147], v[96:99]
    ds_read_b64_tr_b16 v[36:37], v224 offset:45056
    v_mfma_f32_16x16x32_bf16 v[100:103], v[28:31], a[148:151], v[100:103]
    ds_read_b64_tr_b16 v[38:39], v224 offset:45568
    s_add_u32 m0, s91, 12288
    v_mfma_f32_16x16x32_bf16 v[104:107], v[28:31], a[152:155], v[104:107]
    s_add_u32 s60, s90, 32896
    buffer_load_dwordx4 v200, s[16:19], s60 offen lds
    v_mfma_f32_16x16x32_bf16 v[108:111], v[28:31], a[156:159], v[108:111]
    v_xor_b32 v209, s86, v9
    v_add_u32 v209, s87, v209
    v_mfma_f32_16x16x32_bf16 v[112:115], v[28:31], v[40:43], v[112:115]
    s_add_u32 s87, s50, 3
    s_and_b32 s87, s87, 2
    s_waitcnt lgkmcnt(2)
    v_mfma_f32_16x16x32_bf16 v[96:99], v[32:35], a[160:163], v[96:99]
    v_add_u32 v224, 49152, v224
    ds_read_b64_tr_b16 v[24:25], v224 offset:0
    v_mfma_f32_16x16x32_bf16 v[100:103], v[32:35], a[164:167], v[100:103]
    ds_read_b64_tr_b16 v[26:27], v224 offset:512
    s_add_u32 m0, s91, 5120
    v_mfma_f32_16x16x32_bf16 v[104:107], v[32:35], a[168:171], v[104:107]
    s_add_u32 s60, s90, 40960
    buffer_load_dwordx4 v200, s[16:19], s60 offen lds
    v_mfma_f32_16x16x32_bf16 v[108:111], v[32:35], a[172:175], v[108:111]
    s_lshl_b32 s87, s87, 12
    s_add_u32 s87, s87, s91
    v_mfma_f32_16x16x32_bf16 v[112:115], v[32:35], v[40:43], v[112:115]
    v_xor_b32 v210, s86, v10
    v_add_u32 v210, s87, v210
    s_waitcnt lgkmcnt(2)
    v_mfma_f32_16x16x32_bf16 v[96:99], v[36:39], a[176:179], v[96:99]
    ds_read_b64_tr_b16 v[28:29], v224 offset:4096
    v_mfma_f32_16x16x32_bf16 v[100:103], v[36:39], a[180:183], v[100:103]
    ds_read_b64_tr_b16 v[30:31], v224 offset:4608
    s_add_u32 m0, s91, 13312
    v_mfma_f32_16x16x32_bf16 v[104:107], v[36:39], a[184:187], v[104:107]
    s_add_u32 s60, s90, 41088
    buffer_load_dwordx4 v200, s[16:19], s60 offen lds
    v_mfma_f32_16x16x32_bf16 v[108:111], v[36:39], a[188:191], v[108:111]
    v_xor_b32 v211, s86, v11
    v_add_u32 v211, s87, v211
    v_mfma_f32_16x16x32_bf16 v[112:115], v[36:39], v[40:43], v[112:115]
    s_lshl_b32 s87, s62, 6
    s_add_u32 s87, s87, s93
    s_waitcnt lgkmcnt(2)
    v_mfma_f32_16x16x32_bf16 v[96:99], v[24:27], a[192:195], v[96:99]
    ds_read_b64_tr_b16 v[32:33], v224 offset:8192
    v_mfma_f32_16x16x32_bf16 v[100:103], v[24:27], a[196:199], v[100:103]
    ds_read_b64_tr_b16 v[34:35], v224 offset:8704
    s_add_u32 m0, s91, 6144
    v_mfma_f32_16x16x32_bf16 v[104:107], v[24:27], a[200:203], v[104:107]
    s_add_u32 s60, s90, 49152
    v_mfma_f32_16x16x32_bf16 v[108:111], v[24:27], a[204:207], v[108:111]
    buffer_load_dwordx4 v200, s[16:19], s60 offen lds
    s_lshl_b32 s87, s87, 10
    v_mfma_f32_16x16x32_bf16 v[112:115], v[24:27], v[40:43], v[112:115]
    s_add_u32 s64, s87, 1048576
    s_add_u32 s65, s64, 32768
    s_waitcnt lgkmcnt(2)
    v_mfma_f32_16x16x32_bf16 v[96:99], v[28:31], a[208:211], v[96:99]
    ds_read_b64_tr_b16 v[36:37], v224 offset:12288
    v_mfma_f32_16x16x32_bf16 v[100:103], v[28:31], a[212:215], v[100:103]
    ds_read_b64_tr_b16 v[38:39], v224 offset:12800
    v_mfma_f32_16x16x32_bf16 v[104:107], v[28:31], a[216:219], v[104:107]
    s_add_u32 m0, s91, 14336
    v_mfma_f32_16x16x32_bf16 v[108:111], v[28:31], a[220:223], v[108:111]
    s_add_u32 s60, s90, 49280
    v_mfma_f32_16x16x32_bf16 v[112:115], v[28:31], v[40:43], v[112:115]
    buffer_load_dwordx4 v200, s[16:19], s60 offen lds
    s_waitcnt lgkmcnt(2)
    v_mfma_f32_16x16x32_bf16 v[96:99], v[32:35], a[224:227], v[96:99]
    v_mfma_f32_16x16x32_bf16 v[100:103], v[32:35], a[228:231], v[100:103]
    s_add_u32 m0, s91, 7168
    v_mfma_f32_16x16x32_bf16 v[104:107], v[32:35], a[232:235], v[104:107]
    v_mfma_f32_16x16x32_bf16 v[108:111], v[32:35], a[236:239], v[108:111]
    s_add_u32 s60, s90, 57344
    v_mfma_f32_16x16x32_bf16 v[112:115], v[32:35], v[40:43], v[112:115]
    buffer_load_dwordx4 v200, s[16:19], s60 offen lds
    s_waitcnt lgkmcnt(0)
    v_mfma_f32_16x16x32_bf16 v[96:99], v[36:39], a[240:243], v[96:99]
    v_mfma_f32_16x16x32_bf16 v[100:103], v[36:39], a[244:247], v[100:103]
    s_add_u32 m0, s91, 15360
    v_mfma_f32_16x16x32_bf16 v[104:107], v[36:39], a[248:251], v[104:107]
    v_mfma_f32_16x16x32_bf16 v[108:111], v[36:39], a[252:255], v[108:111]
    s_add_u32 s60, s90, 57472
    v_mfma_f32_16x16x32_bf16 v[112:115], v[36:39], v[40:43], v[112:115]
    buffer_load_dwordx4 v200, s[16:19], s60 offen lds
    s_waitcnt vmcnt(16)
    s_barrier
    s_cmp_lg_u32 s50, 0
    s_cbranch_scc1 Lw9
    s_mov_b64 exec, 0xff
    v_mov_b32 v5, s4
    buffer_store_dword v5, v4, s[40:43], 0 offen sc1
    s_mov_b64 exec, -1
Lw9:
    s_nop 2
    v_pk_mul_f32 v[176:177], v[112:113], v[152:153] op_sel:[0,1] op_sel_hi:[1,1]
    v_pk_mul_f32 v[178:179], v[114:115], v[152:153] op_sel:[0,1] op_sel_hi:[1,1]
    v_pk_mul_f32 v[180:181], v[112:113], v[154:155] op_sel:[0,1] op_sel_hi:[1,1]
    v_pk_mul_f32 v[182:183], v[114:115], v[154:155] op_sel:[0,1] op_sel_hi:[1,1]
    v_pk_fma_f32 v[96:97], v[96:97], v[152:153], v[176:177] op_sel:[0,0,0] op_sel_hi:[1,0,1]
    v_pk_fma_f32 v[98:99], v[98:99], v[152:153], v[178:179] op_sel:[0,0,0] op_sel_hi:[1,0,1]
    v_pk_fma_f32 v[100:101], v[100:101], v[154:155], v[180:181] op_sel:[0,0,0] op_sel_hi:[1,0,1]
    v_pk_fma_f32 v[102:103], v[102:103], v[154:155], v[182:183] op_sel:[0,0,0] op_sel_hi:[1,0,1]
    v_pk_mul_f32 v[176:177], v[96:97], s[52:53]
    v_pk_mul_f32 v[178:179], v[98:99], s[52:53]
    v_pk_mul_f32 v[180:181], v[100:101], s[52:53]
    v_pk_mul_f32 v[182:183], v[102:103], s[52:53]
    v_max_f32 v96, 0, v96
    v_max_f32 v98, 0, v98
    v_max_f32 v100, 0, v100
    v_max_f32 v102, 0, v102
    v_max_f32 v97, 0, v97
    v_max_f32 v99, 0, v99
    v_max_f32 v101, 0, v101
    v_max_f32 v103, 0, v103
    v_min_f32 v176, 0, v176
    v_min_f32 v178, 0, v178
    v_min_f32 v180, 0, v180
    v_min_f32 v182, 0, v182
    v_min_f32 v177, 0, v177
    v_min_f32 v179, 0, v179
    v_min_f32 v181, 0, v181
    v_min_f32 v183, 0, v183
    v_exp_f32 v176, v176
    v_exp_f32 v178, v178
    v_exp_f32 v180, v180
    v_exp_f32 v182, v182
    v_exp_f32 v177, v177
    v_exp_f32 v179, v179
    v_exp_f32 v181, v181
    v_exp_f32 v183, v183
    v_pk_add_f32 v[96:97], v[96:97], s[54:55]
    v_pk_add_f32 v[98:99], v[98:99], s[54:55]
    v_pk_add_f32 v[100:101], v[100:101], s[54:55]
    v_pk_add_f32 v[102:103], v[102:103], s[54:55]
    v_pk_add_f32 v[96:97], v[96:97], v[176:177]
    v_pk_add_f32 v[98:99], v[98:99], v[178:179]
    v_pk_add_f32 v[100:101], v[100:101], v[180:181]
    v_pk_add_f32 v[102:103], v[102:103], v[182:183]
    v_cvt_pk_bf16_f32 v160, v96, v97
    v_cvt_pk_bf16_f32 v161, v98, v99
    v_cvt_pk_bf16_f32 v162, v100, v101
    v_cvt_pk_bf16_f32 v163, v102, v103
    buffer_store_dwordx4 v[160:163], v1, s[40:43], s64 offen sc1
    v_pk_mul_f32 v[176:177], v[112:113], v[156:157] op_sel:[0,1] op_sel_hi:[1,1]
    v_pk_mul_f32 v[178:179], v[114:115], v[156:157] op_sel:[0,1] op_sel_hi:[1,1]
    v_pk_mul_f32 v[180:181], v[112:113], v[158:159] op_sel:[0,1] op_sel_hi:[1,1]
    v_pk_mul_f32 v[182:183], v[114:115], v[158:159] op_sel:[0,1] op_sel_hi:[1,1]
    v_pk_fma_f32 v[104:105], v[104:105], v[156:157], v[176:177] op_sel:[0,0,0] op_sel_hi:[1,0,1]
    v_pk_fma_f32 v[106:107], v[106:107], v[156:157], v[178:179] op_sel:[0,0,0] op_sel_hi:[1,0,1]
    v_pk_fma_f32 v[108:109], v[108:109], v[158:159], v[180:181] op_sel:[0,0,0] op_sel_hi:[1,0,1]
    v_pk_fma_f32 v[110:111], v[110:111], v[158:159], v[182:183] op_sel:[0,0,0] op_sel_hi:[1,0,1]
    v_pk_mul_f32 v[176:177], v[104:105], s[52:53]
    v_pk_mul_f32 v[178:179], v[106:107], s[52:53]
    v_pk_mul_f32 v[180:181], v[108:109], s[52:53]
    v_pk_mul_f32 v[182:183], v[110:111], s[52:53]
    v_max_f32 v104, 0, v104
    v_max_f32 v106, 0, v106
    v_max_f32 v108, 0, v108
    v_max_f32 v110, 0, v110
    v_max_f32 v105, 0, v105
    v_max_f32 v107, 0, v107
    v_max_f32 v109, 0, v109
    v_max_f32 v111, 0, v111
    v_min_f32 v176, 0, v176
    v_min_f32 v178, 0, v178
    v_min_f32 v180, 0, v180
    v_min_f32 v182, 0, v182
    v_min_f32 v177, 0, v177
    v_min_f32 v179, 0, v179
    v_min_f32 v181, 0, v181
    v_min_f32 v183, 0, v183
    v_exp_f32 v176, v176
    v_exp_f32 v178, v178
    v_exp_f32 v180, v180
    v_exp_f32 v182, v182
    v_exp_f32 v177, v177
    v_exp_f32 v179, v179
    v_exp_f32 v181, v181
    v_exp_f32 v183, v183
    v_pk_add_f32 v[104:105], v[104:105], s[54:55]
    v_pk_add_f32 v[106:107], v[106:107], s[54:55]
    v_pk_add_f32 v[108:109], v[108:109], s[54:55]
    v_pk_add_f32 v[110:111], v[110:111], s[54:55]
    v_pk_add_f32 v[104:105], v[104:105], v[176:177]
    v_pk_add_f32 v[106:107], v[106:107], v[178:179]
    v_pk_add_f32 v[108:109], v[108:109], v[180:181]
    v_pk_add_f32 v[110:111], v[110:111], v[182:183]
    v_cvt_pk_bf16_f32 v164, v104, v105
    v_cvt_pk_bf16_f32 v165, v106, v107
    v_cvt_pk_bf16_f32 v166, v108, v109
    v_cvt_pk_bf16_f32 v167, v110, v111
    buffer_store_dwordx4 v[164:167], v1, s[40:43], s65 offen sc1
    s_waitcnt vmcnt(10)
    ds_read_b64_tr_b16 a[0:1], v204 offset:0
    s_add_u32 m0, s96, 0
    s_add_u32 s60, s90, 65536
    buffer_load_dwordx4 v200, s[16:19], s60 offen lds
    ds_read_b64_tr_b16 a[2:3], v204 offset:2048
    ds_read_b64_tr_b16 a[4:5], v205 offset:0
    ds_read_b64_tr_b16 a[6:7], v205 offset:2048
    ds_read_b64_tr_b16 a[8:9], v206 offset:0
    s_add_u32 m0, s96, 8192
    s_add_u32 s60, s90, 65664
    buffer_load_dwordx4 v200, s[16:19], s60 offen lds
    ds_read_b64_tr_b16 a[10:11], v206 offset:2048
    ds_read_b64_tr_b16 a[12:13], v207 offset:0
    ds_read_b64_tr_b16 a[14:15], v207 offset:2048
    ds_read_b64_tr_b16 a[16:17], v208 offset:0
    s_add_u32 m0, s96, 1024
    s_add_u32 s60, s90, 73728
    buffer_load_dwordx4 v200, s[16:19], s60 offen lds
    ds_read_b64_tr_b16 a[18:19], v208 offset:2048
    ds_read_b64_tr_b16 a[20:21], v209 offset:0
    ds_read_b64_tr_b16 a[22:23], v209 offset:2048
    ds_read_b64_tr_b16 a[24:25], v210 offset:0
    s_add_u32 m0, s96, 9216
    s_add_u32 s60, s90, 73856
    buffer_load_dwordx4 v200, s[16:19], s60 offen lds
    ds_read_b64_tr_b16 a[26:27], v210 offset:2048
    ds_read_b64_tr_b16 a[28:29], v211 offset:0
    ds_read_b64_tr_b16 a[30:31], v211 offset:2048
    s_waitcnt vmcnt(6)
    ds_read_b64_tr_b16 a[32:33], v204 offset:4096
    s_add_u32 m0, s96, 2048
    s_add_u32 s60, s90, 81920
    buffer_load_dwordx4 v200, s[16:19], s60 offen lds
    ds_read_b64_tr_b16 a[34:35], v204 offset:6144
    ds_read_b64_tr_b16 a[36:37], v205 offset:4096
    ds_read_b64_tr_b16 a[38:39], v205 offset:6144
    ds_read_b64_tr_b16 a[40:41], v206 offset:4096
    s_add_u32 m0, s96, 10240
    s_add_u32 s60, s90, 82048
    buffer_load_dwordx4 v200, s[16:19], s60 offen lds
    ds_read_b64_tr_b16 a[42:43], v206 offset:6144
    ds_read_b64_tr_b16 a[44:45], v207 offset:4096
    ds_read_b64_tr_b16 a[46:47], v207 offset:6144
    ds_read_b64_tr_b16 a[48:49], v208 offset:4096
    s_add_u32 m0, s96, 3072
    s_add_u32 s60, s90, 90112
    buffer_load_dwordx4 v200, s[16:19], s60 offen lds
    ds_read_b64_tr_b16 a[50:51], v208 offset:6144
    ds_read_b64_tr_b16 a[52:53], v209 offset:4096
    ds_read_b64_tr_b16 a[54:55], v209 offset:6144
    ds_read_b64_tr_b16 a[56:57], v210 offset:4096
    s_add_u32 m0, s96, 11264
    s_add_u32 s60, s90, 90240
    buffer_load_dwordx4 v200, s[16:19], s60 offen lds
    ds_read_b64_tr_b16 a[58:59], v210 offset:6144
    ds_read_b64_tr_b16 a[60:61], v211 offset:4096
    ds_read_b64_tr_b16 a[62:63], v211 offset:6144
    s_waitcnt vmcnt(8)
    s_barrier
    s_cmp_lg_u32 s50, 0
    s_cbranch_scc1 Lw10
    s_mov_b64 exec, 0x8000000
    v_mov_b32 v5, s4
    buffer_store_dword v5, v4, s[40:43], 0 offen sc1
    s_mov_b64 exec, -1
Lw10:
    s_add_u32 m0, s96, 4096
    s_add_u32 s60, s90, 98304
    buffer_load_dwordx4 v200, s[16:19], s60 offen lds
    s_add_u32 m0, s96, 12288
    s_add_u32 s60, s90, 98432
    buffer_load_dwordx4 v200, s[16:19], s60 offen lds
    s_add_u32 m0, s96, 5120
    s_add_u32 s60, s90, 106496
    buffer_load_dwordx4 v200, s[16:19], s60 offen lds
    s_add_u32 m0, s96, 13312
    s_add_u32 s60, s90, 106624
    buffer_load_dwordx4 v200, s[16:19], s60 offen lds
    s_add_u32 m0, s96, 6144
    s_add_u32 s60, s90, 114688
    buffer_load_dwordx4 v200, s[16:19], s60 offen lds
    s_add_u32 m0, s96, 14336
    s_add_u32 s60, s90, 114816
    buffer_load_dwordx4 v200, s[16:19], s60 offen lds
    s_add_u32 m0, s96, 7168
    s_add_u32 s60, s90, 122880
    buffer_load_dwordx4 v200, s[16:19], s60 offen lds
    s_add_u32 m0, s96, 15360
    s_add_u32 s60, s90, 123008
    buffer_load_dwordx4 v200, s[16:19], s60 offen lds
    s_lshl_b32 s86, s88, 15
    s_lshl_b32 s87, s89, 8
    s_add_u32 s86, s86, s87
    s_lshl_b32 s87, s50, 6
    s_add_u32 s60, s86, s87
    s_lshl_b32 s87, s50, 11
    s_add_u32 m0, s87, 147456
    v_lshrrev_b32 v12, 2, v0
    v_lshrrev_b32 v13, 3, v0
    v_xor_b32 v13, v13, v0
    v_and_b32 v13, 3, v13
    v_lshlrev_b32 v13, 4, v13
    v_lshl_add_u32 v12, v12, 10, v13
    buffer_load_dwordx4 v12, s[8:11], s60 offen lds
    s_add_u32 m0, s87, 148480
    s_add_u32 s60, s60, 16384
    buffer_load_dwordx4 v12, s[8:11], s60 offen lds
    v_lshrrev_b32 v13, 1, v2
    v_lshrrev_b32 v14, 1, v3
    v_xor_b32 v13, v13, v14
    v_and_b32 v13, 3, v13
    v_lshlrev_b32 v13, 4, v13
    v_lshl_add_u32 v13, v2, 6, v13
    v_and_b32 v14, 1, v3
    v_lshl_add_u32 v13, v14, 3, v13
    s_add_u32 s87, s87, 147456
    v_add_u32 v20, s87, v13
    v_xor_b32 v21, 32, v20
    s_lshl_b32 s86, s50, 3
    s_mul_i32 s92, s86, 1152
    s_add_u32 s92, s92, 40960
    s_add_u32 s93, s92, 4608
    s_lshl_b32 s94, s88, 5
    s_add_u32 s94, s94, s86
    s_lshl_b32 s94, s94, 10
    s_add_u32 s94, s94, 1048576
    s_add_u32 s95, s94, 4096
    v_and_b32 v12, 7, v0
    v_mul_u32_u24 v12, 1152, v12
    v_lshl_add_u32 v19, v3, 4, v12
    v_and_b32 v18, 31, v0
    v_lshlrev_b32 v18, 2, v18
    s_lshl_b32 s66, s48, 7
    s_add_u32 s66, s66, 37120
    s_lshl_b32 s83, s88, 6
    s_add_u32 s83, s83, 28672
    s_lshl_b32 s74, s89, 2
    s_add_u32 s74, s74, s50
    s_lshl_b32 s74, s74, 2
    s_add_u32 s74, s74, s83
    v_lshlrev_b32 v255, 2, v2
    s_and_b32 s67, s2, 7
    s_lshl_b32 s67, s67, 10
    s_add_u32 s67, s67, 0
    s_lshr_b32 s97, s88, 1
    s_lshl_b32 s97, s97, 7
    s_add_u32 s97, s97, 24576
    v_and_b32 v16, 7, v0
    v_lshlrev_b32 v16, 2, v16
    v_mov_b32 v124, s54
    v_mov_b32 v125, s54
    v_mov_b32 v126, s54
    v_mov_b32 v127, s54
    v_lshrrev_b32 v123, 3, v0
    v_mul_u32_u24 v123, 3584, v123
    v_add_u32 v123, v123, v6
    s_min_u32 s70, s101, 13
    s_lshl_b32 s70, s70, 7
    s_mul_i32 s71, s50, 28672
    s_add_u32 s70, s70, s71
    s_lshl_b32 s71, s50, 10
    s_mov_b32 s82, s70
    s_cmp_lt_u32 s101, 14
    s_cbranch_scc1 Lr11
    s_mov_b32 s20, s24
    s_mov_b32 s21, s25
    s_mov_b32 s22, 8388608
    s_lshl_b32 s86, s100, 1
    s_add_u32 s86, s86, s101
    s_sub_u32 s86, s86, 14
    s_lshl_b32 s86, s86, 2
    s_add_u32 s86, s86, s50
    s_mul_i32 s87, s86, 147
    s_lshr_b32 s87, s87, 12
    s_mul_i32 s87, s87, 420
    s_add_u32 s86, s86, s87
    s_lshl_b32 s86, s86, 12
    s_mov_b32 s70, s86
    s_mov_b32 s82, 0x40000000
    v_lshrrev_b32 v123, 4, v0
    v_lshlrev_b32 v123, 10, v123
    v_bfe_u32 v12, v0, 3, 1
    v_lshl_add_u32 v123, v12, 7, v123
    v_and_b32 v12, 7, v0
    v_lshl_add_u32 v123, v12, 4, v123
    v_add_u32 v123, 2304, v123
    s_sub_u32 s70, s70, 4096
    s_cmp_eq_u32 s86, 0
    s_cselect_b32 s70, 0x40000000, s70
Lr11:
    s_add_u32 s86, s50, 1
    s_and_b32 s86, s86, 3
    s_mul_i32 s86, s86, 12288
    s_add_u32 s86, s86, 114688
    v_add_u32 v119, s86, v1
    s_add_u32 s86, s50, 2
    s_and_b32 s86, s86, 3
    s_mul_i32 s86, s86, 12288
    s_add_u32 s86, s86, 118784
    v_add_u32 v120, s86, v1
    s_add_u32 s86, s50, 3
    s_and_b32 s86, s86, 3
    s_mul_i32 s86, s86, 12288
    s_add_u32 s86, s86, 122880
    v_add_u32 v121, s86, v1
    s_mul_i32 s86, s50, 12288
    s_add_u32 s86, s86, 114688
    v_add_u32 v118, s86, v1
    s_lshl_b32 s64, s88, 5
    s_lshl_b32 s87, s89, 2
    s_add_u32 s64, s64, s87
    s_add_u32 s64, s64, s50
    s_lshl_b32 s64, s64, 10
    s_add_u32 s64, s64, 1048576
    s_add_u32 s65, s64, 16384
    s_lshl_b32 s61, s88, 12
    s_lshl_b32 s86, s89, 8
    s_add_u32 s61, s61, s86
    s_lshr_b32 s86, s50, 1
    s_lshl_b32 s86, s86, 10
    s_add_u32 s61, s61, s86
    s_and_b32 s86, s50, 1
    s_lshl_b32 s86, s86, 3
    s_add_u32 s61, s61, s86
    s_add_u32 s61, s61, 786432
    v_lshlrev_b32 v122, 4, v2
    v_lshl_add_u32 v122, v3, 11, v122
    s_sub_u32 s86, s96, s91
    v_add_u32 v204, s86, v204
    v_add_u32 v205, s86, v205
    v_add_u32 v206, s86, v206
    v_add_u32 v207, s86, v207
    v_add_u32 v208, s86, v208
    v_add_u32 v209, s86, v209
    v_add_u32 v210, s86, v210
    v_add_u32 v211, s86, v211
    s_waitcnt vmcnt(10)
    ds_read_b64_tr_b16 a[64:65], v204 offset:0
    ds_read_b64_tr_b16 a[66:67], v204 offset:2048
    ds_read_b64_tr_b16 a[68:69], v205 offset:0
    ds_read_b64_tr_b16 a[70:71], v205 offset:2048
    ds_read_b64_tr_b16 a[72:73], v206 offset:0
    ds_read_b64_tr_b16 a[74:75], v206 offset:2048
    ds_read_b64_tr_b16 a[76:77], v207 offset:0
    ds_read_b64_tr_b16 a[78:79], v207 offset:2048
    ds_read_b64_tr_b16 a[80:81], v208 offset:0
    ds_read_b64_tr_b16 a[82:83], v208 offset:2048
    ds_read_b64_tr_b16 a[84:85], v209 offset:0
    ds_read_b64_tr_b16 a[86:87], v209 offset:2048
    ds_read_b64_tr_b16 a[88:89], v210 offset:0
    ds_read_b64_tr_b16 a[90:91], v210 offset:2048
    ds_read_b64_tr_b16 a[92:93], v211 offset:0
    ds_read_b64_tr_b16 a[94:95], v211 offset:2048
    s_waitcnt vmcnt(2)
    ds_read_b64_tr_b16 a[96:97], v204 offset:4096
    ds_read_b64_tr_b16 a[98:99], v204 offset:6144
    ds_read_b64_tr_b16 a[100:101], v205 offset:4096
    ds_read_b64_tr_b16 a[102:103], v205 offset:6144
    ds_read_b64_tr_b16 a[104:105], v206 offset:4096
    ds_read_b64_tr_b16 a[106:107], v206 offset:6144
    ds_read_b64_tr_b16 a[108:109], v207 offset:4096
    ds_read_b64_tr_b16 a[110:111], v207 offset:6144
    ds_read_b64_tr_b16 a[112:113], v208 offset:4096
    ds_read_b64_tr_b16 a[114:115], v208 offset:6144
    ds_read_b64_tr_b16 a[116:117], v209 offset:4096
    ds_read_b64_tr_b16 a[118:119], v209 offset:6144
    ds_read_b64_tr_b16 a[120:121], v210 offset:4096
    ds_read_b64_tr_b16 a[122:123], v210 offset:6144
    ds_read_b64_tr_b16 a[124:125], v211 offset:4096
    ds_read_b64_tr_b16 a[126:127], v211 offset:6144
    s_waitcnt vmcnt(0)
    ds_read_b64 v[244:245], v20 offset:0
    ds_read_b64 v[246:247], v21 offset:0
    ds_read_b64 v[248:249], v20 offset:1024
    ds_read_b64 v[250:251], v21 offset:1024
    s_cmp_lg_u32 s50, 0
    s_cbranch_scc1 Lw12
    buffer_load_dwordx4 v[12:15], v1, s[40:43], s67 offen sc1
    buffer_load_dword v17, v16, s[40:43], s97 offen sc1
    s_mov_b32 s51, 0
    s_waitcnt vmcnt(1)
    v_xor_b32 v12, s4, v12
    v_xor_b32 v13, s4, v13
    v_xor_b32 v14, s4, v14
    v_xor_b32 v15, s4, v15
    s_waitcnt vmcnt(0)
    v_xor_b32 v17, s4, v17
    v_or3_b32 v12, v12, v13, v14
    v_or3_b32 v12, v12, v15, v17
    v_cmp_ne_u32 vcc, 0, v12
    s_nop 0
    s_cbranch_vccz Le14
Lk13:
    buffer_load_dwordx4 v[12:15], v1, s[40:43], s67 offen sc1
    buffer_load_dword v17, v16, s[40:43], s97 offen sc1
    s_waitcnt vmcnt(0)
    v_xor_b32 v12, s4, v12
    v_xor_b32 v13, s4, v13
    v_xor_b32 v14, s4, v14
    v_xor_b32 v15, s4, v15
    v_xor_b32 v17, s4, v17
    v_or3_b32 v12, v12, v13, v14
    v_or3_b32 v12, v12, v15, v17
    v_cmp_ne_u32 vcc, 0, v12
    s_add_u32 s51, s51, 1
    s_cbranch_vccz Le14
    s_cmp_lt_u32 s51, 65536
    s_cbranch_scc1 Lk13
Le14:
Lw12:
    s_waitcnt lgkmcnt(0)
    s_barrier
    buffer_load_dwordx4 v[64:67], v19, s[40:43], s92 offen offset:1024 sc1
    buffer_load_dword v252, v18, s[40:43], s66 offen sc1
    buffer_load_dwordx4 v[16:19], v1, s[40:43], s92 offen offset:0 sc1
    buffer_load_dwordx4 v[86:89], v1, s[40:43], s94 offen offset:0 sc1
    buffer_load_dwordx4 v[20:23], v1, s[40:43], s92 offen offset:1152 sc1
    buffer_load_dwordx4 v[90:93], v1, s[40:43], s94 offen offset:1024 sc1
    buffer_load_dwordx4 v[24:27], v1, s[40:43], s92 offen offset:2304 sc1
    buffer_load_dwordx4 v[94:97], v1, s[40:43], s94 offen offset:2048 sc1
    buffer_load_dwordx4 v[28:31], v1, s[40:43], s92 offen offset:3456 sc1
    buffer_load_dwordx4 v[98:101], v1, s[40:43], s94 offen offset:3072 sc1
    buffer_load_dwordx4 v[32:35], v1, s[40:43], s93 offen offset:0 sc1
    buffer_load_dwordx4 v[102:105], v1, s[40:43], s95 offen offset:0 sc1
    buffer_load_dwordx4 v[36:39], v1, s[40:43], s93 offen offset:1152 sc1
    buffer_load_dwordx4 v[106:109], v1, s[40:43], s95 offen offset:1024 sc1
    buffer_load_dwordx4 v[40:43], v1, s[40:43], s93 offen offset:2304 sc1
    buffer_load_dwordx4 v[110:113], v1, s[40:43], s95 offen offset:2048 sc1
    buffer_load_dwordx4 v[44:47], v1, s[40:43], s93 offen offset:3456 sc1
    buffer_load_dwordx4 v[114:117], v1, s[40:43], s95 offen offset:3072 sc1
    s_waitcnt vmcnt(17)
    v_cvt_pk_bf16_f32 v68, v64, v65
    v_cvt_pk_bf16_f32 v69, v66, v67
    s_waitcnt vmcnt(16)
    v_cmp_ne_u32 vcc, s7, v252
    v_mov_b32_dpp v70, v68 row_newbcast:0 row_mask:0xf bank_mask:0xf
    v_mov_b32_dpp v71, v69 row_newbcast:0 row_mask:0xf bank_mask:0xf
    v_mov_b32_dpp v72, v68 row_newbcast:1 row_mask:0xf bank_mask:0xf
    v_mov_b32_dpp v73, v69 row_newbcast:1 row_mask:0xf bank_mask:0xf
    v_mov_b32_dpp v74, v68 row_newbcast:2 row_mask:0xf bank_mask:0xf
    v_mov_b32_dpp v75, v69 row_newbcast:2 row_mask:0xf bank_mask:0xf
    v_mov_b32_dpp v76, v68 row_newbcast:3 row_mask:0xf bank_mask:0xf
    v_mov_b32_dpp v77, v69 row_newbcast:3 row_mask:0xf bank_mask:0xf
    v_mov_b32_dpp v78, v68 row_newbcast:4 row_mask:0xf bank_mask:0xf
    v_mov_b32_dpp v79, v69 row_newbcast:4 row_mask:0xf bank_mask:0xf
    v_mov_b32_dpp v80, v68 row_newbcast:5 row_mask:0xf bank_mask:0xf
    v_mov_b32_dpp v81, v69 row_newbcast:5 row_mask:0xf bank_mask:0xf
    v_mov_b32_dpp v82, v68 row_newbcast:6 row_mask:0xf bank_mask:0xf
    v_mov_b32_dpp v83, v69 row_newbcast:6 row_mask:0xf bank_mask:0xf
    v_mov_b32_dpp v84, v68 row_newbcast:7 row_mask:0xf bank_mask:0xf
    v_mov_b32_dpp v85, v69 row_newbcast:7 row_mask:0xf bank_mask:0xf
    s_cmp_eq_u64 vcc, 0
    s_cselect_b32 s6, 1, 0
    s_waitcnt vmcnt(15)
    v_cvt_pk_bf16_f32 v48, v16, v17
    v_cvt_pk_bf16_f32 v49, v18, v19
    s_waitcnt vmcnt(14)
    v_mfma_f32_16x16x16_bf16 v[216:219], v[70:71], v[86:87], v[124:127]
    v_mfma_f32_16x16x16_bf16 v[224:227], v[70:71], v[88:89], v[124:127]
    s_waitcnt vmcnt(13)
    v_cvt_pk_bf16_f32 v50, v20, v21
    s_waitcnt vmcnt(12)
    v_mfma_f32_16x16x16_bf16 v[232:235], v[72:73], v[90:91], v[124:127]
    v_mfma_f32_16x16x16_bf16 v[240:243], v[72:73], v[92:93], v[124:127]
    v_cvt_pk_bf16_f32 v51, v22, v23
    v_mfma_f32_16x16x16_bf16 v[212:215], v[48:49], v[86:87], 0
    v_mfma_f32_16x16x16_bf16 v[220:223], v[48:49], v[88:89], 0
    v_mfma_f32_16x16x16_bf16 v[228:231], v[50:51], v[90:91], 0
    v_mfma_f32_16x16x16_bf16 v[236:239], v[50:51], v[92:93], 0
    v_rcp_f32 v216, v216
    v_rcp_f32 v224, v224
    v_rcp_f32 v232, v232
    v_rcp_f32 v240, v240
    s_nop 0
    v_mul_f32 v212, v212, v216
    v_mul_f32 v213, v213, v216
    v_mul_f32 v214, v214, v216
    v_mul_f32 v215, v215, v216
    v_cvt_pk_bf16_f32 v192, v212, v213
    v_cvt_pk_bf16_f32 v193, v214, v215
    v_mul_f32 v220, v220, v224
    v_mul_f32 v221, v221, v224
    v_mul_f32 v222, v222, v224
    v_mul_f32 v223, v223, v224
    v_cvt_pk_bf16_f32 v196, v220, v221
    v_cvt_pk_bf16_f32 v197, v222, v223
    v_mul_f32 v228, v228, v232
    v_mul_f32 v229, v229, v232
    v_mul_f32 v230, v230, v232
    v_mul_f32 v231, v231, v232
    v_cvt_pk_bf16_f32 v194, v228, v229
    v_cvt_pk_bf16_f32 v195, v230, v231
    v_mul_f32 v236, v236, v240
    v_mul_f32 v237, v237, v240
    v_mul_f32 v238, v238, v240
    v_mul_f32 v239, v239, v240
    v_cvt_pk_bf16_f32 v198, v236, v237
    v_cvt_pk_bf16_f32 v199, v238, v239
    s_waitcnt vmcnt(10)
    v_mfma_f32_16x16x16_bf16 v[216:219], v[74:75], v[94:95], v[124:127]
    v_cvt_pk_bf16_f32 v52, v24, v25
    v_mfma_f32_16x16x16_bf16 v[224:227], v[74:75], v[96:97], v[124:127]
    v_cvt_pk_bf16_f32 v53, v26, v27
    s_waitcnt vmcnt(8)
    v_mfma_f32_16x16x16_bf16 v[232:235], v[76:77], v[98:99], v[124:127]
    v_cvt_pk_bf16_f32 v54, v28, v29
    v_mfma_f32_16x16x16_bf16 v[240:243], v[76:77], v[100:101], v[124:127]
    v_cvt_pk_bf16_f32 v55, v30, v31
    v_mfma_f32_16x16x16_bf16 v[212:215], v[52:53], v[94:95], 0
    s_add_u32 m0, s71, 0
    v_mfma_f32_16x16x16_bf16 v[220:223], v[52:53], v[96:97], 0
    s_add_u32 s60, s70, 1792
    buffer_load_dwordx4 v123, s[20:23], s60 offen lds
    v_mfma_f32_16x16x16_bf16 v[228:231], v[54:55], v[98:99], 0
    s_add_u32 m0, s71, 4096
    v_mfma_f32_16x16x16_bf16 v[236:239], v[54:55], v[100:101], 0
    s_add_u32 s60, s70, 116480
    buffer_load_dwordx4 v123, s[20:23], s60 offen lds
    v_mfma_f32_16x16x32_bf16 v[128:131], a[0:3], v[192:195], 0
    v_mfma_f32_16x16x32_bf16 v[136:139], a[0:3], v[196:199], 0
    v_rcp_f32 v216, v216
    v_rcp_f32 v224, v224
    v_mfma_f32_16x16x32_bf16 v[132:135], a[4:7], v[192:195], 0
    v_rcp_f32 v232, v232
    v_rcp_f32 v240, v240
    s_add_u32 m0, s71, 8192
    v_mfma_f32_16x16x32_bf16 v[140:143], a[4:7], v[196:199], 0
    s_add_u32 s60, s70, 231168
    v_mfma_f32_16x16x32_bf16 v[144:147], a[8:11], v[192:195], 0
    buffer_load_dwordx4 v123, s[20:23], s60 offen lds
    v_mul_f32 v212, v212, v216
    v_mul_f32 v213, v213, v216
    v_mfma_f32_16x16x32_bf16 v[152:155], a[8:11], v[196:199], 0
    v_mul_f32 v214, v214, v216
    v_mul_f32 v215, v215, v216
    v_cvt_pk_bf16_f32 v200, v212, v213
    v_mfma_f32_16x16x32_bf16 v[148:151], a[12:15], v[192:195], 0
    v_cvt_pk_bf16_f32 v201, v214, v215
    v_mul_f32 v220, v220, v224
    v_mul_f32 v221, v221, v224
    v_mfma_f32_16x16x32_bf16 v[156:159], a[12:15], v[196:199], 0
    v_mul_f32 v222, v222, v224
    v_mul_f32 v223, v223, v224
    s_add_u32 m0, s71, 12288
    v_mfma_f32_16x16x32_bf16 v[160:163], a[16:19], v[192:195], 0
    s_add_u32 s60, s70, 345856
    v_mfma_f32_16x16x32_bf16 v[168:171], a[16:19], v[196:199], 0
    buffer_load_dwordx4 v123, s[20:23], s60 offen lds
    v_cvt_pk_bf16_f32 v204, v220, v221
    v_mfma_f32_16x16x32_bf16 v[164:167], a[20:23], v[192:195], 0
    v_cvt_pk_bf16_f32 v205, v222, v223
    v_mul_f32 v228, v228, v232
    v_mul_f32 v229, v229, v232
    v_mfma_f32_16x16x32_bf16 v[172:175], a[20:23], v[196:199], 0
    v_mul_f32 v230, v230, v232
    v_mul_f32 v231, v231, v232
    v_cvt_pk_bf16_f32 v202, v228, v229
    v_mfma_f32_16x16x32_bf16 v[176:179], a[24:27], v[192:195], 0
    v_cvt_pk_bf16_f32 v203, v230, v231
    v_mul_f32 v236, v236, v240
    s_add_u32 m0, s71, 16384
    v_mfma_f32_16x16x32_bf16 v[184:187], a[24:27], v[196:199], 0
    s_add_u32 s60, s70, 460544
    v_mfma_f32_16x16x32_bf16 v[180:183], a[28:31], v[192:195], 0
    buffer_load_dwordx4 v123, s[20:23], s60 offen lds
    v_mul_f32 v237, v237, v240
    v_mul_f32 v238, v238, v240
    v_mfma_f32_16x16x32_bf16 v[188:191], a[28:31], v[196:199], 0
    v_mul_f32 v239, v239, v240
    v_cvt_pk_bf16_f32 v206, v236, v237
    v_cvt_pk_bf16_f32 v207, v238, v239
    s_waitcnt vmcnt(11)
    v_mfma_f32_16x16x16_bf16 v[216:219], v[78:79], v[102:103], v[124:127]
    v_cvt_pk_bf16_f32 v56, v32, v33
    v_mfma_f32_16x16x16_bf16 v[224:227], v[78:79], v[104:105], v[124:127]
    v_cvt_pk_bf16_f32 v57, v34, v35
    s_waitcnt vmcnt(9)
    v_mfma_f32_16x16x16_bf16 v[232:235], v[80:81], v[106:107], v[124:127]
    v_cvt_pk_bf16_f32 v58, v36, v37
    v_mfma_f32_16x16x16_bf16 v[240:243], v[80:81], v[108:109], v[124:127]
    v_cvt_pk_bf16_f32 v59, v38, v39
    v_mfma_f32_16x16x16_bf16 v[212:215], v[56:57], v[102:103], 0
    s_add_u32 m0, s71, 20480
    v_mfma_f32_16x16x16_bf16 v[220:223], v[56:57], v[104:105], 0
    s_add_u32 s60, s70, 575232
    buffer_load_dwordx4 v123, s[20:23], s60 offen lds
    v_mfma_f32_16x16x16_bf16 v[228:231], v[58:59], v[106:107], 0
    s_add_u32 m0, s71, 24576
    v_mfma_f32_16x16x16_bf16 v[236:239], v[58:59], v[108:109], 0
    s_add_u32 s60, s70, 689920
    buffer_load_dwordx4 v123, s[20:23], s60 offen lds
    v_mfma_f32_16x16x32_bf16 v[128:131], a[32:35], v[200:203], v[128:131]
    v_mfma_f32_16x16x32_bf16 v[136:139], a[32:35], v[204:207], v[136:139]
    v_rcp_f32 v216, v216
    v_rcp_f32 v224, v224
    v_mfma_f32_16x16x32_bf16 v[132:135], a[36:39], v[200:203], v[132:135]
    v_rcp_f32 v232, v232
    v_rcp_f32 v240, v240
    s_add_u32 m0, s71, 28672
    v_mfma_f32_16x16x32_bf16 v[140:143], a[36:39], v[204:207], v[140:143]
    s_add_u32 s60, s70, 804608
    v_mfma_f32_16x16x32_bf16 v[144:147], a[40:43], v[200:203], v[144:147]
    buffer_load_dwordx4 v123, s[20:23], s60 offen lds
    v_mul_f32 v212, v212, v216
    v_mul_f32 v213, v213, v216
    v_mfma_f32_16x16x32_bf16 v[152:155], a[40:43], v[204:207], v[152:155]
    v_mul_f32 v214, v214, v216
    v_mul_f32 v215, v215, v216
    v_cvt_pk_bf16_f32 v192, v212, v213
    v_mfma_f32_16x16x32_bf16 v[148:151], a[44:47], v[200:203], v[148:151]
    v_cvt_pk_bf16_f32 v193, v214, v215
    v_mul_f32 v220, v220, v224
    v_mul_f32 v221, v221, v224
    v_mfma_f32_16x16x32_bf16 v[156:159], a[44:47], v[204:207], v[156:159]
    v_mul_f32 v222, v222, v224
    v_mul_f32 v223, v223, v224
    s_add_u32 m0, s71, 32768
    v_mfma_f32_16x16x32_bf16 v[160:163], a[48:51], v[200:203], v[160:163]
    s_add_u32 s60, s70, 919296
    v_mfma_f32_16x16x32_bf16 v[168:171], a[48:51], v[204:207], v[168:171]
    buffer_load_dwordx4 v123, s[20:23], s60 offen lds
    v_cvt_pk_bf16_f32 v196, v220, v221
    v_mfma_f32_16x16x32_bf16 v[164:167], a[52:55], v[200:203], v[164:167]
    v_cvt_pk_bf16_f32 v197, v222, v223
    v_mul_f32 v228, v228, v232
    v_mul_f32 v229, v229, v232
    v_mfma_f32_16x16x32_bf16 v[172:175], a[52:55], v[204:207], v[172:175]
    v_mul_f32 v230, v230, v232
    v_mul_f32 v231, v231, v232
    v_cvt_pk_bf16_f32 v194, v228, v229
    v_mfma_f32_16x16x32_bf16 v[176:179], a[56:59], v[200:203], v[176:179]
    v_cvt_pk_bf16_f32 v195, v230, v231
    v_mul_f32 v236, v236, v240
    s_add_u32 m0, s71, 36864
    v_mfma_f32_16x16x32_bf16 v[184:187], a[56:59], v[204:207], v[184:187]
    s_add_u32 s60, s70, 1033984
    v_mfma_f32_16x16x32_bf16 v[180:183], a[60:63], v[200:203], v[180:183]
    buffer_load_dwordx4 v123, s[20:23], s60 offen lds
    v_mul_f32 v237, v237, v240
    v_mul_f32 v238, v238, v240
    v_mfma_f32_16x16x32_bf16 v[188:191], a[60:63], v[204:207], v[188:191]
    v_mul_f32 v239, v239, v240
    v_cvt_pk_bf16_f32 v198, v236, v237
    v_cvt_pk_bf16_f32 v199, v238, v239
    s_waitcnt vmcnt(12)
    v_mfma_f32_16x16x16_bf16 v[216:219], v[82:83], v[110:111], v[124:127]
    v_cvt_pk_bf16_f32 v60, v40, v41
    v_mfma_f32_16x16x16_bf16 v[224:227], v[82:83], v[112:113], v[124:127]
    v_cvt_pk_bf16_f32 v61, v42, v43
    s_waitcnt vmcnt(10)
    v_mfma_f32_16x16x16_bf16 v[232:235], v[84:85], v[114:115], v[124:127]
    v_cvt_pk_bf16_f32 v62, v44, v45
    v_mfma_f32_16x16x16_bf16 v[240:243], v[84:85], v[116:117], v[124:127]
    v_cvt_pk_bf16_f32 v63, v46, v47
    v_mfma_f32_16x16x16_bf16 v[212:215], v[60:61], v[110:111], 0
    s_add_u32 m0, s71, 40960
    v_mfma_f32_16x16x16_bf16 v[220:223], v[60:61], v[112:113], 0
    s_add_u32 s60, s70, 1148672
    buffer_load_dwordx4 v123, s[20:23], s60 offen lds
    v_mfma_f32_16x16x16_bf16 v[228:231], v[62:63], v[114:115], 0
    s_add_u32 m0, s71, 45056
    v_mfma_f32_16x16x16_bf16 v[236:239], v[62:63], v[116:117], 0
    s_add_u32 s60, s70, 1263360
    buffer_load_dwordx4 v123, s[20:23], s60 offen lds
    v_mov_b32 v253, s4
    s_mov_b64 exec, 1
    s_cmp_eq_u32 s6, 0
    s_cbranch_scc1 La15
    buffer_store_dword v253, off, s[40:43], s74
    s_branch Lb15
La15:
    buffer_store_dword v253, off, s[40:43], s74 sc1
Lb15:
    s_mov_b64 exec, -1
    v_mfma_f32_16x16x32_bf16 v[128:131], a[64:67], v[192:195], v[128:131]
    v_mfma_f32_16x16x32_bf16 v[136:139], a[64:67], v[196:199], v[136:139]
    v_rcp_f32 v216, v216
    v_rcp_f32 v224, v224
    v_mfma_f32_16x16x32_bf16 v[132:135], a[68:71], v[192:195], v[132:135]
    v_rcp_f32 v232, v232
    v_rcp_f32 v240, v240
    s_add_u32 m0, s71, 49152
    v_mfma_f32_16x16x32_bf16 v[140:143], a[68:71], v[196:199], v[140:143]
    s_add_u32 s60, s70, 1378048
    v_mfma_f32_16x16x32_bf16 v[144:147], a[72:75], v[192:195], v[144:147]
    buffer_load_dwordx4 v123, s[20:23], s60 offen lds
    v_mul_f32 v212, v212, v216
    v_mul_f32 v213, v213, v216
    v_mfma_f32_16x16x32_bf16 v[152:155], a[72:75], v[196:199], v[152:155]
    v_mul_f32 v214, v214, v216
    v_mul_f32 v215, v215, v216
    v_cvt_pk_bf16_f32 v200, v212, v213
    v_mfma_f32_16x16x32_bf16 v[148:151], a[76:79], v[192:195], v[148:151]
    v_cvt_pk_bf16_f32 v201, v214, v215
    v_mul_f32 v220, v220, v224
    v_mul_f32 v221, v221, v224
    v_mfma_f32_16x16x32_bf16 v[156:159], a[76:79], v[196:199], v[156:159]
    v_mul_f32 v222, v222, v224
    v_mul_f32 v223, v223, v224
    s_add_u32 m0, s71, 53248
    v_mfma_f32_16x16x32_bf16 v[160:163], a[80:83], v[192:195], v[160:163]
    s_add_u32 s60, s70, 1492736
    v_mfma_f32_16x16x32_bf16 v[168:171], a[80:83], v[196:199], v[168:171]
    buffer_load_dwordx4 v123, s[20:23], s60 offen lds
    v_cvt_pk_bf16_f32 v204, v220, v221
    v_mfma_f32_16x16x32_bf16 v[164:167], a[84:87], v[192:195], v[164:167]
    v_cvt_pk_bf16_f32 v205, v222, v223
    v_mul_f32 v228, v228, v232
    v_mul_f32 v229, v229, v232
    v_mfma_f32_16x16x32_bf16 v[172:175], a[84:87], v[196:199], v[172:175]
    v_mul_f32 v230, v230, v232
    v_mul_f32 v231, v231, v232
    v_cvt_pk_bf16_f32 v202, v228, v229
    v_mfma_f32_16x16x32_bf16 v[176:179], a[88:91], v[192:195], v[176:179]
    v_cvt_pk_bf16_f32 v203, v230, v231
    v_mul_f32 v236, v236, v240
    s_add_u32 m0, s71, 57344
    v_mfma_f32_16x16x32_bf16 v[184:187], a[88:91], v[196:199], v[184:187]
    s_add_u32 s60, s70, 1607424
    v_mfma_f32_16x16x32_bf16 v[180:183], a[92:95], v[192:195], v[180:183]
    buffer_load_dwordx4 v123, s[20:23], s60 offen lds
    v_mul_f32 v237, v237, v240
    v_mul_f32 v238, v238, v240
    v_mfma_f32_16x16x32_bf16 v[188:191], a[92:95], v[196:199], v[188:191]
    v_mul_f32 v239, v239, v240
    v_cvt_pk_bf16_f32 v206, v236, v237
    v_cvt_pk_bf16_f32 v207, v238, v239
    v_mfma_f32_16x16x32_bf16 v[144:147], a[104:107], v[200:203], v[144:147]
    s_add_u32 m0, s71, 61440
    v_mfma_f32_16x16x32_bf16 v[152:155], a[104:107], v[204:207], v[152:155]
    s_add_u32 s60, s70, 1722112
    v_mfma_f32_16x16x32_bf16 v[148:151], a[108:111], v[200:203], v[148:151]
    buffer_load_dwordx4 v123, s[20:23], s60 offen lds
    v_mfma_f32_16x16x32_bf16 v[156:159], a[108:111], v[204:207], v[156:159]
    s_add_u32 m0, s71, 65536
    v_mfma_f32_16x16x32_bf16 v[160:163], a[112:115], v[200:203], v[160:163]
    s_add_u32 s60, s82, 0
    v_mfma_f32_16x16x32_bf16 v[168:171], a[112:115], v[204:207], v[168:171]
    buffer_load_dwordx4 v123, s[20:23], s60 offen lds
    v_mfma_f32_16x16x32_bf16 v[164:167], a[116:119], v[200:203], v[164:167]
    s_add_u32 m0, s71, 69632
    v_mfma_f32_16x16x32_bf16 v[172:175], a[116:119], v[204:207], v[172:175]
    s_add_u32 s60, s82, 114688
    v_mfma_f32_16x16x32_bf16 v[176:179], a[120:123], v[200:203], v[176:179]
    buffer_load_dwordx4 v123, s[20:23], s60 offen lds
    v_mfma_f32_16x16x32_bf16 v[184:187], a[120:123], v[204:207], v[184:187]
    ds_write_b128 v119, v[144:147] offset:0
    v_mfma_f32_16x16x32_bf16 v[180:183], a[124:127], v[200:203], v[180:183]
    ds_write_b128 v119, v[148:151] offset:1024
    v_mfma_f32_16x16x32_bf16 v[188:191], a[124:127], v[204:207], v[188:191]
    ds_write_b128 v119, v[152:155] offset:2048
    v_mfma_f32_16x16x32_bf16 v[128:131], a[96:99], v[200:203], v[128:131]
    ds_write_b128 v119, v[156:159] offset:3072
    v_mfma_f32_16x16x32_bf16 v[136:139], a[96:99], v[204:207], v[136:139]
    ds_write_b128 v120, v[160:163] offset:0
    v_mfma_f32_16x16x32_bf16 v[132:135], a[100:103], v[200:203], v[132:135]
    ds_write_b128 v120, v[164:167] offset:1024
    v_mfma_f32_16x16x32_bf16 v[140:143], a[100:103], v[204:207], v[140:143]
    ds_write_b128 v120, v[168:171] offset:2048
    ds_write_b128 v120, v[172:175] offset:3072
    ds_write_b128 v121, v[176:179] offset:0
    ds_write_b128 v121, v[180:183] offset:1024
    ds_write_b128 v121, v[184:187] offset:2048
    ds_write_b128 v121, v[188:191] offset:3072
    buffer_load_dword v254, v255, s[40:43], s83 offen sc1
    v_lshlrev_b32 v80, 16, v244
    s_add_u32 m0, s71, 73728
    s_add_u32 s60, s82, 229376
    buffer_load_dwordx4 v123, s[20:23], s60 offen lds
    v_and_b32 v81, 0xffff0000, v244
    v_lshlrev_b32 v82, 16, v245
    s_add_u32 m0, s71, 77824
    s_add_u32 s60, s82, 344064
    buffer_load_dwordx4 v123, s[20:23], s60 offen lds
    v_and_b32 v83, 0xffff0000, v245
    v_lshlrev_b32 v84, 16, v246
    s_add_u32 m0, s71, 81920
    s_add_u32 s60, s82, 458752
    buffer_load_dwordx4 v123, s[20:23], s60 offen lds
    v_and_b32 v85, 0xffff0000, v246
    v_lshlrev_b32 v86, 16, v247
    s_add_u32 m0, s71, 86016
    s_add_u32 s60, s82, 573440
    buffer_load_dwordx4 v123, s[20:23], s60 offen lds
    v_and_b32 v87, 0xffff0000, v247
    v_lshlrev_b32 v88, 16, v248
    s_add_u32 m0, s71, 90112
    s_add_u32 s60, s82, 688128
    buffer_load_dwordx4 v123, s[20:23], s60 offen lds
    v_and_b32 v89, 0xffff0000, v248
    v_lshlrev_b32 v90, 16, v249
    s_add_u32 m0, s71, 94208
    s_add_u32 s60, s82, 802816
    buffer_load_dwordx4 v123, s[20:23], s60 offen lds
    v_and_b32 v91, 0xffff0000, v249
    v_lshlrev_b32 v92, 16, v250
    s_add_u32 m0, s71, 98304
    s_add_u32 s60, s82, 917504
    buffer_load_dwordx4 v123, s[20:23], s60 offen lds
    v_and_b32 v93, 0xffff0000, v250
    v_lshlrev_b32 v94, 16, v251
    s_add_u32 m0, s71, 102400
    s_add_u32 s60, s82, 1032192
    buffer_load_dwordx4 v123, s[20:23], s60 offen lds
    v_and_b32 v95, 0xffff0000, v251
    v_pk_add_f32 v[128:129], v[128:129], v[80:81]
    v_pk_add_f32 v[130:131], v[130:131], v[82:83]
    v_pk_add_f32 v[132:133], v[132:133], v[84:85]
    v_pk_add_f32 v[134:135], v[134:135], v[86:87]
    v_pk_add_f32 v[136:137], v[136:137], v[88:89]
    v_pk_add_f32 v[138:139], v[138:139], v[90:91]
    v_pk_add_f32 v[140:141], v[140:141], v[92:93]
    v_pk_add_f32 v[142:143], v[142:143], v[94:95]
    s_waitcnt lgkmcnt(0)
    s_barrier
    ds_read_b128 v[32:35], v118 offset:0
    ds_read_b128 v[48:51], v118 offset:4096
    ds_read_b128 v[64:67], v118 offset:8192
    ds_read_b128 v[36:39], v118 offset:1024
    ds_read_b128 v[52:55], v118 offset:5120
    ds_read_b128 v[68:71], v118 offset:9216
    ds_read_b128 v[40:43], v118 offset:2048
    ds_read_b128 v[56:59], v118 offset:6144
    ds_read_b128 v[72:75], v118 offset:10240
    ds_read_b128 v[44:47], v118 offset:3072
    ds_read_b128 v[60:63], v118 offset:7168
    ds_read_b128 v[76:79], v118 offset:11264
    s_waitcnt lgkmcnt(11)
    v_pk_add_f32 v[128:129], v[128:129], v[32:33]
    v_pk_add_f32 v[130:131], v[130:131], v[34:35]
    s_waitcnt lgkmcnt(10)
    v_pk_add_f32 v[128:129], v[128:129], v[48:49]
    v_pk_add_f32 v[130:131], v[130:131], v[50:51]
    s_waitcnt lgkmcnt(9)
    v_pk_add_f32 v[128:129], v[128:129], v[64:65]
    v_pk_add_f32 v[130:131], v[130:131], v[66:67]
    v_cvt_pk_bf16_f32 v96, v128, v129
    v_cvt_pk_bf16_f32 v97, v130, v131
    s_waitcnt lgkmcnt(8)
    v_pk_add_f32 v[132:133], v[132:133], v[36:37]
    v_pk_add_f32 v[134:135], v[134:135], v[38:39]
    s_waitcnt lgkmcnt(7)
    v_pk_add_f32 v[132:133], v[132:133], v[52:53]
    v_pk_add_f32 v[134:135], v[134:135], v[54:55]
    s_waitcnt lgkmcnt(6)
    v_pk_add_f32 v[132:133], v[132:133], v[68:69]
    v_pk_add_f32 v[134:135], v[134:135], v[70:71]
    v_cvt_pk_bf16_f32 v98, v132, v133
    v_cvt_pk_bf16_f32 v99, v134, v135
    s_waitcnt lgkmcnt(5)
    v_pk_add_f32 v[136:137], v[136:137], v[40:41]
    v_pk_add_f32 v[138:139], v[138:139], v[42:43]
    s_waitcnt lgkmcnt(4)
    v_pk_add_f32 v[136:137], v[136:137], v[56:57]
    v_pk_add_f32 v[138:139], v[138:139], v[58:59]
    s_waitcnt lgkmcnt(3)
    v_pk_add_f32 v[136:137], v[136:137], v[72:73]
    v_pk_add_f32 v[138:139], v[138:139], v[74:75]
    v_cvt_pk_bf16_f32 v100, v136, v137
    v_cvt_pk_bf16_f32 v101, v138, v139
    s_waitcnt lgkmcnt(2)
    v_pk_add_f32 v[140:141], v[140:141], v[44:45]
    v_pk_add_f32 v[142:143], v[142:143], v[46:47]
    s_waitcnt lgkmcnt(1)
    v_pk_add_f32 v[140:141], v[140:141], v[60:61]
    v_pk_add_f32 v[142:143], v[142:143], v[62:63]
    s_waitcnt lgkmcnt(0)
    v_pk_add_f32 v[140:141], v[140:141], v[76:77]
    v_pk_add_f32 v[142:143], v[142:143], v[78:79]
    v_cvt_pk_bf16_f32 v102, v140, v141
    v_cvt_pk_bf16_f32 v103, v142, v143
    s_mov_b32 s51, 0
    s_waitcnt vmcnt(8)
    v_cmp_ne_u32 vcc, s4, v254
    s_nop 0
    s_cbranch_vccz Le17
Lk16:
    buffer_load_dword v254, v255, s[40:43], s83 offen sc1
    s_waitcnt vmcnt(0)
    v_cmp_ne_u32 vcc, s4, v254
    s_add_u32 s51, s51, 1
    s_cbranch_vccz Le17
    s_cmp_lt_u32 s51, 65536
    s_cbranch_scc1 Lk16
Le17:
    s_cmp_eq_u32 s6, 0
    s_cbranch_scc1 La18
    buffer_store_dwordx4 v[96:99], v1, s[40:43], s64 offen
    buffer_store_dwordx4 v[100:103], v1, s[40:43], s65 offen
    s_branch Lb18
La18:
    buffer_store_dwordx4 v[96:99], v1, s[40:43], s64 offen sc1
    buffer_store_dwordx4 v[100:103], v1, s[40:43], s65 offen sc1
Lb18:
    v_pk_add_f32 v[104:105], v[128:129], v[130:131]
    v_pk_add_f32 v[108:109], v[136:137], v[138:139]
    v_pk_mul_f32 v[106:107], v[128:129], v[128:129]
    v_pk_mul_f32 v[110:111], v[136:137], v[136:137]
    v_pk_add_f32 v[104:105], v[104:105], v[132:133]
    v_pk_add_f32 v[108:109], v[108:109], v[140:141]
    v_pk_fma_f32 v[106:107], v[130:131], v[130:131], v[106:107]
    v_pk_fma_f32 v[110:111], v[138:139], v[138:139], v[110:111]
    v_pk_add_f32 v[104:105], v[104:105], v[134:135]
    v_pk_add_f32 v[108:109], v[108:109], v[142:143]
    v_pk_fma_f32 v[106:107], v[132:133], v[132:133], v[106:107]
    v_pk_fma_f32 v[110:111], v[140:141], v[140:141], v[110:111]
    v_add_f32 v104, v104, v105
    v_add_f32 v108, v108, v109
    v_pk_fma_f32 v[106:107], v[134:135], v[134:135], v[106:107]
    v_pk_fma_f32 v[110:111], v[142:143], v[142:143], v[110:111]
    v_add_f32 v105, v106, v107
    v_add_f32 v109, v110, v111
    v_mov_b32 v112, v104
    v_mov_b32 v113, v105
    v_mov_b32 v114, v108
    v_mov_b32 v115, v109
    v_permlane32_swap_b32 v112, v104
    v_permlane32_swap_b32 v113, v105
    v_permlane32_swap_b32 v114, v108
    v_permlane32_swap_b32 v115, v109
    v_add_f32 v104, v104, v112
    v_add_f32 v105, v105, v113
    v_add_f32 v108, v108, v114
    v_add_f32 v109, v109, v115
    s_nop 0
    v_permlane16_swap_b32 v104, v108
    v_permlane16_swap_b32 v105, v109
    v_pk_add_f32 v[104:105], v[104:105], v[108:109]
    s_mov_b32 exec_hi, 0
    s_cmp_eq_u32 s6, 0
    s_cbranch_scc1 La19
    buffer_store_dwordx2 v[104:105], v122, s[40:43], s61 offen
    s_branch Lb19
La19:
    buffer_store_dwordx2 v[104:105], v122, s[40:43], s61 offen sc1
Lb19:
    s_mov_b64 exec, -1
    s_lshl_b32 s90, s100, 3
    s_lshl_b32 s86, s50, 1
    s_add_u32 s90, s90, s86
    s_lshl_b32 s93, s90, 11
    s_add_u32 s93, s93, 786432
    s_lshl_b32 s90, s90, 14
    s_add_u32 s90, s90, 1048576
    s_lshl_b32 s91, s50, 9
    s_add_u32 s91, s91, 131584
    s_lshl_b32 s67, s100, 7
    s_add_u32 s67, s67, 8192
    v_lshlrev_b32 v240, 2, v2
    v_mov_b32 v12, 0x3f803f80
    v_accvgpr_write_b32 a240, v12
    v_accvgpr_write_b32 a241, v12
    v_accvgpr_write_b32 a242, v12
    v_accvgpr_write_b32 a243, v12
    s_lshl_b32 s86, s50, 5
    v_xor_b32 v15, s86, v8
    s_mul_i32 s74, s100, 14
    s_add_u32 s74, s74, s101
    s_mul_i32 s74, s74, 3
    s_add_u32 s74, s74, s50
    s_lshl_b32 s74, s74, 14
    s_add_u32 s74, s74, 512
    s_cmp_eq_u32 s50, 3
    s_cselect_b32 s74, 0x1000000, s74
    s_waitcnt vmcnt(0)
    s_barrier
    s_cmp_lg_u32 s50, 0
    s_cbranch_scc1 Lw20
    s_mov_b64 exec, 0x10000
    v_mov_b32 v5, s4
    s_cmp_eq_u32 s6, 0
    s_cbranch_scc1 La21
    buffer_store_dword v5, v4, s[40:43], 0 offen
    s_branch Lb21
La21:
    buffer_store_dword v5, v4, s[40:43], 0 offen sc1
Lb21:
    s_mov_b64 exec, -1
Lw20:
    s_cmp_ge_u32 s101, 14
    s_cbranch_scc1 L_p3skip
    ds_read_b64_tr_b16 v[16:17], v15 offset:0
    ds_read_b64_tr_b16 v[18:19], v15 offset:2048
    ds_read_b64_tr_b16 v[20:21], v15 offset:4096
    ds_read_b64_tr_b16 v[22:23], v15 offset:6144
    ds_read_b64_tr_b16 v[24:25], v15 offset:8192
    ds_read_b64_tr_b16 v[26:27], v15 offset:10240
    s_waitcnt lgkmcnt(4)
    v_mfma_f32_16x16x32_bf16 a[236:239], a[240:243], v[16:19], 0
    ds_read_b64_tr_b16 v[28:29], v15 offset:12288
    ds_read_b64_tr_b16 v[30:31], v15 offset:14336
    s_waitcnt lgkmcnt(4)
    v_mfma_f32_16x16x32_bf16 a[236:239], a[240:243], v[20:23], a[236:239]
    ds_read_b64_tr_b16 v[32:33], v15 offset:16384
    ds_read_b64_tr_b16 v[34:35], v15 offset:18432
    s_waitcnt lgkmcnt(4)
    v_mfma_f32_16x16x32_bf16 a[236:239], a[240:243], v[24:27], a[236:239]
    ds_read_b64_tr_b16 v[36:37], v15 offset:20480
    ds_read_b64_tr_b16 v[38:39], v15 offset:22528
    s_waitcnt lgkmcnt(4)
    v_mfma_f32_16x16x32_bf16 a[236:239], a[240:243], v[28:31], a[236:239]
    ds_read_b64_tr_b16 v[40:41], v15 offset:24576
    ds_read_b64_tr_b16 v[42:43], v15 offset:26624
    s_waitcnt lgkmcnt(4)
    v_mfma_f32_16x16x32_bf16 a[236:239], a[240:243], v[32:35], a[236:239]
    ds_read_b64_tr_b16 v[44:45], v15 offset:28672
    ds_read_b64_tr_b16 v[46:47], v15 offset:30720
    s_waitcnt lgkmcnt(4)
    v_mfma_f32_16x16x32_bf16 a[236:239], a[240:243], v[36:39], a[236:239]
    ds_read_b64_tr_b16 v[48:49], v15 offset:32768
    ds_read_b64_tr_b16 v[50:51], v15 offset:34816
    s_waitcnt lgkmcnt(4)
    v_mfma_f32_16x16x32_bf16 a[236:239], a[240:243], v[40:43], a[236:239]
    ds_read_b64_tr_b16 v[52:53], v15 offset:36864
    ds_read_b64_tr_b16 v[54:55], v15 offset:38912
    s_waitcnt lgkmcnt(4)
    v_mfma_f32_16x16x32_bf16 a[236:239], a[240:243], v[44:47], a[236:239]
    ds_read_b64_tr_b16 v[56:57], v15 offset:40960
    ds_read_b64_tr_b16 v[58:59], v15 offset:43008
    s_waitcnt lgkmcnt(4)
    v_mfma_f32_16x16x32_bf16 a[236:239], a[240:243], v[48:51], a[236:239]
    ds_read_b64_tr_b16 v[60:61], v15 offset:45056
    ds_read_b64_tr_b16 v[62:63], v15 offset:47104
    s_waitcnt lgkmcnt(4)
    v_mfma_f32_16x16x32_bf16 a[236:239], a[240:243], v[52:55], a[236:239]
    ds_read_b64_tr_b16 v[64:65], v15 offset:49152
    ds_read_b64_tr_b16 v[66:67], v15 offset:51200
    s_waitcnt lgkmcnt(4)
    v_mfma_f32_16x16x32_bf16 a[236:239], a[240:243], v[56:59], a[236:239]
    ds_read_b64_tr_b16 v[68:69], v15 offset:53248
    ds_read_b64_tr_b16 v[70:71], v15 offset:55296
    s_waitcnt lgkmcnt(4)
    v_mfma_f32_16x16x32_bf16 a[236:239], a[240:243], v[60:63], a[236:239]
    ds_read_b64_tr_b16 v[72:73], v15 offset:57344
    ds_read_b64_tr_b16 v[74:75], v15 offset:59392
    s_waitcnt lgkmcnt(4)
    v_mfma_f32_16x16x32_bf16 a[236:239], a[240:243], v[64:67], a[236:239]
    ds_read_b64_tr_b16 v[76:77], v15 offset:61440
    ds_read_b64_tr_b16 v[78:79], v15 offset:63488
    s_waitcnt lgkmcnt(4)
    v_mfma_f32_16x16x32_bf16 a[236:239], a[240:243], v[68:71], a[236:239]
    s_waitcnt lgkmcnt(2)
    v_mfma_f32_16x16x32_bf16 a[236:239], a[240:243], v[72:75], a[236:239]
    s_waitcnt lgkmcnt(0)
    v_mfma_f32_16x16x32_bf16 a[236:239], a[240:243], v[76:79], a[236:239]
    s_lshl_b32 s86, s50, 6
    s_add_u32 s86, s86, 133632
    v_lshl_add_u32 v5, v2, 2, s86
    s_nop 4
    ds_write_b32 v5, a236
    ds_read_b64_tr_b16 v[144:145], v8 offset:0
    ds_read_b64_tr_b16 v[146:147], v8 offset:2048
    ds_read_b64_tr_b16 v[148:149], v9 offset:0
    ds_read_b64_tr_b16 v[150:151], v9 offset:2048
    ds_read_b64_tr_b16 v[152:153], v10 offset:0
    ds_read_b64_tr_b16 v[154:155], v10 offset:2048
    ds_read_b64_tr_b16 v[156:157], v11 offset:0
    ds_read_b64_tr_b16 v[158:159], v11 offset:2048
    s_cmp_lg_u32 s50, 0
    s_cbranch_scc1 Lw22
    s_mov_b32 s51, 0
Lp23:
    buffer_load_dword v12, v240, s[40:43], s67 offen sc1
    s_waitcnt vmcnt(0)
    v_cmp_ne_u32 vcc, s4, v12
    s_add_u32 s51, s51, 1
    s_cbranch_vccz Le24
    s_cmp_lt_u32 s51, 65536
    s_cbranch_scc1 Lp23
Le24:
Lw22:
    s_waitcnt lgkmcnt(0)
    s_barrier
    s_add_u32 s64, s90, 0
    s_add_u32 s65, s90, 16384
    buffer_load_dwordx4 v[16:19], v1, s[40:43], s64 offen offset:0 sc1
    buffer_load_dwordx4 v[20:23], v1, s[40:43], s65 offen offset:0 sc1
    buffer_load_dwordx4 v[24:27], v1, s[40:43], s64 offen offset:1024 sc1
    buffer_load_dwordx4 v[28:31], v1, s[40:43], s65 offen offset:1024 sc1
    buffer_load_dwordx4 v[32:35], v1, s[40:43], s64 offen offset:2048 sc1
    buffer_load_dwordx4 v[36:39], v1, s[40:43], s65 offen offset:2048 sc1
    buffer_load_dwordx4 v[40:43], v1, s[40:43], s64 offen offset:3072 sc1
    buffer_load_dwordx4 v[44:47], v1, s[40:43], s65 offen offset:3072 sc1
    s_add_u32 s64, s90, 4096
    s_add_u32 s65, s90, 20480
    buffer_load_dwordx4 v[48:51], v1, s[40:43], s64 offen offset:0 sc1
    buffer_load_dwordx4 v[52:55], v1, s[40:43], s65 offen offset:0 sc1
    v_add_u32 v5, 133632, v240
    ds_read_b32 v228, v5 offset:0
    ds_read_b32 v229, v5 offset:64
    ds_read_b32 v230, v5 offset:128
    ds_read_b32 v231, v5 offset:192
    v_lshrrev_b32 v241, 3, v0
    v_mul_u32_u24 v241, 3584, v241
    v_add_u32 v241, v241, v6
    v_lshrrev_b32 v242, 3, v0
    v_lshl_add_u32 v242, v242, 10, v6
    s_lshl_b32 s68, s50, 13
    s_lshl_b32 s86, s5, 7
    s_add_u32 s68, s68, s86
    s_lshl_b32 s69, s50, 10
    s_add_u32 s69, s69, 49152
    s_waitcnt lgkmcnt(0) vmcnt(9)
    v_mfma_f32_16x16x32_bf16 v[176:179], v[16:19], v[144:147], 0
    ds_read_b64_tr_b16 v[160:161], v8 offset:4096
    ds_read_b64_tr_b16 v[162:163], v8 offset:6144
    s_waitcnt vmcnt(8)
    v_mfma_f32_16x16x32_bf16 v[192:195], v[20:23], v[144:147], 0
    ds_read_b64_tr_b16 v[164:165], v9 offset:4096
    ds_read_b64_tr_b16 v[166:167], v9 offset:6144
    v_mfma_f32_16x16x32_bf16 v[180:183], v[16:19], v[148:151], 0
    ds_read_b64_tr_b16 v[168:169], v10 offset:4096
    ds_read_b64_tr_b16 v[170:171], v10 offset:6144
    v_mfma_f32_16x16x32_bf16 v[196:199], v[20:23], v[148:151], 0
    ds_read_b64_tr_b16 v[172:173], v11 offset:4096
    ds_read_b64_tr_b16 v[174:175], v11 offset:6144
    v_mfma_f32_16x16x32_bf16 v[184:187], v[16:19], v[152:155], 0
    v_lshrrev_b32 v12, 3, v0
    v_mfma_f32_16x16x32_bf16 v[200:203], v[20:23], v[152:155], 0
    buffer_load_dwordx4 v[56:59], v1, s[40:43], s64 offen offset:1024 sc1
    v_and_b32 v13, 7, v0
    v_mfma_f32_16x16x32_bf16 v[188:191], v[16:19], v[156:159], 0
    v_xor_b32 v13, v13, v3
    buffer_load_dwordx4 v[60:63], v1, s[40:43], s65 offen offset:1024 sc1
    v_mfma_f32_16x16x32_bf16 v[204:207], v[20:23], v[156:159], 0
    v_lshlrev_b32 v13, 4, v13
    v_lshl_add_u32 v244, v12, 12, v13
    s_waitcnt lgkmcnt(0) vmcnt(9)
    v_mfma_f32_16x16x32_bf16 v[176:179], v[24:27], v[160:163], v[176:179]
    ds_read_b64_tr_b16 v[144:145], v8 offset:8192
    ds_read_b64_tr_b16 v[146:147], v8 offset:10240
    s_waitcnt vmcnt(8)
    v_mfma_f32_16x16x32_bf16 v[192:195], v[28:31], v[160:163], v[192:195]
    ds_read_b64_tr_b16 v[148:149], v9 offset:8192
    ds_read_b64_tr_b16 v[150:151], v9 offset:10240
    v_mfma_f32_16x16x32_bf16 v[180:183], v[24:27], v[164:167], v[180:183]
    ds_read_b64_tr_b16 v[152:153], v10 offset:8192
    ds_read_b64_tr_b16 v[154:155], v10 offset:10240
    v_mfma_f32_16x16x32_bf16 v[196:199], v[28:31], v[164:167], v[196:199]
    ds_read_b64_tr_b16 v[156:157], v11 offset:8192
    ds_read_b64_tr_b16 v[158:159], v11 offset:10240
    v_mfma_f32_16x16x32_bf16 v[184:187], v[24:27], v[168:171], v[184:187]
    v_xor_b32 v245, 64, v244
    v_mfma_f32_16x16x32_bf16 v[200:203], v[28:31], v[168:171], v[200:203]
    buffer_load_dwordx4 v[64:67], v1, s[40:43], s64 offen offset:2048 sc1
    v_add_u32 v245, 32768, v245
    v_mfma_f32_16x16x32_bf16 v[188:191], v[24:27], v[172:175], v[188:191]
    s_lshl_b32 s96, s62, 18
    buffer_load_dwordx4 v[68:71], v1, s[40:43], s65 offen offset:2048 sc1
    v_mfma_f32_16x16x32_bf16 v[204:207], v[28:31], v[172:175], v[204:207]
    s_lshl_b32 s86, s50, 10
    s_add_u32 s96, s96, s86
    s_waitcnt lgkmcnt(0) vmcnt(9)
    v_mfma_f32_16x16x32_bf16 v[176:179], v[32:35], v[144:147], v[176:179]
    ds_read_b64_tr_b16 v[160:161], v8 offset:12288
    ds_read_b64_tr_b16 v[162:163], v8 offset:14336
    s_waitcnt vmcnt(8)
    v_mfma_f32_16x16x32_bf16 v[192:195], v[36:39], v[144:147], v[192:195]
    ds_read_b64_tr_b16 v[164:165], v9 offset:12288
    ds_read_b64_tr_b16 v[166:167], v9 offset:14336
    v_mfma_f32_16x16x32_bf16 v[180:183], v[32:35], v[148:151], v[180:183]
    ds_read_b64_tr_b16 v[168:169], v10 offset:12288
    ds_read_b64_tr_b16 v[170:171], v10 offset:14336
    v_mfma_f32_16x16x32_bf16 v[196:199], v[36:39], v[148:151], v[196:199]
    ds_read_b64_tr_b16 v[172:173], v11 offset:12288
    ds_read_b64_tr_b16 v[174:175], v11 offset:14336
    v_mfma_f32_16x16x32_bf16 v[184:187], v[32:35], v[152:155], v[184:187]
    s_lshl_b32 s97, s50, 14
    v_mfma_f32_16x16x32_bf16 v[200:203], v[36:39], v[152:155], v[200:203]
    buffer_load_dwordx4 v[72:75], v1, s[40:43], s64 offen offset:3072 sc1
    v_lshrrev_b32 v12, 1, v2
    v_mfma_f32_16x16x32_bf16 v[188:191], v[32:35], v[156:159], v[188:191]
    v_xor_b32 v12, v12, v3
    buffer_load_dwordx4 v[76:79], v1, s[40:43], s65 offen offset:3072 sc1
    v_mfma_f32_16x16x32_bf16 v[204:207], v[36:39], v[156:159], v[204:207]
    v_lshlrev_b32 v12, 4, v12
    v_lshl_add_u32 v12, v2, 7, v12
    s_waitcnt lgkmcnt(0) vmcnt(9)
    v_mfma_f32_16x16x32_bf16 v[176:179], v[40:43], v[160:163], v[176:179]
    ds_read_b64_tr_b16 v[144:145], v8 offset:16384
    ds_read_b64_tr_b16 v[146:147], v8 offset:18432
    s_waitcnt vmcnt(8)
    v_mfma_f32_16x16x32_bf16 v[192:195], v[44:47], v[160:163], v[192:195]
    ds_read_b64_tr_b16 v[148:149], v9 offset:16384
    ds_read_b64_tr_b16 v[150:151], v9 offset:18432
    v_mfma_f32_16x16x32_bf16 v[180:183], v[40:43], v[164:167], v[180:183]
    ds_read_b64_tr_b16 v[152:153], v10 offset:16384
    ds_read_b64_tr_b16 v[154:155], v10 offset:18432
    v_mfma_f32_16x16x32_bf16 v[196:199], v[44:47], v[164:167], v[196:199]
    ds_read_b64_tr_b16 v[156:157], v11 offset:16384
    ds_read_b64_tr_b16 v[158:159], v11 offset:18432
    v_mfma_f32_16x16x32_bf16 v[184:187], v[40:43], v[168:171], v[184:187]
    v_xor_b32 v13, 64, v12
    s_add_u32 s64, s90, 8192
    v_mfma_f32_16x16x32_bf16 v[200:203], v[44:47], v[168:171], v[200:203]
    s_add_u32 s65, s90, 24576
    buffer_load_dwordx4 v[80:83], v1, s[40:43], s64 offen offset:0 sc1
    v_mfma_f32_16x16x32_bf16 v[188:191], v[40:43], v[172:175], v[188:191]
    s_add_u32 s86, s50, 0
    s_and_b32 s86, s86, 3
    v_mfma_f32_16x16x32_bf16 v[204:207], v[44:47], v[172:175], v[204:207]
    buffer_load_dwordx4 v[84:87], v1, s[40:43], s65 offen offset:0 sc1
    s_lshl_b32 s86, s86, 11
    s_add_u32 s86, s86, s97
    s_waitcnt lgkmcnt(0) vmcnt(9)
    v_mfma_f32_16x16x32_bf16 v[176:179], v[48:51], v[144:147], v[176:179]
    ds_read_b64_tr_b16 v[160:161], v8 offset:20480
    ds_read_b64_tr_b16 v[162:163], v8 offset:22528
    s_waitcnt vmcnt(8)
    v_mfma_f32_16x16x32_bf16 v[192:195], v[52:55], v[144:147], v[192:195]
    ds_read_b64_tr_b16 v[164:165], v9 offset:20480
    ds_read_b64_tr_b16 v[166:167], v9 offset:22528
    v_mfma_f32_16x16x32_bf16 v[180:183], v[48:51], v[148:151], v[180:183]
    ds_read_b64_tr_b16 v[168:169], v10 offset:20480
    ds_read_b64_tr_b16 v[170:171], v10 offset:22528
    v_mfma_f32_16x16x32_bf16 v[196:199], v[52:55], v[148:151], v[196:199]
    ds_read_b64_tr_b16 v[172:173], v11 offset:20480
    ds_read_b64_tr_b16 v[174:175], v11 offset:22528
    v_mfma_f32_16x16x32_bf16 v[184:187], v[48:51], v[152:155], v[184:187]
    v_add_u32 v246, s86, v12
    v_mfma_f32_16x16x32_bf16 v[200:203], v[52:55], v[152:155], v[200:203]
    buffer_load_dwordx4 v[88:91], v1, s[40:43], s64 offen offset:1024 sc1
    v_add_u32 v247, s86, v13
    v_mfma_f32_16x16x32_bf16 v[188:191], v[48:51], v[156:159], v[188:191]
    s_add_u32 s86, s50, 1
    buffer_load_dwordx4 v[92:95], v1, s[40:43], s65 offen offset:1024 sc1
    v_mfma_f32_16x16x32_bf16 v[204:207], v[52:55], v[156:159], v[204:207]
    s_and_b32 s86, s86, 3
    s_lshl_b32 s86, s86, 11
    s_waitcnt lgkmcnt(0) vmcnt(9)
    v_mfma_f32_16x16x32_bf16 v[176:179], v[56:59], v[160:163], v[176:179]
    ds_read_b64_tr_b16 v[144:145], v8 offset:24576
    ds_read_b64_tr_b16 v[146:147], v8 offset:26624
    s_waitcnt vmcnt(8)
    v_mfma_f32_16x16x32_bf16 v[192:195], v[60:63], v[160:163], v[192:195]
    ds_read_b64_tr_b16 v[148:149], v9 offset:24576
    ds_read_b64_tr_b16 v[150:151], v9 offset:26624
    v_mfma_f32_16x16x32_bf16 v[180:183], v[56:59], v[164:167], v[180:183]
    ds_read_b64_tr_b16 v[152:153], v10 offset:24576
    ds_read_b64_tr_b16 v[154:155], v10 offset:26624
    v_mfma_f32_16x16x32_bf16 v[196:199], v[60:63], v[164:167], v[196:199]
    ds_read_b64_tr_b16 v[156:157], v11 offset:24576
    ds_read_b64_tr_b16 v[158:159], v11 offset:26624
    v_mfma_f32_16x16x32_bf16 v[184:187], v[56:59], v[168:171], v[184:187]
    s_add_u32 s86, s86, s97
    v_mfma_f32_16x16x32_bf16 v[200:203], v[60:63], v[168:171], v[200:203]
    buffer_load_dwordx4 v[96:99], v1, s[40:43], s64 offen offset:2048 sc1
    v_add_u32 v248, s86, v12
    v_mfma_f32_16x16x32_bf16 v[188:191], v[56:59], v[172:175], v[188:191]
    v_add_u32 v249, s86, v13
    buffer_load_dwordx4 v[100:103], v1, s[40:43], s65 offen offset:2048 sc1
    v_mfma_f32_16x16x32_bf16 v[204:207], v[60:63], v[172:175], v[204:207]
    s_add_u32 s86, s50, 2
    s_and_b32 s86, s86, 3
    s_waitcnt lgkmcnt(0) vmcnt(9)
    v_mfma_f32_16x16x32_bf16 v[176:179], v[64:67], v[144:147], v[176:179]
    ds_read_b64_tr_b16 v[160:161], v8 offset:28672
    ds_read_b64_tr_b16 v[162:163], v8 offset:30720
    s_waitcnt vmcnt(8)
    v_mfma_f32_16x16x32_bf16 v[192:195], v[68:71], v[144:147], v[192:195]
    ds_read_b64_tr_b16 v[164:165], v9 offset:28672
    ds_read_b64_tr_b16 v[166:167], v9 offset:30720
    v_mfma_f32_16x16x32_bf16 v[180:183], v[64:67], v[148:151], v[180:183]
    ds_read_b64_tr_b16 v[168:169], v10 offset:28672
    ds_read_b64_tr_b16 v[170:171], v10 offset:30720
    v_mfma_f32_16x16x32_bf16 v[196:199], v[68:71], v[148:151], v[196:199]
    ds_read_b64_tr_b16 v[172:173], v11 offset:28672
    ds_read_b64_tr_b16 v[174:175], v11 offset:30720
    v_mfma_f32_16x16x32_bf16 v[184:187], v[64:67], v[152:155], v[184:187]
    s_lshl_b32 s86, s86, 11
    v_mfma_f32_16x16x32_bf16 v[200:203], v[68:71], v[152:155], v[200:203]
    buffer_load_dwordx4 v[104:107], v1, s[40:43], s64 offen offset:3072 sc1
    s_add_u32 s86, s86, s97
    v_mfma_f32_16x16x32_bf16 v[188:191], v[64:67], v[156:159], v[188:191]
    v_add_u32 v250, s86, v12
    buffer_load_dwordx4 v[108:111], v1, s[40:43], s65 offen offset:3072 sc1
    v_mfma_f32_16x16x32_bf16 v[204:207], v[68:71], v[156:159], v[204:207]
    v_add_u32 v251, s86, v13
    s_add_u32 s86, s50, 3
    s_waitcnt lgkmcnt(0) vmcnt(9)
    v_mfma_f32_16x16x32_bf16 v[176:179], v[72:75], v[160:163], v[176:179]
    ds_read_b64_tr_b16 v[144:145], v8 offset:32768
    ds_read_b64_tr_b16 v[146:147], v8 offset:34816
    s_waitcnt vmcnt(8)
    v_mfma_f32_16x16x32_bf16 v[192:195], v[76:79], v[160:163], v[192:195]
    ds_read_b64_tr_b16 v[148:149], v9 offset:32768
    ds_read_b64_tr_b16 v[150:151], v9 offset:34816
    v_mfma_f32_16x16x32_bf16 v[180:183], v[72:75], v[164:167], v[180:183]
    ds_read_b64_tr_b16 v[152:153], v10 offset:32768
    ds_read_b64_tr_b16 v[154:155], v10 offset:34816
    v_mfma_f32_16x16x32_bf16 v[196:199], v[76:79], v[164:167], v[196:199]
    ds_read_b64_tr_b16 v[156:157], v11 offset:32768
    ds_read_b64_tr_b16 v[158:159], v11 offset:34816
    v_mfma_f32_16x16x32_bf16 v[184:187], v[72:75], v[168:171], v[184:187]
    s_and_b32 s86, s86, 3
    s_add_u32 s64, s90, 12288
    v_mfma_f32_16x16x32_bf16 v[200:203], v[76:79], v[168:171], v[200:203]
    s_add_u32 s65, s90, 28672
    buffer_load_dwordx4 v[112:115], v1, s[40:43], s64 offen offset:0 sc1
    v_mfma_f32_16x16x32_bf16 v[188:191], v[72:75], v[172:175], v[188:191]
    s_lshl_b32 s86, s86, 11
    s_add_u32 s86, s86, s97
    v_mfma_f32_16x16x32_bf16 v[204:207], v[76:79], v[172:175], v[204:207]
    buffer_load_dwordx4 v[116:119], v1, s[40:43], s65 offen offset:0 sc1
    v_add_u32 v252, s86, v12
    v_add_u32 v253, s86, v13
    s_waitcnt lgkmcnt(0) vmcnt(9)
    v_mfma_f32_16x16x32_bf16 v[176:179], v[80:83], v[144:147], v[176:179]
    ds_read_b64_tr_b16 v[160:161], v8 offset:36864
    ds_read_b64_tr_b16 v[162:163], v8 offset:38912
    s_waitcnt vmcnt(8)
    v_mfma_f32_16x16x32_bf16 v[192:195], v[84:87], v[144:147], v[192:195]
    ds_read_b64_tr_b16 v[164:165], v9 offset:36864
    ds_read_b64_tr_b16 v[166:167], v9 offset:38912
    v_mfma_f32_16x16x32_bf16 v[180:183], v[80:83], v[148:151], v[180:183]
    ds_read_b64_tr_b16 v[168:169], v10 offset:36864
    ds_read_b64_tr_b16 v[170:171], v10 offset:38912
    v_mfma_f32_16x16x32_bf16 v[196:199], v[84:87], v[148:151], v[196:199]
    ds_read_b64_tr_b16 v[172:173], v11 offset:36864
    ds_read_b64_tr_b16 v[174:175], v11 offset:38912
    v_mfma_f32_16x16x32_bf16 v[184:187], v[80:83], v[152:155], v[184:187]
    v_mov_b32 v254, 0xc0135761
    v_mfma_f32_16x16x32_bf16 v[200:203], v[84:87], v[152:155], v[200:203]
    buffer_load_dwordx4 v[120:123], v1, s[40:43], s64 offen offset:1024 sc1
    v_mov_b32 v255, 0xc0135761
    v_mfma_f32_16x16x32_bf16 v[188:191], v[80:83], v[156:159], v[188:191]
    v_lshl_add_u32 v13, v2, 2, s91
    buffer_load_dwordx4 v[124:127], v1, s[40:43], s65 offen offset:1024 sc1
    v_mfma_f32_16x16x32_bf16 v[204:207], v[84:87], v[156:159], v[204:207]
    v_lshl_add_u32 v14, v3, 4, s91
    v_bfe_u32 v12, v0, 3, 1
    s_waitcnt lgkmcnt(0) vmcnt(9)
    v_mfma_f32_16x16x32_bf16 v[176:179], v[88:91], v[160:163], v[176:179]
    ds_read_b64_tr_b16 v[144:145], v8 offset:40960
    ds_read_b64_tr_b16 v[146:147], v8 offset:43008
    s_waitcnt vmcnt(8)
    v_mfma_f32_16x16x32_bf16 v[192:195], v[92:95], v[160:163], v[192:195]
    ds_read_b64_tr_b16 v[148:149], v9 offset:40960
    ds_read_b64_tr_b16 v[150:151], v9 offset:43008
    v_mfma_f32_16x16x32_bf16 v[180:183], v[88:91], v[164:167], v[180:183]
    ds_read_b64_tr_b16 v[152:153], v10 offset:40960
    ds_read_b64_tr_b16 v[154:155], v10 offset:43008
    v_mfma_f32_16x16x32_bf16 v[196:199], v[92:95], v[164:167], v[196:199]
    ds_read_b64_tr_b16 v[156:157], v11 offset:40960
    ds_read_b64_tr_b16 v[158:159], v11 offset:43008
    v_mfma_f32_16x16x32_bf16 v[184:187], v[88:91], v[168:171], v[184:187]
    v_lshlrev_b32 v12, 8, v12
    v_mfma_f32_16x16x32_bf16 v[200:203], v[92:95], v[168:171], v[200:203]
    buffer_load_dwordx4 v[128:131], v1, s[40:43], s64 offen offset:2048 sc1
    v_lshl_add_u32 v12, v3, 6, v12
    v_mfma_f32_16x16x32_bf16 v[188:191], v[88:91], v[172:175], v[188:191]
    v_bfe_u32 v5, v0, 2, 1
    buffer_load_dwordx4 v[132:135], v1, s[40:43], s65 offen offset:2048 sc1
    v_mfma_f32_16x16x32_bf16 v[204:207], v[92:95], v[172:175], v[204:207]
    v_lshl_add_u32 v12, v5, 5, v12
    v_and_b32 v5, 1, v0
    s_waitcnt lgkmcnt(0) vmcnt(9)
    v_mfma_f32_16x16x32_bf16 v[176:179], v[96:99], v[144:147], v[176:179]
    ds_read_b64_tr_b16 v[160:161], v8 offset:45056
    ds_read_b64_tr_b16 v[162:163], v8 offset:47104
    s_waitcnt vmcnt(8)
    v_mfma_f32_16x16x32_bf16 v[192:195], v[100:103], v[144:147], v[192:195]
    ds_read_b64_tr_b16 v[164:165], v9 offset:45056
    ds_read_b64_tr_b16 v[166:167], v9 offset:47104
    v_mfma_f32_16x16x32_bf16 v[180:183], v[96:99], v[148:151], v[180:183]
    ds_read_b64_tr_b16 v[168:169], v10 offset:45056
    ds_read_b64_tr_b16 v[170:171], v10 offset:47104
    v_mfma_f32_16x16x32_bf16 v[196:199], v[100:103], v[148:151], v[196:199]
    ds_read_b64_tr_b16 v[172:173], v11 offset:45056
    ds_read_b64_tr_b16 v[174:175], v11 offset:47104
    v_mfma_f32_16x16x32_bf16 v[184:187], v[96:99], v[152:155], v[184:187]
    v_lshl_add_u32 v12, v5, 4, v12
    v_mfma_f32_16x16x32_bf16 v[200:203], v[100:103], v[152:155], v[200:203]
    buffer_load_dwordx4 v[136:139], v1, s[40:43], s64 offen offset:3072 sc1
    v_cmp_eq_u32 s[72:73], 1, v5
    v_mfma_f32_16x16x32_bf16 v[188:191], v[96:99], v[156:159], v[188:191]
    s_lshl_b32 s92, s100, 15
    buffer_load_dwordx4 v[140:143], v1, s[40:43], s65 offen offset:3072 sc1
    v_mfma_f32_16x16x32_bf16 v[204:207], v[100:103], v[156:159], v[204:207]
    s_lshl_b32 s86, s50, 9
    s_add_u32 s92, s92, s86
    s_waitcnt lgkmcnt(0) vmcnt(9)
    v_mfma_f32_16x16x32_bf16 v[176:179], v[104:107], v[160:163], v[176:179]
    ds_read_b64_tr_b16 v[144:145], v8 offset:49152
    ds_read_b64_tr_b16 v[146:147], v8 offset:51200
    s_waitcnt vmcnt(8)
    v_mfma_f32_16x16x32_bf16 v[192:195], v[108:111], v[160:163], v[192:195]
    ds_read_b64_tr_b16 v[148:149], v9 offset:49152
    ds_read_b64_tr_b16 v[150:151], v9 offset:51200
    v_mfma_f32_16x16x32_bf16 v[180:183], v[104:107], v[164:167], v[180:183]
    ds_read_b64_tr_b16 v[152:153], v10 offset:49152
    ds_read_b64_tr_b16 v[154:155], v10 offset:51200
    v_mfma_f32_16x16x32_bf16 v[196:199], v[108:111], v[164:167], v[196:199]
    ds_read_b64_tr_b16 v[156:157], v11 offset:49152
    ds_read_b64_tr_b16 v[158:159], v11 offset:51200
    v_mfma_f32_16x16x32_bf16 v[184:187], v[104:107], v[168:171], v[184:187]
    buffer_load_dwordx4 v[212:215], v1, s[40:43], s93 offen offset:0 sc1
    v_mfma_f32_16x16x32_bf16 v[200:203], v[108:111], v[168:171], v[200:203]
    s_add_u32 s92, s92, 17825792
    v_mfma_f32_16x16x32_bf16 v[188:191], v[104:107], v[172:175], v[188:191]
    s_lshl_b32 s66, s101, 11
    v_mfma_f32_16x16x32_bf16 v[204:207], v[108:111], v[172:175], v[204:207]
    buffer_load_dwordx4 v[216:219], v1, s[40:43], s93 offen offset:1024 sc1
    s_add_u32 s66, s66, s92
    s_waitcnt lgkmcnt(0) vmcnt(9)
    v_mfma_f32_16x16x32_bf16 v[176:179], v[112:115], v[144:147], v[176:179]
    ds_read_b64_tr_b16 v[160:161], v8 offset:53248
    ds_read_b64_tr_b16 v[162:163], v8 offset:55296
    s_waitcnt vmcnt(8)
    v_mfma_f32_16x16x32_bf16 v[192:195], v[116:119], v[144:147], v[192:195]
    ds_read_b64_tr_b16 v[164:165], v9 offset:53248
    ds_read_b64_tr_b16 v[166:167], v9 offset:55296
    v_mfma_f32_16x16x32_bf16 v[180:183], v[112:115], v[148:151], v[180:183]
    ds_read_b64_tr_b16 v[168:169], v10 offset:53248
    ds_read_b64_tr_b16 v[170:171], v10 offset:55296
    v_mfma_f32_16x16x32_bf16 v[196:199], v[116:119], v[148:151], v[196:199]
    ds_read_b64_tr_b16 v[172:173], v11 offset:53248
    ds_read_b64_tr_b16 v[174:175], v11 offset:55296
    v_mfma_f32_16x16x32_bf16 v[184:187], v[112:115], v[152:155], v[184:187]
    v_mfma_f32_16x16x32_bf16 v[200:203], v[116:119], v[152:155], v[200:203]
    buffer_load_dwordx4 v[220:223], v1, s[40:43], s93 offen offset:2048 sc1
    v_mfma_f32_16x16x32_bf16 v[188:191], v[112:115], v[156:159], v[188:191]
    v_mfma_f32_16x16x32_bf16 v[204:207], v[116:119], v[156:159], v[204:207]
    buffer_load_dwordx4 v[224:227], v1, s[40:43], s93 offen offset:3072 sc1
    s_waitcnt lgkmcnt(0) vmcnt(9)
    v_mfma_f32_16x16x32_bf16 v[176:179], v[120:123], v[160:163], v[176:179]
    ds_read_b64_tr_b16 v[144:145], v8 offset:57344
    ds_read_b64_tr_b16 v[146:147], v8 offset:59392
    s_waitcnt vmcnt(8)
    v_mfma_f32_16x16x32_bf16 v[192:195], v[124:127], v[160:163], v[192:195]
    ds_read_b64_tr_b16 v[148:149], v9 offset:57344
    ds_read_b64_tr_b16 v[150:151], v9 offset:59392
    v_mfma_f32_16x16x32_bf16 v[180:183], v[120:123], v[164:167], v[180:183]
    ds_read_b64_tr_b16 v[152:153], v10 offset:57344
    ds_read_b64_tr_b16 v[154:155], v10 offset:59392
    v_mfma_f32_16x16x32_bf16 v[196:199], v[124:127], v[164:167], v[196:199]
    ds_read_b64_tr_b16 v[156:157], v11 offset:57344
    ds_read_b64_tr_b16 v[158:159], v11 offset:59392
    v_mfma_f32_16x16x32_bf16 v[184:187], v[120:123], v[168:171], v[184:187]
    s_add_u32 m0, s71, 106496
    v_mfma_f32_16x16x32_bf16 v[200:203], v[124:127], v[168:171], v[200:203]
    s_add_u32 s60, s82, 1146880
    buffer_load_dwordx4 v241, s[20:23], s60 offen lds
    v_mfma_f32_16x16x32_bf16 v[188:191], v[120:123], v[172:175], v[188:191]
    s_add_u32 m0, s71, 110592
    v_mfma_f32_16x16x32_bf16 v[204:207], v[124:127], v[172:175], v[204:207]
    s_add_u32 s60, s82, 1261568
    buffer_load_dwordx4 v241, s[20:23], s60 offen lds
    s_waitcnt lgkmcnt(0) vmcnt(9)
    v_mfma_f32_16x16x32_bf16 v[176:179], v[128:131], v[144:147], v[176:179]
    ds_read_b64_tr_b16 v[160:161], v8 offset:61440
    ds_read_b64_tr_b16 v[162:163], v8 offset:63488
    s_waitcnt vmcnt(8)
    v_mfma_f32_16x16x32_bf16 v[192:195], v[132:135], v[144:147], v[192:195]
    ds_read_b64_tr_b16 v[164:165], v9 offset:61440
    ds_read_b64_tr_b16 v[166:167], v9 offset:63488
    v_mfma_f32_16x16x32_bf16 v[180:183], v[128:131], v[148:151], v[180:183]
    ds_read_b64_tr_b16 v[168:169], v10 offset:61440
    ds_read_b64_tr_b16 v[170:171], v10 offset:63488
    v_mfma_f32_16x16x32_bf16 v[196:199], v[132:135], v[148:151], v[196:199]
    ds_read_b64_tr_b16 v[172:173], v11 offset:61440
    ds_read_b64_tr_b16 v[174:175], v11 offset:63488
    v_mfma_f32_16x16x32_bf16 v[184:187], v[128:131], v[152:155], v[184:187]
    s_add_u32 m0, s71, 114688
    v_mfma_f32_16x16x32_bf16 v[200:203], v[132:135], v[152:155], v[200:203]
    s_add_u32 s60, s82, 1376256
    buffer_load_dwordx4 v241, s[20:23], s60 offen lds
    v_mfma_f32_16x16x32_bf16 v[188:191], v[128:131], v[156:159], v[188:191]
    s_add_u32 m0, s71, 118784
    v_mfma_f32_16x16x32_bf16 v[204:207], v[132:135], v[156:159], v[204:207]
    s_add_u32 s60, s82, 1490944
    buffer_load_dwordx4 v241, s[20:23], s60 offen lds
    s_waitcnt lgkmcnt(0) vmcnt(9)
    v_mfma_f32_16x16x32_bf16 v[176:179], v[136:139], v[160:163], v[176:179]
    s_add_u32 m0, s71, 122880
    s_waitcnt vmcnt(8)
    v_mfma_f32_16x16x32_bf16 v[192:195], v[140:143], v[160:163], v[192:195]
    v_mfma_f32_16x16x32_bf16 v[180:183], v[136:139], v[164:167], v[180:183]
    s_add_u32 s60, s82, 1605632
    v_mfma_f32_16x16x32_bf16 v[196:199], v[140:143], v[164:167], v[196:199]
    buffer_load_dwordx4 v241, s[20:23], s60 offen lds
    v_mfma_f32_16x16x32_bf16 v[184:187], v[136:139], v[168:171], v[184:187]
    s_add_u32 m0, s71, 126976
    v_mfma_f32_16x16x32_bf16 v[200:203], v[140:143], v[168:171], v[200:203]
    v_mfma_f32_16x16x32_bf16 v[188:191], v[136:139], v[172:175], v[188:191]
    s_add_u32 s60, s82, 1720320
    v_mfma_f32_16x16x32_bf16 v[204:207], v[140:143], v[172:175], v[204:207]
    buffer_load_dwordx4 v241, s[20:23], s60 offen lds
    v_lshlrev_b32 v5, 7, v0
    s_mov_b64 exec, 0xf
    buffer_load_dword a234, v5, s[40:43], s66 offen
    s_mov_b64 exec, -1
    s_waitcnt vmcnt(10)
    v_pk_add_f32 v[212:213], v[212:213], v[214:215]
    s_waitcnt vmcnt(9)
    v_pk_add_f32 v[216:217], v[216:217], v[218:219]
    s_waitcnt vmcnt(8)
    v_pk_add_f32 v[220:221], v[220:221], v[222:223]
    s_waitcnt vmcnt(7)
    v_pk_add_f32 v[224:225], v[224:225], v[226:227]
    v_pk_add_f32 v[212:213], v[212:213], v[216:217]
    v_pk_add_f32 v[220:221], v[220:221], v[224:225]
    s_barrier
    v_mov_b32 v144, v212
    v_mov_b32 v145, v213
    v_mov_b32 v146, v220
    v_mov_b32 v147, v221
    v_permlane32_swap_b32 v144, v212
    v_permlane32_swap_b32 v145, v213
    v_permlane32_swap_b32 v146, v220
    v_permlane32_swap_b32 v147, v221
    v_add_f32 v212, v212, v144
    v_add_f32 v213, v213, v145
    v_add_f32 v220, v220, v146
    v_add_f32 v221, v221, v147
    v_mov_b32 v144, v212
    v_mov_b32 v145, v213
    v_mov_b32 v146, v220
    v_mov_b32 v147, v221
    v_permlane16_swap_b32 v144, v212
    v_permlane16_swap_b32 v145, v213
    v_permlane16_swap_b32 v146, v220
    v_permlane16_swap_b32 v147, v221
    v_add_f32 v212, v212, v144
    v_add_f32 v213, v213, v145
    v_add_f32 v220, v220, v146
    v_add_f32 v221, v221, v147
    v_mul_f32 v212, 0xbb000000, v212
    v_mul_f32 v220, 0xbb000000, v220
    v_mul_f32 v213, 0x3b000000, v213
    v_mul_f32 v221, 0x3b000000, v221
    v_fma_f32 v213, -v212, v212, v213
    v_fma_f32 v221, -v220, v220, v221
    v_max_f32 v213, 0, v213
    v_max_f32 v221, 0, v221
    v_add_f32 v213, 0x3727c5ac, v213
    v_add_f32 v221, 0x3727c5ac, v221
    v_rsq_f32 v208, v213
    v_rsq_f32 v210, v221
    v_mul_f32 v209, v212, v208
    v_mul_f32 v211, v220, v210
    ds_write_b32 v13, v208 offset:0
    ds_write_b32 v13, v209 offset:128
    ds_write_b32 v13, v210 offset:64
    ds_write_b32 v13, v211 offset:192
    s_add_u32 m0, s97, 0
    s_add_u32 s60, s96, 0
    buffer_load_dwordx4 v244, s[24:27], s60 offen lds
    s_add_u32 m0, s97, 1024
    s_nop 0
    buffer_load_dwordx4 v245, s[24:27], s60 offen lds
    s_waitcnt lgkmcnt(0)
    ds_read_b128 v[144:147], v14 offset:0
    ds_read_b128 v[152:155], v14 offset:128
    ds_read_b128 v[148:151], v14 offset:64
    ds_read_b128 v[156:159], v14 offset:192
    s_add_u32 m0, s97, 2048
    s_add_u32 s60, s96, 65536
    buffer_load_dwordx4 v244, s[24:27], s60 offen lds
    s_add_u32 m0, s97, 3072
    s_nop 0
    buffer_load_dwordx4 v245, s[24:27], s60 offen lds
    s_waitcnt lgkmcnt(2)
    v_pk_mul_f32 v[160:161], v[152:153], v[228:229] op_sel:[0,0] op_sel_hi:[1,0]
    v_pk_mul_f32 v[162:163], v[154:155], v[228:229] op_sel:[0,0] op_sel_hi:[1,0]
    s_waitcnt lgkmcnt(0)
    v_pk_mul_f32 v[164:165], v[156:157], v[228:229] op_sel:[0,0] op_sel_hi:[1,0]
    s_add_u32 m0, s97, 4096
    s_add_u32 s60, s96, 131072
    buffer_load_dwordx4 v244, s[24:27], s60 offen lds
    v_pk_mul_f32 v[166:167], v[158:159], v[228:229] op_sel:[0,0] op_sel_hi:[1,0]
    v_pk_fma_f32 v[176:177], v[176:177], v[144:145], v[160:161]
    v_pk_fma_f32 v[178:179], v[178:179], v[146:147], v[162:163]
    v_pk_fma_f32 v[192:193], v[192:193], v[148:149], v[164:165]
    v_pk_fma_f32 v[194:195], v[194:195], v[150:151], v[166:167]
    v_pk_mul_f32 v[160:161], v[176:177], v[176:177]
    v_pk_mul_f32 v[162:163], v[178:179], v[178:179]
    s_add_u32 m0, s97, 5120
    s_nop 0
    buffer_load_dwordx4 v245, s[24:27], s60 offen lds
    v_pk_mul_f32 v[164:165], v[192:193], v[192:193]
    v_pk_mul_f32 v[166:167], v[194:195], v[194:195]
    v_pk_fma_f32 v[160:161], v[160:161], s[56:57], v[254:255]
    v_pk_fma_f32 v[162:163], v[162:163], s[56:57], v[254:255]
    v_pk_fma_f32 v[164:165], v[164:165], s[56:57], v[254:255]
    v_pk_fma_f32 v[166:167], v[166:167], s[56:57], v[254:255]
    v_pk_mul_f32 v[160:161], v[160:161], v[176:177]
    s_add_u32 m0, s97, 6144
    s_add_u32 s60, s96, 196608
    buffer_load_dwordx4 v244, s[24:27], s60 offen lds
    v_pk_mul_f32 v[162:163], v[162:163], v[178:179]
    v_pk_mul_f32 v[164:165], v[164:165], v[192:193]
    v_pk_mul_f32 v[166:167], v[166:167], v[194:195]
    v_exp_f32 v160, v160
    v_exp_f32 v162, v162
    v_exp_f32 v164, v164
    v_exp_f32 v166, v166
    s_add_u32 m0, s97, 7168
    s_nop 0
    buffer_load_dwordx4 v245, s[24:27], s60 offen lds
    v_exp_f32 v161, v161
    v_exp_f32 v163, v163
    v_exp_f32 v165, v165
    v_exp_f32 v167, v167
    v_pk_add_f32 v[160:161], v[160:161], s[58:59]
    v_pk_add_f32 v[162:163], v[162:163], s[58:59]
    v_pk_add_f32 v[164:165], v[164:165], s[58:59]
    v_pk_add_f32 v[166:167], v[166:167], s[58:59]
    v_rcp_f32 v160, v160
    v_rcp_f32 v162, v162
    v_rcp_f32 v164, v164
    v_rcp_f32 v166, v166
    v_rcp_f32 v161, v161
    v_rcp_f32 v163, v163
    v_rcp_f32 v165, v165
    v_rcp_f32 v167, v167
    v_pk_mul_f32 v[176:177], v[176:177], v[160:161]
    v_pk_mul_f32 v[178:179], v[178:179], v[162:163]
    v_pk_mul_f32 v[192:193], v[192:193], v[164:165]
    v_pk_mul_f32 v[194:195], v[194:195], v[166:167]
    s_add_u32 m0, s97, 8192
    s_add_u32 s60, s96, 128
    buffer_load_dwordx4 v244, s[24:27], s60 offen lds
    v_pk_mul_f32 v[220:221], v[176:177], v[176:177]
    v_pk_mul_f32 v[222:223], v[178:179], v[178:179]
    v_pk_mul_f32 v[224:225], v[192:193], v[192:193]
    v_pk_mul_f32 v[226:227], v[194:195], v[194:195]
    v_pk_mul_f32 v[160:161], v[152:153], v[228:229] op_sel:[0,1] op_sel_hi:[1,1]
    v_pk_mul_f32 v[162:163], v[154:155], v[228:229] op_sel:[0,1] op_sel_hi:[1,1]
    v_pk_mul_f32 v[164:165], v[156:157], v[228:229] op_sel:[0,1] op_sel_hi:[1,1]
    s_add_u32 m0, s97, 9216
    s_nop 0
    buffer_load_dwordx4 v245, s[24:27], s60 offen lds
    v_pk_mul_f32 v[166:167], v[158:159], v[228:229] op_sel:[0,1] op_sel_hi:[1,1]
    v_pk_fma_f32 v[180:181], v[180:181], v[144:145], v[160:161]
    v_pk_fma_f32 v[182:183], v[182:183], v[146:147], v[162:163]
    v_pk_fma_f32 v[196:197], v[196:197], v[148:149], v[164:165]
    v_pk_fma_f32 v[198:199], v[198:199], v[150:151], v[166:167]
    v_pk_mul_f32 v[160:161], v[180:181], v[180:181]
    v_pk_mul_f32 v[162:163], v[182:183], v[182:183]
    v_pk_mul_f32 v[164:165], v[196:197], v[196:197]
    s_add_u32 m0, s97, 10240
    s_add_u32 s60, s96, 65664
    buffer_load_dwordx4 v244, s[24:27], s60 offen lds
    v_pk_mul_f32 v[166:167], v[198:199], v[198:199]
    v_pk_fma_f32 v[160:161], v[160:161], s[56:57], v[254:255]
    v_pk_fma_f32 v[162:163], v[162:163], s[56:57], v[254:255]
    v_pk_fma_f32 v[164:165], v[164:165], s[56:57], v[254:255]
    v_pk_fma_f32 v[166:167], v[166:167], s[56:57], v[254:255]
    v_pk_mul_f32 v[160:161], v[160:161], v[180:181]
    v_pk_mul_f32 v[162:163], v[162:163], v[182:183]
    s_add_u32 m0, s97, 11264
    s_nop 0
    buffer_load_dwordx4 v245, s[24:27], s60 offen lds
    v_pk_mul_f32 v[164:165], v[164:165], v[196:197]
    v_pk_mul_f32 v[166:167], v[166:167], v[198:199]
    v_exp_f32 v160, v160
    v_exp_f32 v162, v162
    v_exp_f32 v164, v164
    v_exp_f32 v166, v166
    v_exp_f32 v161, v161
    v_exp_f32 v163, v163
    s_add_u32 m0, s97, 12288
    s_add_u32 s60, s96, 131200
    buffer_load_dwordx4 v244, s[24:27], s60 offen lds
    v_exp_f32 v165, v165
    v_exp_f32 v167, v167
    v_pk_add_f32 v[160:161], v[160:161], s[58:59]
    v_pk_add_f32 v[162:163], v[162:163], s[58:59]
    v_pk_add_f32 v[164:165], v[164:165], s[58:59]
    v_pk_add_f32 v[166:167], v[166:167], s[58:59]
    v_rcp_f32 v160, v160
    s_add_u32 m0, s97, 13312
    s_nop 0
    buffer_load_dwordx4 v245, s[24:27], s60 offen lds
    v_rcp_f32 v162, v162
    v_rcp_f32 v164, v164
    v_rcp_f32 v166, v166
    v_rcp_f32 v161, v161
    v_rcp_f32 v163, v163
    v_rcp_f32 v165, v165
    v_rcp_f32 v167, v167
    s_add_u32 m0, s97, 14336
    s_add_u32 s60, s96, 196736
    buffer_load_dwordx4 v244, s[24:27], s60 offen lds
    v_pk_mul_f32 v[180:181], v[180:181], v[160:161]
    v_pk_mul_f32 v[182:183], v[182:183], v[162:163]
    v_pk_mul_f32 v[196:197], v[196:197], v[164:165]
    v_pk_mul_f32 v[198:199], v[198:199], v[166:167]
    v_pk_fma_f32 v[220:221], v[180:181], v[180:181], v[220:221]
    v_pk_fma_f32 v[222:223], v[182:183], v[182:183], v[222:223]
    v_pk_fma_f32 v[224:225], v[196:197], v[196:197], v[224:225]
    v_pk_fma_f32 v[226:227], v[198:199], v[198:199], v[226:227]
    s_add_u32 m0, s97, 15360
    s_nop 0
    buffer_load_dwordx4 v245, s[24:27], s60 offen lds
    v_pk_add_f32 v[212:213], v[176:177], v[180:181]
    v_pk_add_f32 v[214:215], v[178:179], v[182:183]
    v_pk_add_f32 v[216:217], v[192:193], v[196:197]
    v_pk_add_f32 v[218:219], v[194:195], v[198:199]
    v_pk_mul_f32 v[160:161], v[152:153], v[230:231] op_sel:[0,0] op_sel_hi:[1,0]
    v_pk_mul_f32 v[162:163], v[154:155], v[230:231] op_sel:[0,0] op_sel_hi:[1,0]
    v_pk_mul_f32 v[164:165], v[156:157], v[230:231] op_sel:[0,0] op_sel_hi:[1,0]
    v_pk_mul_f32 v[166:167], v[158:159], v[230:231] op_sel:[0,0] op_sel_hi:[1,0]
    v_pk_fma_f32 v[184:185], v[184:185], v[144:145], v[160:161]
    v_pk_fma_f32 v[186:187], v[186:187], v[146:147], v[162:163]
    s_add_u32 m0, s69, 86016
    s_add_u32 s61, s68, 688128
    buffer_load_dwordx4 v242, s[32:35], s61 offen lds
    v_pk_fma_f32 v[200:201], v[200:201], v[148:149], v[164:165]
    v_pk_fma_f32 v[202:203], v[202:203], v[150:151], v[166:167]
    v_pk_mul_f32 v[160:161], v[184:185], v[184:185]
    v_pk_mul_f32 v[162:163], v[186:187], v[186:187]
    v_pk_mul_f32 v[164:165], v[200:201], v[200:201]
    v_pk_mul_f32 v[166:167], v[202:203], v[202:203]
    v_pk_fma_f32 v[160:161], v[160:161], s[56:57], v[254:255]
    v_pk_fma_f32 v[162:163], v[162:163], s[56:57], v[254:255]
    v_pk_fma_f32 v[164:165], v[164:165], s[56:57], v[254:255]
    v_pk_fma_f32 v[166:167], v[166:167], s[56:57], v[254:255]
    v_pk_mul_f32 v[160:161], v[160:161], v[184:185]
    v_pk_mul_f32 v[162:163], v[162:163], v[186:187]
    v_pk_mul_f32 v[164:165], v[164:165], v[200:201]
    s_add_u32 m0, s69, 90112
    s_add_u32 s61, s68, 720896
    buffer_load_dwordx4 v242, s[32:35], s61 offen lds
    v_pk_mul_f32 v[166:167], v[166:167], v[202:203]
    v_exp_f32 v160, v160
    v_exp_f32 v162, v162
    v_exp_f32 v164, v164
    v_exp_f32 v166, v166
    v_exp_f32 v161, v161
    v_exp_f32 v163, v163
    v_exp_f32 v165, v165
    v_exp_f32 v167, v167
    v_pk_add_f32 v[160:161], v[160:161], s[58:59]
    v_pk_add_f32 v[162:163], v[162:163], s[58:59]
    v_pk_add_f32 v[164:165], v[164:165], s[58:59]
    v_pk_add_f32 v[166:167], v[166:167], s[58:59]
    s_add_u32 m0, s69, 94208
    s_add_u32 s61, s68, 753664
    buffer_load_dwordx4 v242, s[32:35], s61 offen lds
    v_rcp_f32 v160, v160
    v_rcp_f32 v162, v162
    v_rcp_f32 v164, v164
    v_rcp_f32 v166, v166
    v_rcp_f32 v161, v161
    v_rcp_f32 v163, v163
    v_rcp_f32 v165, v165
    v_rcp_f32 v167, v167
    v_pk_mul_f32 v[184:185], v[184:185], v[160:161]
    v_pk_mul_f32 v[186:187], v[186:187], v[162:163]
    v_pk_mul_f32 v[200:201], v[200:201], v[164:165]
    v_pk_mul_f32 v[202:203], v[202:203], v[166:167]
    v_pk_fma_f32 v[220:221], v[184:185], v[184:185], v[220:221]
    s_add_u32 m0, s69, 98304
    s_add_u32 s61, s68, 786432
    buffer_load_dwordx4 v242, s[32:35], s61 offen lds
    v_pk_fma_f32 v[222:223], v[186:187], v[186:187], v[222:223]
    v_pk_fma_f32 v[224:225], v[200:201], v[200:201], v[224:225]
    v_pk_fma_f32 v[226:227], v[202:203], v[202:203], v[226:227]
    v_pk_add_f32 v[212:213], v[212:213], v[184:185]
    v_pk_add_f32 v[214:215], v[214:215], v[186:187]
    v_pk_add_f32 v[216:217], v[216:217], v[200:201]
    v_pk_add_f32 v[218:219], v[218:219], v[202:203]
    v_pk_mul_f32 v[160:161], v[152:153], v[230:231] op_sel:[0,1] op_sel_hi:[1,1]
    v_pk_mul_f32 v[162:163], v[154:155], v[230:231] op_sel:[0,1] op_sel_hi:[1,1]
    v_pk_mul_f32 v[164:165], v[156:157], v[230:231] op_sel:[0,1] op_sel_hi:[1,1]
    v_pk_mul_f32 v[166:167], v[158:159], v[230:231] op_sel:[0,1] op_sel_hi:[1,1]
    v_pk_fma_f32 v[188:189], v[188:189], v[144:145], v[160:161]
    v_pk_fma_f32 v[190:191], v[190:191], v[146:147], v[162:163]
    v_pk_fma_f32 v[204:205], v[204:205], v[148:149], v[164:165]
    v_pk_fma_f32 v[206:207], v[206:207], v[150:151], v[166:167]
    s_add_u32 m0, s69, 102400
    s_add_u32 s61, s68, 819200
    buffer_load_dwordx4 v242, s[32:35], s61 offen lds
    v_pk_mul_f32 v[160:161], v[188:189], v[188:189]
    v_pk_mul_f32 v[162:163], v[190:191], v[190:191]
    v_pk_mul_f32 v[164:165], v[204:205], v[204:205]
    v_pk_mul_f32 v[166:167], v[206:207], v[206:207]
    v_pk_fma_f32 v[160:161], v[160:161], s[56:57], v[254:255]
    v_pk_fma_f32 v[162:163], v[162:163], s[56:57], v[254:255]
    v_pk_fma_f32 v[164:165], v[164:165], s[56:57], v[254:255]
    v_pk_fma_f32 v[166:167], v[166:167], s[56:57], v[254:255]
    v_pk_mul_f32 v[160:161], v[160:161], v[188:189]
    v_pk_mul_f32 v[162:163], v[162:163], v[190:191]
    v_pk_mul_f32 v[164:165], v[164:165], v[204:205]
    v_pk_mul_f32 v[166:167], v[166:167], v[206:207]
    v_exp_f32 v160, v160
    v_exp_f32 v162, v162
    v_exp_f32 v164, v164
    v_exp_f32 v166, v166
    v_exp_f32 v161, v161
    v_exp_f32 v163, v163
    s_add_u32 m0, s69, 106496
    s_add_u32 s61, s68, 851968
    buffer_load_dwordx4 v242, s[32:35], s61 offen lds
    v_exp_f32 v165, v165
    v_exp_f32 v167, v167
    v_pk_add_f32 v[160:161], v[160:161], s[58:59]
    v_pk_add_f32 v[162:163], v[162:163], s[58:59]
    v_pk_add_f32 v[164:165], v[164:165], s[58:59]
    v_pk_add_f32 v[166:167], v[166:167], s[58:59]
    v_rcp_f32 v160, v160
    v_rcp_f32 v162, v162
    v_rcp_f32 v164, v164
    v_rcp_f32 v166, v166
    v_rcp_f32 v161, v161
    v_rcp_f32 v163, v163
    v_rcp_f32 v165, v165
    v_rcp_f32 v167, v167
    v_pk_mul_f32 v[188:189], v[188:189], v[160:161]
    v_pk_mul_f32 v[190:191], v[190:191], v[162:163]
    v_pk_mul_f32 v[204:205], v[204:205], v[164:165]
    s_add_u32 m0, s69, 110592
    s_add_u32 s61, s68, 884736
    buffer_load_dwordx4 v242, s[32:35], s61 offen lds
    v_pk_mul_f32 v[206:207], v[206:207], v[166:167]
    v_pk_fma_f32 v[220:221], v[188:189], v[188:189], v[220:221]
    v_pk_fma_f32 v[222:223], v[190:191], v[190:191], v[222:223]
    v_pk_fma_f32 v[224:225], v[204:205], v[204:205], v[224:225]
    v_pk_fma_f32 v[226:227], v[206:207], v[206:207], v[226:227]
    v_pk_add_f32 v[212:213], v[212:213], v[188:189]
    v_pk_add_f32 v[214:215], v[214:215], v[190:191]
    v_pk_add_f32 v[216:217], v[216:217], v[204:205]
    v_pk_add_f32 v[218:219], v[218:219], v[206:207]
    v_add_f32_dpp v228, v212, v212 row_ror:8 row_mask:0xf bank_mask:0x3
    v_add_f32_dpp v229, v220, v220 row_ror:8 row_mask:0xf bank_mask:0x3
    v_add_f32_dpp v230, v213, v213 row_ror:8 row_mask:0xf bank_mask:0x3
    v_add_f32_dpp v231, v221, v221 row_ror:8 row_mask:0xf bank_mask:0x3
    v_add_f32_dpp v232, v214, v214 row_ror:8 row_mask:0xf bank_mask:0x3
    v_add_f32_dpp v233, v222, v222 row_ror:8 row_mask:0xf bank_mask:0x3
    v_add_f32_dpp v234, v215, v215 row_ror:8 row_mask:0xf bank_mask:0x3
    v_add_f32_dpp v235, v223, v223 row_ror:8 row_mask:0xf bank_mask:0x3
    v_add_f32_dpp v228, v216, v216 row_ror:8 row_mask:0xf bank_mask:0xc
    v_add_f32_dpp v229, v224, v224 row_ror:8 row_mask:0xf bank_mask:0xc
    v_add_f32_dpp v230, v217, v217 row_ror:8 row_mask:0xf bank_mask:0xc
    v_add_f32_dpp v231, v225, v225 row_ror:8 row_mask:0xf bank_mask:0xc
    v_add_f32_dpp v232, v218, v218 row_ror:8 row_mask:0xf bank_mask:0xc
    v_add_f32_dpp v233, v226, v226 row_ror:8 row_mask:0xf bank_mask:0xc
    v_add_f32_dpp v234, v219, v219 row_ror:8 row_mask:0xf bank_mask:0xc
    v_add_f32_dpp v235, v227, v227 row_ror:8 row_mask:0xf bank_mask:0xc
    v_add_u32 v8, 65536, v8
    v_add_u32 v9, 65536, v9
    v_add_u32 v10, 65536, v10
    v_add_u32 v11, 65536, v11
    v_add_u32 v15, 65536, v15
    s_waitcnt vmcnt(24)
    v_add_f32_dpp v236, v228, v228 row_half_mirror row_mask:0xf bank_mask:0x5
    v_add_f32_dpp v237, v229, v229 row_half_mirror row_mask:0xf bank_mask:0x5
    v_add_f32_dpp v238, v230, v230 row_half_mirror row_mask:0xf bank_mask:0x5
    v_add_f32_dpp v239, v231, v231 row_half_mirror row_mask:0xf bank_mask:0x5
    v_add_f32_dpp v236, v232, v232 row_half_mirror row_mask:0xf bank_mask:0xa
    v_add_f32_dpp v237, v233, v233 row_half_mirror row_mask:0xf bank_mask:0xa
    v_add_f32_dpp v238, v234, v234 row_half_mirror row_mask:0xf bank_mask:0xa
    v_add_f32_dpp v239, v235, v235 row_half_mirror row_mask:0xf bank_mask:0xa
    s_barrier
    v_add_f32_dpp v236, v236, v236 quad_perm:[1,0,3,2] row_mask:0xf bank_mask:0xf
    v_add_f32_dpp v237, v237, v237 quad_perm:[1,0,3,2] row_mask:0xf bank_mask:0xf
    v_add_f32_dpp v238, v238, v238 quad_perm:[1,0,3,2] row_mask:0xf bank_mask:0xf
    v_add_f32_dpp v239, v239, v239 quad_perm:[1,0,3,2] row_mask:0xf bank_mask:0xf
    v_add_f32_dpp v236, v236, v236 quad_perm:[2,3,0,1] row_mask:0xf bank_mask:0xf
    v_add_f32_dpp v237, v237, v237 quad_perm:[2,3,0,1] row_mask:0xf bank_mask:0xf
    v_add_f32_dpp v238, v238, v238 quad_perm:[2,3,0,1] row_mask:0xf bank_mask:0xf
    v_add_f32_dpp v239, v239, v239 quad_perm:[2,3,0,1] row_mask:0xf bank_mask:0xf
    ds_read_b64_tr_b16 v[144:145], v8 offset:0
    ds_read_b64_tr_b16 v[146:147], v8 offset:2048
    ds_read_b64_tr_b16 v[148:149], v9 offset:0
    ds_read_b64_tr_b16 v[150:151], v9 offset:2048
    ds_read_b64_tr_b16 v[152:153], v10 offset:0
    ds_read_b64_tr_b16 v[154:155], v10 offset:2048
    ds_read_b64_tr_b16 v[156:157], v11 offset:0
    ds_read_b64_tr_b16 v[158:159], v11 offset:2048
    v_cndmask_b32 v236, v236, v238, s[72:73]
    v_cndmask_b32 v237, v237, v239, s[72:73]
    v_mov_b32 v238, s4
    v_mov_b32 v239, s4
    s_mov_b32 exec_lo, 0x33333333
    s_mov_b32 exec_hi, 0x33333333
    s_cmp_eq_u32 s6, 0
    s_cbranch_scc1 La25
    buffer_store_dwordx4 v[236:239], v12, s[40:43], s66 offen
    s_branch Lb25
La25:
    buffer_store_dwordx4 v[236:239], v12, s[40:43], s66 offen sc1
Lb25:
    s_mov_b64 exec, -1
    s_waitcnt lgkmcnt(0)
    v_mfma_f32_16x16x32_bf16 v[212:215], v[144:147], v[16:19], 0
    ds_read_b64_tr_b16 v[160:161], v8 offset:4096
    ds_read_b64_tr_b16 v[162:163], v8 offset:6144
    v_mfma_f32_16x16x32_bf16 v[228:231], v[144:147], v[20:23], 0
    ds_read_b64_tr_b16 v[164:165], v9 offset:4096
    ds_read_b64_tr_b16 v[166:167], v9 offset:6144
    v_mfma_f32_16x16x32_bf16 v[216:219], v[148:151], v[16:19], 0
    ds_read_b64_tr_b16 v[168:169], v10 offset:4096
    ds_read_b64_tr_b16 v[170:171], v10 offset:6144
    v_mfma_f32_16x16x32_bf16 v[232:235], v[148:151], v[20:23], 0
    ds_read_b64_tr_b16 v[172:173], v11 offset:4096
    ds_read_b64_tr_b16 v[174:175], v11 offset:6144
    v_mfma_f32_16x16x32_bf16 v[220:223], v[152:155], v[16:19], 0
    v_lshrrev_b32 v12, 5, v0
    v_lshlrev_b32 v12, 11, v12
    v_mfma_f32_16x16x32_bf16 v[236:239], v[152:155], v[20:23], 0
    v_and_b32 v13, 31, v0
    v_lshl_add_u32 v12, v13, 4, v12
    v_mfma_f32_16x16x32_bf16 v[224:227], v[156:159], v[16:19], 0
    v_lshl_add_u32 v13, v13, 2, s91
    s_lshl_b32 s93, s100, 2
    v_mfma_f32_16x16x32_bf16 v[240:243], v[156:159], v[20:23], 0
    s_add_u32 s93, s93, s50
    s_mul_i32 s93, s93, 7168
    s_add_u32 s93, s93, 5242880
    s_waitcnt lgkmcnt(0)
    v_mfma_f32_16x16x32_bf16 v[212:215], v[160:163], v[24:27], v[212:215]
    ds_read_b64_tr_b16 v[144:145], v8 offset:8192
    ds_read_b64_tr_b16 v[146:147], v8 offset:10240
    v_mfma_f32_16x16x32_bf16 v[228:231], v[160:163], v[28:31], v[228:231]
    ds_read_b64_tr_b16 v[148:149], v9 offset:8192
    ds_read_b64_tr_b16 v[150:151], v9 offset:10240
    v_mfma_f32_16x16x32_bf16 v[216:219], v[164:167], v[24:27], v[216:219]
    ds_read_b64_tr_b16 v[152:153], v10 offset:8192
    ds_read_b64_tr_b16 v[154:155], v10 offset:10240
    v_mfma_f32_16x16x32_bf16 v[232:235], v[164:167], v[28:31], v[232:235]
    ds_read_b64_tr_b16 v[156:157], v11 offset:8192
    ds_read_b64_tr_b16 v[158:159], v11 offset:10240
    v_mfma_f32_16x16x32_bf16 v[220:223], v[168:171], v[24:27], v[220:223]
    s_waitcnt vmcnt(16)
    ds_read_b128 a[0:3], v246 offset:0
    v_mfma_f32_16x16x32_bf16 v[236:239], v[168:171], v[28:31], v[236:239]
    ds_read_b128 a[4:7], v248 offset:0
    ds_read_b128 a[8:11], v250 offset:0
    v_mfma_f32_16x16x32_bf16 v[224:227], v[172:175], v[24:27], v[224:227]
    ds_read_b128 a[12:15], v252 offset:0
    ds_read_b128 a[16:19], v247 offset:0
    v_mfma_f32_16x16x32_bf16 v[240:243], v[172:175], v[28:31], v[240:243]
    ds_read_b128 a[20:23], v249 offset:0
    ds_read_b128 a[24:27], v251 offset:0
    ds_read_b128 a[28:31], v253 offset:0
    s_waitcnt lgkmcnt(0)
    v_mfma_f32_16x16x32_bf16 v[212:215], v[144:147], v[32:35], v[212:215]
    ds_read_b64_tr_b16 v[160:161], v8 offset:12288
    ds_read_b64_tr_b16 v[162:163], v8 offset:14336
    v_mfma_f32_16x16x32_bf16 v[228:231], v[144:147], v[36:39], v[228:231]
    ds_read_b64_tr_b16 v[164:165], v9 offset:12288
    ds_read_b64_tr_b16 v[166:167], v9 offset:14336
    v_mfma_f32_16x16x32_bf16 v[216:219], v[148:151], v[32:35], v[216:219]
    ds_read_b64_tr_b16 v[168:169], v10 offset:12288
    ds_read_b64_tr_b16 v[170:171], v10 offset:14336
    v_mfma_f32_16x16x32_bf16 v[232:235], v[148:151], v[36:39], v[232:235]
    ds_read_b64_tr_b16 v[172:173], v11 offset:12288
    ds_read_b64_tr_b16 v[174:175], v11 offset:14336
    v_mfma_f32_16x16x32_bf16 v[220:223], v[152:155], v[32:35], v[220:223]
    s_waitcnt vmcnt(8)
    ds_read_b128 a[32:35], v246 offset:8192
    v_mfma_f32_16x16x32_bf16 v[236:239], v[152:155], v[36:39], v[236:239]
    ds_read_b128 a[36:39], v248 offset:8192
    ds_read_b128 a[40:43], v250 offset:8192
    v_mfma_f32_16x16x32_bf16 v[224:227], v[156:159], v[32:35], v[224:227]
    ds_read_b128 a[44:47], v252 offset:8192
    ds_read_b128 a[48:51], v247 offset:8192
    v_mfma_f32_16x16x32_bf16 v[240:243], v[156:159], v[36:39], v[240:243]
    ds_read_b128 a[52:55], v249 offset:8192
    ds_read_b128 a[56:59], v251 offset:8192
    ds_read_b128 a[60:63], v253 offset:8192
    s_waitcnt lgkmcnt(0)
    v_mfma_f32_16x16x32_bf16 v[212:215], v[160:163], v[40:43], v[212:215]
    ds_read_b64_tr_b16 v[144:145], v8 offset:16384
    ds_read_b64_tr_b16 v[146:147], v8 offset:18432
    v_mfma_f32_16x16x32_bf16 v[228:231], v[160:163], v[44:47], v[228:231]
    ds_read_b64_tr_b16 v[148:149], v9 offset:16384
    ds_read_b64_tr_b16 v[150:151], v9 offset:18432
    v_mfma_f32_16x16x32_bf16 v[216:219], v[164:167], v[40:43], v[216:219]
    ds_read_b64_tr_b16 v[152:153], v10 offset:16384
    ds_read_b64_tr_b16 v[154:155], v10 offset:18432
    v_mfma_f32_16x16x32_bf16 v[232:235], v[164:167], v[44:47], v[232:235]
    ds_read_b64_tr_b16 v[156:157], v11 offset:16384
    ds_read_b64_tr_b16 v[158:159], v11 offset:18432
    v_mfma_f32_16x16x32_bf16 v[220:223], v[168:171], v[40:43], v[220:223]
    s_lshl_b32 s86, s101, 2
    s_add_u32 s86, s86, 0
    v_mfma_f32_16x16x32_bf16 v[236:239], v[168:171], v[44:47], v[236:239]
    s_mul_i32 s87, s86, 37
    s_lshr_b32 s87, s87, 8
    v_mfma_f32_16x16x32_bf16 v[224:227], v[172:175], v[40:43], v[224:227]
    s_mul_i32 s87, s87, 441
    s_add_u32 s86, s86, s87
    v_mfma_f32_16x16x32_bf16 v[240:243], v[172:175], v[44:47], v[240:243]
    s_lshl_b32 s86, s86, 10
    s_add_u32 s64, s86, s93
    s_lshl_b32 s86, s101, 2
    s_waitcnt lgkmcnt(0)
    v_mfma_f32_16x16x32_bf16 v[212:215], v[144:147], v[48:51], v[212:215]
    ds_read_b64_tr_b16 v[160:161], v8 offset:20480
    ds_read_b64_tr_b16 v[162:163], v8 offset:22528
    v_mfma_f32_16x16x32_bf16 v[228:231], v[144:147], v[52:55], v[228:231]
    ds_read_b64_tr_b16 v[164:165], v9 offset:20480
    ds_read_b64_tr_b16 v[166:167], v9 offset:22528
    v_mfma_f32_16x16x32_bf16 v[216:219], v[148:151], v[48:51], v[216:219]
    ds_read_b64_tr_b16 v[168:169], v10 offset:20480
    ds_read_b64_tr_b16 v[170:171], v10 offset:22528
    v_mfma_f32_16x16x32_bf16 v[232:235], v[148:151], v[52:55], v[232:235]
    ds_read_b64_tr_b16 v[172:173], v11 offset:20480
    ds_read_b64_tr_b16 v[174:175], v11 offset:22528
    v_mfma_f32_16x16x32_bf16 v[220:223], v[152:155], v[48:51], v[220:223]
    s_add_u32 s60, s92, 0
    buffer_load_dwordx4 v[16:19], v12, s[40:43], s60 offen sc1
    s_add_u32 s60, s92, 4096
    v_mfma_f32_16x16x32_bf16 v[236:239], v[152:155], v[52:55], v[236:239]
    buffer_load_dwordx4 v[20:23], v12, s[40:43], s60 offen sc1
    s_add_u32 s60, s92, 8192
    buffer_load_dwordx4 v[24:27], v12, s[40:43], s60 offen sc1
    s_add_u32 s60, s92, 12288
    v_mfma_f32_16x16x32_bf16 v[224:227], v[156:159], v[48:51], v[224:227]
    buffer_load_dwordx4 v[28:31], v12, s[40:43], s60 offen sc1
    s_add_u32 s60, s92, 16384
    buffer_load_dwordx4 v[32:35], v12, s[40:43], s60 offen sc1
    v_mfma_f32_16x16x32_bf16 v[240:243], v[156:159], v[52:55], v[240:243]
    s_add_u32 s60, s92, 20480
    buffer_load_dwordx4 v[36:39], v12, s[40:43], s60 offen sc1
    s_add_u32 s60, s92, 24576
    buffer_load_dwordx4 v[40:43], v12, s[40:43], s60 offen sc1
    s_waitcnt lgkmcnt(0)
    v_mfma_f32_16x16x32_bf16 v[212:215], v[160:163], v[56:59], v[212:215]
    ds_read_b64_tr_b16 v[144:145], v8 offset:24576
    ds_read_b64_tr_b16 v[146:147], v8 offset:26624
    v_mfma_f32_16x16x32_bf16 v[228:231], v[160:163], v[60:63], v[228:231]
    ds_read_b64_tr_b16 v[148:149], v9 offset:24576
    ds_read_b64_tr_b16 v[150:151], v9 offset:26624
    v_mfma_f32_16x16x32_bf16 v[216:219], v[164:167], v[56:59], v[216:219]
    ds_read_b64_tr_b16 v[152:153], v10 offset:24576
    ds_read_b64_tr_b16 v[154:155], v10 offset:26624
    v_mfma_f32_16x16x32_bf16 v[232:235], v[164:167], v[60:63], v[232:235]
    ds_read_b64_tr_b16 v[156:157], v11 offset:24576
    ds_read_b64_tr_b16 v[158:159], v11 offset:26624
    v_mfma_f32_16x16x32_bf16 v[220:223], v[168:171], v[56:59], v[220:223]
    v_mfma_f32_16x16x32_bf16 v[236:239], v[168:171], v[60:63], v[236:239]
    v_mfma_f32_16x16x32_bf16 v[224:227], v[172:175], v[56:59], v[224:227]
    s_add_u32 m0, s97, 0
    s_add_u32 s60, s96, 256
    v_mfma_f32_16x16x32_bf16 v[240:243], v[172:175], v[60:63], v[240:243]
    buffer_load_dwordx4 v244, s[24:27], s60 offen lds
    s_add_u32 m0, s97, 1024
    s_nop 0
    buffer_load_dwordx4 v245, s[24:27], s60 offen lds
    s_waitcnt lgkmcnt(0)
    v_mfma_f32_16x16x32_bf16 v[212:215], v[144:147], v[64:67], v[212:215]
    ds_read_b64_tr_b16 v[160:161], v8 offset:28672
    ds_read_b64_tr_b16 v[162:163], v8 offset:30720
    v_mfma_f32_16x16x32_bf16 v[228:231], v[144:147], v[68:71], v[228:231]
    ds_read_b64_tr_b16 v[164:165], v9 offset:28672
    ds_read_b64_tr_b16 v[166:167], v9 offset:30720
    v_mfma_f32_16x16x32_bf16 v[216:219], v[148:151], v[64:67], v[216:219]
    ds_read_b64_tr_b16 v[168:169], v10 offset:28672
    ds_read_b64_tr_b16 v[170:171], v10 offset:30720
    v_mfma_f32_16x16x32_bf16 v[232:235], v[148:151], v[68:71], v[232:235]
    ds_read_b64_tr_b16 v[172:173], v11 offset:28672
    ds_read_b64_tr_b16 v[174:175], v11 offset:30720
    v_mfma_f32_16x16x32_bf16 v[220:223], v[152:155], v[64:67], v[220:223]
    s_add_u32 m0, s97, 2048
    s_add_u32 s60, s96, 65792
    v_mfma_f32_16x16x32_bf16 v[236:239], v[152:155], v[68:71], v[236:239]
    buffer_load_dwordx4 v244, s[24:27], s60 offen lds
    s_add_u32 m0, s97, 3072
    v_mfma_f32_16x16x32_bf16 v[224:227], v[156:159], v[64:67], v[224:227]
    buffer_load_dwordx4 v245, s[24:27], s60 offen lds
    s_add_u32 s86, s86, 1
    v_mfma_f32_16x16x32_bf16 v[240:243], v[156:159], v[68:71], v[240:243]
    s_mul_i32 s87, s86, 37
    s_lshr_b32 s87, s87, 8
    s_mul_i32 s87, s87, 441
    s_waitcnt lgkmcnt(0)
    v_mfma_f32_16x16x32_bf16 v[212:215], v[160:163], v[72:75], v[212:215]
    ds_read_b64_tr_b16 v[144:145], v8 offset:32768
    ds_read_b64_tr_b16 v[146:147], v8 offset:34816
    v_mfma_f32_16x16x32_bf16 v[228:231], v[160:163], v[76:79], v[228:231]
    ds_read_b64_tr_b16 v[148:149], v9 offset:32768
    ds_read_b64_tr_b16 v[150:151], v9 offset:34816
    v_mfma_f32_16x16x32_bf16 v[216:219], v[164:167], v[72:75], v[216:219]
    ds_read_b64_tr_b16 v[152:153], v10 offset:32768
    ds_read_b64_tr_b16 v[154:155], v10 offset:34816
    v_mfma_f32_16x16x32_bf16 v[232:235], v[164:167], v[76:79], v[232:235]
    ds_read_b64_tr_b16 v[156:157], v11 offset:32768
    ds_read_b64_tr_b16 v[158:159], v11 offset:34816
    v_mfma_f32_16x16x32_bf16 v[220:223], v[168:171], v[72:75], v[220:223]
    v_mfma_f32_16x16x32_bf16 v[236:239], v[168:171], v[76:79], v[236:239]
    v_mfma_f32_16x16x32_bf16 v[224:227], v[172:175], v[72:75], v[224:227]
    v_mfma_f32_16x16x32_bf16 v[240:243], v[172:175], v[76:79], v[240:243]
    s_mov_b32 s51, 0
    s_waitcnt vmcnt(10)
    v_xor_b32 v18, s4, v18
    s_waitcnt vmcnt(9)
    v_xor_b32 v22, s4, v22
    s_waitcnt vmcnt(8)
    v_xor_b32 v26, s4, v26
    s_waitcnt vmcnt(7)
    v_xor_b32 v30, s4, v30
    s_waitcnt vmcnt(6)
    v_xor_b32 v34, s4, v34
    s_waitcnt vmcnt(5)
    v_xor_b32 v38, s4, v38
    s_waitcnt vmcnt(4)
    v_xor_b32 v42, s4, v42
    v_or3_b32 v5, v18, v22, v26
    v_or3_b32 v5, v5, v30, v34
    v_or3_b32 v5, v5, v38, v42
    v_cmp_ne_u32 vcc, 0, v5
    s_nop 0
    s_cbranch_vccz Le27
Lk26:
    s_add_u32 s60, s92, 0
    buffer_load_dwordx4 v[16:19], v12, s[40:43], s60 offen sc1
    s_add_u32 s60, s92, 4096
    buffer_load_dwordx4 v[20:23], v12, s[40:43], s60 offen sc1
    s_add_u32 s60, s92, 8192
    buffer_load_dwordx4 v[24:27], v12, s[40:43], s60 offen sc1
    s_add_u32 s60, s92, 12288
    buffer_load_dwordx4 v[28:31], v12, s[40:43], s60 offen sc1
    s_add_u32 s60, s92, 16384
    buffer_load_dwordx4 v[32:35], v12, s[40:43], s60 offen sc1
    s_add_u32 s60, s92, 20480
    buffer_load_dwordx4 v[36:39], v12, s[40:43], s60 offen sc1
    s_add_u32 s60, s92, 24576
    buffer_load_dwordx4 v[40:43], v12, s[40:43], s60 offen sc1
    s_waitcnt vmcnt(0)
    v_xor_b32 v18, s4, v18
    v_xor_b32 v22, s4, v22
    v_xor_b32 v26, s4, v26
    v_xor_b32 v30, s4, v30
    v_xor_b32 v34, s4, v34
    v_xor_b32 v38, s4, v38
    v_xor_b32 v42, s4, v42
    v_or3_b32 v5, v18, v22, v26
    v_or3_b32 v5, v5, v30, v34
    v_or3_b32 v5, v5, v38, v42
    v_cmp_ne_u32 vcc, 0, v5
    s_add_u32 s51, s51, 1
    s_cbranch_vccz Le27
    s_cmp_lt_u32 s51, 65536
    s_cbranch_scc1 Lk26
Le27:
    v_pk_add_f32 v[16:17], v[16:17], v[20:21]
    v_pk_add_f32 v[24:25], v[24:25], v[28:29]
    v_pk_add_f32 v[32:33], v[32:33], v[36:37]
    v_pk_add_f32 v[16:17], v[16:17], v[24:25]
    v_pk_add_f32 v[32:33], v[32:33], v[40:41]
    v_pk_add_f32 v[16:17], v[16:17], v[32:33]
    s_add_u32 m0, s97, 4096
    s_add_u32 s60, s96, 131328
    buffer_load_dwordx4 v244, s[24:27], s60 offen lds
    v_mov_b32 v18, v16
    v_mov_b32 v19, v17
    s_nop 0
    v_permlane32_swap_b32 v18, v16
    v_permlane32_swap_b32 v19, v17
    v_add_f32 v16, v16, v18
    v_add_f32 v17, v17, v19
    v_mul_f32 v16, 0xba924925, v16
    v_mul_f32 v17, 0x3a924925, v17
    v_fma_f32 v17, -v16, v16, v17
    v_max_f32 v17, 0, v17
    v_add_f32 v17, 0x3727c5ac, v17
    v_rsq_f32 v20, v17
    s_nop 0
    v_mul_f32 v21, v16, v20
    ds_write_b32 v13, v20 offset:256
    ds_write_b32 v13, v21 offset:384
    v_bfe_u32 v12, v0, 4, 1
    v_bfe_u32 v13, v0, 5, 1
    v_lshl_add_u32 v12, v12, 1, v13
    v_lshl_add_u32 v12, v12, 4, v2
    v_lshlrev_b32 v12, 4, v12
    s_add_u32 m0, s97, 5120
    s_nop 0
    buffer_load_dwordx4 v245, s[24:27], s60 offen lds
    s_add_u32 s86, s86, s87
    s_lshl_b32 s86, s86, 10
    s_add_u32 s65, s86, s93
    s_lshl_b32 s86, s101, 2
    s_add_u32 s86, s86, 2
    s_mul_i32 s87, s86, 37
    s_lshr_b32 s87, s87, 8
    s_mul_i32 s87, s87, 441
    s_waitcnt lgkmcnt(0)
    ds_read_b128 v[44:47], v14 offset:256
    ds_read_b128 v[52:55], v14 offset:384
    ds_read_b128 v[48:51], v14 offset:320
    ds_read_b128 v[56:59], v14 offset:448
    s_add_u32 s86, s86, s87
    s_lshl_b32 s86, s86, 10
    s_add_u32 s66, s86, s93
    s_lshl_b32 s86, s101, 2
    s_add_u32 s86, s86, 3
    s_mul_i32 s87, s86, 37
    s_lshr_b32 s87, s87, 8
    s_mul_i32 s87, s87, 441
    s_add_u32 s86, s86, s87
    s_lshl_b32 s86, s86, 10
    s_add_u32 s67, s86, s93
    s_add_u32 m0, s97, 6144
    s_add_u32 s60, s96, 196864
    buffer_load_dwordx4 v244, s[24:27], s60 offen lds
    s_add_u32 m0, s97, 7168
    s_nop 0
    buffer_load_dwordx4 v245, s[24:27], s60 offen lds
    s_waitcnt lgkmcnt(2)
    v_pk_fma_f32 v[176:177], v[176:177], v[44:45], v[52:53]
    v_pk_fma_f32 v[178:179], v[178:179], v[46:47], v[54:55]
    s_waitcnt lgkmcnt(0)
    v_pk_fma_f32 v[192:193], v[192:193], v[48:49], v[56:57]
    v_pk_fma_f32 v[194:195], v[194:195], v[50:51], v[58:59]
    v_cvt_pk_bf16_f32 v16, v176, v177
    v_cvt_pk_bf16_f32 v17, v178, v179
    v_cvt_pk_bf16_f32 v18, v192, v193
    v_cvt_pk_bf16_f32 v19, v194, v195
    s_nop 0
    v_permlane16_swap_b32 v16, v18
    v_permlane16_swap_b32 v17, v19
    v_pk_fma_f32 v[180:181], v[180:181], v[44:45], v[52:53]
    v_pk_fma_f32 v[182:183], v[182:183], v[46:47], v[54:55]
    v_pk_fma_f32 v[196:197], v[196:197], v[48:49], v[56:57]
    v_pk_fma_f32 v[198:199], v[198:199], v[50:51], v[58:59]
    v_cvt_pk_bf16_f32 v20, v180, v181
    v_cvt_pk_bf16_f32 v21, v182, v183
    v_cvt_pk_bf16_f32 v22, v196, v197
    v_cvt_pk_bf16_f32 v23, v198, v199
    buffer_store_dwordx4 v[16:19], v12, s[40:43], s64 offen sc1
    v_permlane16_swap_b32 v20, v22
    v_permlane16_swap_b32 v21, v23
    v_pk_fma_f32 v[184:185], v[184:185], v[44:45], v[52:53]
    v_pk_fma_f32 v[186:187], v[186:187], v[46:47], v[54:55]
    v_pk_fma_f32 v[200:201], v[200:201], v[48:49], v[56:57]
    v_pk_fma_f32 v[202:203], v[202:203], v[50:51], v[58:59]
    v_cvt_pk_bf16_f32 v24, v184, v185
    v_cvt_pk_bf16_f32 v25, v186, v187
    v_cvt_pk_bf16_f32 v26, v200, v201
    v_cvt_pk_bf16_f32 v27, v202, v203
    buffer_store_dwordx4 v[20:23], v12, s[40:43], s65 offen sc1
    v_permlane16_swap_b32 v24, v26
    v_permlane16_swap_b32 v25, v27
    v_pk_fma_f32 v[188:189], v[188:189], v[44:45], v[52:53]
    v_pk_fma_f32 v[190:191], v[190:191], v[46:47], v[54:55]
    v_pk_fma_f32 v[204:205], v[204:205], v[48:49], v[56:57]
    v_pk_fma_f32 v[206:207], v[206:207], v[50:51], v[58:59]
    v_cvt_pk_bf16_f32 v28, v188, v189
    v_cvt_pk_bf16_f32 v29, v190, v191
    v_cvt_pk_bf16_f32 v30, v204, v205
    v_cvt_pk_bf16_f32 v31, v206, v207
    buffer_store_dwordx4 v[24:27], v12, s[40:43], s66 offen sc1
    v_permlane16_swap_b32 v28, v30
    v_permlane16_swap_b32 v29, v31
    buffer_store_dwordx4 v[28:31], v12, s[40:43], s67 offen sc1
    v_mfma_f32_16x16x32_bf16 v[212:215], v[144:147], v[80:83], v[212:215]
    ds_read_b64_tr_b16 v[160:161], v8 offset:36864
    ds_read_b64_tr_b16 v[162:163], v8 offset:38912
    v_mfma_f32_16x16x32_bf16 v[228:231], v[144:147], v[84:87], v[228:231]
    ds_read_b64_tr_b16 v[164:165], v9 offset:36864
    ds_read_b64_tr_b16 v[166:167], v9 offset:38912
    v_mfma_f32_16x16x32_bf16 v[216:219], v[148:151], v[80:83], v[216:219]
    ds_read_b64_tr_b16 v[168:169], v10 offset:36864
    ds_read_b64_tr_b16 v[170:171], v10 offset:38912
    v_mfma_f32_16x16x32_bf16 v[232:235], v[148:151], v[84:87], v[232:235]
    ds_read_b64_tr_b16 v[172:173], v11 offset:36864
    ds_read_b64_tr_b16 v[174:175], v11 offset:38912
    v_mfma_f32_16x16x32_bf16 v[220:223], v[152:155], v[80:83], v[220:223]
    v_mfma_f32_16x16x32_bf16 v[236:239], v[152:155], v[84:87], v[236:239]
    s_add_u32 m0, s97, 8192
    v_mfma_f32_16x16x32_bf16 v[224:227], v[156:159], v[80:83], v[224:227]
    s_add_u32 s60, s96, 384
    buffer_load_dwordx4 v244, s[24:27], s60 offen lds
    v_mfma_f32_16x16x32_bf16 v[240:243], v[156:159], v[84:87], v[240:243]
    s_add_u32 m0, s97, 9216
    s_nop 0
    buffer_load_dwordx4 v245, s[24:27], s60 offen lds
    s_waitcnt lgkmcnt(0)
    v_mfma_f32_16x16x32_bf16 v[212:215], v[160:163], v[88:91], v[212:215]
    ds_read_b64_tr_b16 v[144:145], v8 offset:40960
    ds_read_b64_tr_b16 v[146:147], v8 offset:43008
    v_mfma_f32_16x16x32_bf16 v[228:231], v[160:163], v[92:95], v[228:231]
    ds_read_b64_tr_b16 v[148:149], v9 offset:40960
    ds_read_b64_tr_b16 v[150:151], v9 offset:43008
    v_mfma_f32_16x16x32_bf16 v[216:219], v[164:167], v[88:91], v[216:219]
    ds_read_b64_tr_b16 v[152:153], v10 offset:40960
    ds_read_b64_tr_b16 v[154:155], v10 offset:43008
    v_mfma_f32_16x16x32_bf16 v[232:235], v[164:167], v[92:95], v[232:235]
    ds_read_b64_tr_b16 v[156:157], v11 offset:40960
    ds_read_b64_tr_b16 v[158:159], v11 offset:43008
    v_mfma_f32_16x16x32_bf16 v[220:223], v[168:171], v[88:91], v[220:223]
    s_add_u32 m0, s97, 10240
    s_add_u32 s60, s96, 65920
    v_mfma_f32_16x16x32_bf16 v[236:239], v[168:171], v[92:95], v[236:239]
    buffer_load_dwordx4 v244, s[24:27], s60 offen lds
    s_add_u32 m0, s97, 11264
    v_mfma_f32_16x16x32_bf16 v[224:227], v[172:175], v[88:91], v[224:227]
    buffer_load_dwordx4 v245, s[24:27], s60 offen lds
    v_mfma_f32_16x16x32_bf16 v[240:243], v[172:175], v[92:95], v[240:243]
    s_add_u32 m0, s97, 12288
    s_add_u32 s60, s96, 131456
    buffer_load_dwordx4 v244, s[24:27], s60 offen lds
    s_waitcnt lgkmcnt(0)
    v_mfma_f32_16x16x32_bf16 v[212:215], v[144:147], v[96:99], v[212:215]
    ds_read_b64_tr_b16 v[160:161], v8 offset:45056
    ds_read_b64_tr_b16 v[162:163], v8 offset:47104
    v_mfma_f32_16x16x32_bf16 v[228:231], v[144:147], v[100:103], v[228:231]
    ds_read_b64_tr_b16 v[164:165], v9 offset:45056
    ds_read_b64_tr_b16 v[166:167], v9 offset:47104
    v_mfma_f32_16x16x32_bf16 v[216:219], v[148:151], v[96:99], v[216:219]
    ds_read_b64_tr_b16 v[168:169], v10 offset:45056
    ds_read_b64_tr_b16 v[170:171], v10 offset:47104
    v_mfma_f32_16x16x32_bf16 v[232:235], v[148:151], v[100:103], v[232:235]
    ds_read_b64_tr_b16 v[172:173], v11 offset:45056
    ds_read_b64_tr_b16 v[174:175], v11 offset:47104
    v_mfma_f32_16x16x32_bf16 v[220:223], v[152:155], v[96:99], v[220:223]
    s_add_u32 m0, s97, 13312
    v_mfma_f32_16x16x32_bf16 v[236:239], v[152:155], v[100:103], v[236:239]
    buffer_load_dwordx4 v245, s[24:27], s60 offen lds
    s_add_u32 m0, s97, 14336
    v_mfma_f32_16x16x32_bf16 v[224:227], v[156:159], v[96:99], v[224:227]
    s_add_u32 s60, s96, 196992
    buffer_load_dwordx4 v244, s[24:27], s60 offen lds
    v_mfma_f32_16x16x32_bf16 v[240:243], v[156:159], v[100:103], v[240:243]
    s_add_u32 m0, s97, 15360
    s_nop 0
    buffer_load_dwordx4 v245, s[24:27], s60 offen lds
    s_waitcnt lgkmcnt(0)
    v_mfma_f32_16x16x32_bf16 v[212:215], v[160:163], v[104:107], v[212:215]
    ds_read_b64_tr_b16 v[144:145], v8 offset:49152
    ds_read_b64_tr_b16 v[146:147], v8 offset:51200
    v_mfma_f32_16x16x32_bf16 v[228:231], v[160:163], v[108:111], v[228:231]
    ds_read_b64_tr_b16 v[148:149], v9 offset:49152
    ds_read_b64_tr_b16 v[150:151], v9 offset:51200
    v_mfma_f32_16x16x32_bf16 v[216:219], v[164:167], v[104:107], v[216:219]
    ds_read_b64_tr_b16 v[152:153], v10 offset:49152
    ds_read_b64_tr_b16 v[154:155], v10 offset:51200
    v_mfma_f32_16x16x32_bf16 v[232:235], v[164:167], v[108:111], v[232:235]
    ds_read_b64_tr_b16 v[156:157], v11 offset:49152
    ds_read_b64_tr_b16 v[158:159], v11 offset:51200
    v_mfma_f32_16x16x32_bf16 v[220:223], v[168:171], v[104:107], v[220:223]
    s_lshl_b32 s93, s100, 3
    s_lshl_b32 s86, s50, 1
    v_mfma_f32_16x16x32_bf16 v[236:239], v[168:171], v[108:111], v[236:239]
    s_add_u32 s93, s93, s86
    s_mul_i32 s93, s93, 56
    v_mfma_f32_16x16x32_bf16 v[224:227], v[172:175], v[104:107], v[224:227]
    s_lshl_b32 s86, s101, 2
    s_add_u32 s93, s93, s86
    v_mfma_f32_16x16x32_bf16 v[240:243], v[172:175], v[108:111], v[240:243]
    s_lshl_b32 s93, s93, 9
    s_add_u32 s93, s93, 9437184
    s_add_u32 s94, s93, 28672
    s_waitcnt lgkmcnt(0)
    v_mfma_f32_16x16x32_bf16 v[212:215], v[144:147], v[112:115], v[212:215]
    ds_read_b64_tr_b16 v[160:161], v8 offset:53248
    ds_read_b64_tr_b16 v[162:163], v8 offset:55296
    v_mfma_f32_16x16x32_bf16 v[228:231], v[144:147], v[116:119], v[228:231]
    ds_read_b64_tr_b16 v[164:165], v9 offset:53248
    ds_read_b64_tr_b16 v[166:167], v9 offset:55296
    v_mfma_f32_16x16x32_bf16 v[216:219], v[148:151], v[112:115], v[216:219]
    ds_read_b64_tr_b16 v[168:169], v10 offset:53248
    ds_read_b64_tr_b16 v[170:171], v10 offset:55296
    v_mfma_f32_16x16x32_bf16 v[232:235], v[148:151], v[116:119], v[232:235]
    ds_read_b64_tr_b16 v[172:173], v11 offset:53248
    ds_read_b64_tr_b16 v[174:175], v11 offset:55296
    v_mfma_f32_16x16x32_bf16 v[220:223], v[152:155], v[112:115], v[220:223]
    v_mfma_f32_16x16x32_bf16 v[236:239], v[152:155], v[116:119], v[236:239]
    v_mfma_f32_16x16x32_bf16 v[224:227], v[156:159], v[112:115], v[224:227]
    v_mfma_f32_16x16x32_bf16 v[240:243], v[156:159], v[116:119], v[240:243]
    s_waitcnt vmcnt(8)
    s_barrier
    s_cmp_lg_u32 s50, 0
    s_cbranch_scc1 Lw28
    s_mov_b64 exec, 0x1fe0000
    v_mov_b32 v5, s4
    buffer_store_dword v5, v4, s[40:43], 0 offen sc1
    s_mov_b64 exec, -1
Lw28:
    s_waitcnt lgkmcnt(0)
    v_mfma_f32_16x16x32_bf16 v[212:215], v[160:163], v[120:123], v[212:215]
    ds_read_b64_tr_b16 v[144:145], v8 offset:57344
    ds_read_b64_tr_b16 v[146:147], v8 offset:59392
    v_mfma_f32_16x16x32_bf16 v[228:231], v[160:163], v[124:127], v[228:231]
    ds_read_b64_tr_b16 v[148:149], v9 offset:57344
    ds_read_b64_tr_b16 v[150:151], v9 offset:59392
    v_mfma_f32_16x16x32_bf16 v[216:219], v[164:167], v[120:123], v[216:219]
    ds_read_b64_tr_b16 v[152:153], v10 offset:57344
    ds_read_b64_tr_b16 v[154:155], v10 offset:59392
    v_mfma_f32_16x16x32_bf16 v[232:235], v[164:167], v[124:127], v[232:235]
    ds_read_b64_tr_b16 v[156:157], v11 offset:57344
    ds_read_b64_tr_b16 v[158:159], v11 offset:59392
    v_mfma_f32_16x16x32_bf16 v[220:223], v[168:171], v[120:123], v[220:223]
    ds_read_b128 a[64:67], v246 offset:0
    v_mfma_f32_16x16x32_bf16 v[236:239], v[168:171], v[124:127], v[236:239]
    ds_read_b128 a[68:71], v248 offset:0
    ds_read_b128 a[72:75], v250 offset:0
    v_mfma_f32_16x16x32_bf16 v[224:227], v[172:175], v[120:123], v[224:227]
    ds_read_b128 a[76:79], v252 offset:0
    ds_read_b128 a[80:83], v247 offset:0
    v_mfma_f32_16x16x32_bf16 v[240:243], v[172:175], v[124:127], v[240:243]
    ds_read_b128 a[84:87], v249 offset:0
    ds_read_b128 a[88:91], v251 offset:0
    ds_read_b128 a[92:95], v253 offset:0
    s_waitcnt lgkmcnt(0)
    v_mfma_f32_16x16x32_bf16 v[212:215], v[144:147], v[128:131], v[212:215]
    ds_read_b64_tr_b16 v[160:161], v8 offset:61440
    ds_read_b64_tr_b16 v[162:163], v8 offset:63488
    v_mfma_f32_16x16x32_bf16 v[228:231], v[144:147], v[132:135], v[228:231]
    ds_read_b64_tr_b16 v[164:165], v9 offset:61440
    ds_read_b64_tr_b16 v[166:167], v9 offset:63488
    v_mfma_f32_16x16x32_bf16 v[216:219], v[148:151], v[128:131], v[216:219]
    ds_read_b64_tr_b16 v[168:169], v10 offset:61440
    ds_read_b64_tr_b16 v[170:171], v10 offset:63488
    v_mfma_f32_16x16x32_bf16 v[232:235], v[148:151], v[132:135], v[232:235]
    ds_read_b64_tr_b16 v[172:173], v11 offset:61440
    ds_read_b64_tr_b16 v[174:175], v11 offset:63488
    v_mfma_f32_16x16x32_bf16 v[220:223], v[152:155], v[128:131], v[220:223]
    s_waitcnt vmcnt(0)
    ds_read_b128 a[96:99], v246 offset:8192
    v_mfma_f32_16x16x32_bf16 v[236:239], v[152:155], v[132:135], v[236:239]
    ds_read_b128 a[100:103], v248 offset:8192
    ds_read_b128 a[104:107], v250 offset:8192
    v_mfma_f32_16x16x32_bf16 v[224:227], v[156:159], v[128:131], v[224:227]
    ds_read_b128 a[108:111], v252 offset:8192
    ds_read_b128 a[112:115], v247 offset:8192
    v_mfma_f32_16x16x32_bf16 v[240:243], v[156:159], v[132:135], v[240:243]
    ds_read_b128 a[116:119], v249 offset:8192
    ds_read_b128 a[120:123], v251 offset:8192
    ds_read_b128 a[124:127], v253 offset:8192
    s_waitcnt lgkmcnt(0)
    v_mfma_f32_16x16x32_bf16 v[212:215], v[160:163], v[136:139], v[212:215]
    v_mfma_f32_16x16x32_bf16 v[228:231], v[160:163], v[140:143], v[228:231]
    v_mfma_f32_16x16x32_bf16 v[216:219], v[164:167], v[136:139], v[216:219]
    v_mfma_f32_16x16x32_bf16 v[232:235], v[164:167], v[140:143], v[232:235]
    v_mfma_f32_16x16x32_bf16 v[220:223], v[168:171], v[136:139], v[220:223]
    s_add_u32 m0, s97, 0
    v_mfma_f32_16x16x32_bf16 v[236:239], v[168:171], v[140:143], v[236:239]
    s_add_u32 s60, s96, 512
    v_mfma_f32_16x16x32_bf16 v[224:227], v[172:175], v[136:139], v[224:227]
    buffer_load_dwordx4 v244, s[24:27], s60 offen lds
    s_add_u32 m0, s97, 1024
    v_mfma_f32_16x16x32_bf16 v[240:243], v[172:175], v[140:143], v[240:243]
    buffer_load_dwordx4 v245, s[24:27], s60 offen lds
    ds_read_b64_tr_b16 v[32:33], v15 offset:0
    v_subrev_u32 v8, 65536, v8
    v_subrev_u32 v9, 65536, v9
    v_subrev_u32 v10, 65536, v10
    ds_read_b64_tr_b16 v[34:35], v15 offset:2048
    ds_read_b64_tr_b16 v[36:37], v15 offset:4096
    v_subrev_u32 v11, 65536, v11
    v_lshlrev_b32 v12, 4, v3
    v_add_u32 v12, 131328, v12
    ds_read_b64_tr_b16 v[38:39], v15 offset:6144
    ds_read_b64_tr_b16 v[40:41], v15 offset:8192
    ds_read_b64_tr_b16 v[42:43], v15 offset:10240
    v_lshlrev_b32 v13, 3, v0
    s_add_u32 m0, s97, 2048
    s_add_u32 s60, s96, 66048
    s_waitcnt lgkmcnt(4)
    v_mfma_f32_16x16x32_bf16 a[236:239], a[240:243], v[32:35], 0
    ds_read_b64_tr_b16 v[44:45], v15 offset:12288
    buffer_load_dwordx4 v244, s[24:27], s60 offen lds
    s_add_u32 m0, s97, 3072
    ds_read_b64_tr_b16 v[46:47], v15 offset:14336
    s_waitcnt lgkmcnt(4)
    v_mfma_f32_16x16x32_bf16 a[236:239], a[240:243], v[36:39], a[236:239]
    ds_read_b64_tr_b16 v[48:49], v15 offset:16384
    buffer_load_dwordx4 v245, s[24:27], s60 offen lds
    s_add_u32 m0, s97, 4096
    s_add_u32 s60, s96, 131584
    ds_read_b64_tr_b16 v[50:51], v15 offset:18432
    s_waitcnt lgkmcnt(4)
    v_mfma_f32_16x16x32_bf16 a[236:239], a[240:243], v[40:43], a[236:239]
    buffer_load_dwordx4 v244, s[24:27], s60 offen lds
    s_add_u32 m0, s97, 5120
    ds_read_b64_tr_b16 v[52:53], v15 offset:20480
    ds_read_b64_tr_b16 v[54:55], v15 offset:22528
    s_waitcnt lgkmcnt(4)
    v_mfma_f32_16x16x32_bf16 a[236:239], a[240:243], v[44:47], a[236:239]
    buffer_load_dwordx4 v245, s[24:27], s60 offen lds
    s_add_u32 m0, s97, 6144
    s_add_u32 s60, s96, 197120
    ds_read_b64_tr_b16 v[56:57], v15 offset:24576
    ds_read_b64_tr_b16 v[58:59], v15 offset:26624
    buffer_load_dwordx4 v244, s[24:27], s60 offen lds
    s_add_u32 m0, s97, 7168
    s_waitcnt lgkmcnt(4)
    v_mfma_f32_16x16x32_bf16 a[236:239], a[240:243], v[48:51], a[236:239]
    ds_read_b64_tr_b16 v[60:61], v15 offset:28672
    ds_read_b64_tr_b16 v[62:63], v15 offset:30720
    buffer_load_dwordx4 v245, s[24:27], s60 offen lds
    s_waitcnt lgkmcnt(4)
    v_mfma_f32_16x16x32_bf16 a[236:239], a[240:243], v[52:55], a[236:239]
    ds_read_b64_tr_b16 v[64:65], v15 offset:32768
    ds_read_b64_tr_b16 v[66:67], v15 offset:34816
    s_waitcnt lgkmcnt(4)
    v_mfma_f32_16x16x32_bf16 a[236:239], a[240:243], v[56:59], a[236:239]
    ds_read_b64_tr_b16 v[68:69], v15 offset:36864
    s_add_u32 m0, s97, 8192
    ds_read_b64_tr_b16 v[70:71], v15 offset:38912
    s_waitcnt lgkmcnt(4)
    v_mfma_f32_16x16x32_bf16 a[236:239], a[240:243], v[60:63], a[236:239]
    ds_read_b64_tr_b16 v[72:73], v15 offset:40960
    s_add_u32 s60, s96, 640
    buffer_load_dwordx4 v244, s[24:27], s60 offen lds
    s_add_u32 m0, s97, 9216
    ds_read_b64_tr_b16 v[74:75], v15 offset:43008
    s_waitcnt lgkmcnt(4)
    v_mfma_f32_16x16x32_bf16 a[236:239], a[240:243], v[64:67], a[236:239]
    buffer_load_dwordx4 v245, s[24:27], s60 offen lds
    s_add_u32 m0, s97, 10240
    ds_read_b64_tr_b16 v[76:77], v15 offset:45056
    ds_read_b64_tr_b16 v[78:79], v15 offset:47104
    s_waitcnt lgkmcnt(4)
    v_mfma_f32_16x16x32_bf16 a[236:239], a[240:243], v[68:71], a[236:239]
    s_add_u32 s60, s96, 66176
    buffer_load_dwordx4 v244, s[24:27], s60 offen lds
    s_add_u32 m0, s97, 11264
    ds_read_b64_tr_b16 v[80:81], v15 offset:49152
    ds_read_b64_tr_b16 v[82:83], v15 offset:51200
    buffer_load_dwordx4 v245, s[24:27], s60 offen lds
    s_add_u32 m0, s97, 12288
    s_waitcnt lgkmcnt(4)
    v_mfma_f32_16x16x32_bf16 a[236:239], a[240:243], v[72:75], a[236:239]
    ds_read_b64_tr_b16 v[84:85], v15 offset:53248
    ds_read_b64_tr_b16 v[86:87], v15 offset:55296
    s_add_u32 s60, s96, 131712
    buffer_load_dwordx4 v244, s[24:27], s60 offen lds
    s_add_u32 m0, s97, 13312
    s_waitcnt lgkmcnt(4)
    v_mfma_f32_16x16x32_bf16 a[236:239], a[240:243], v[76:79], a[236:239]
    ds_read_b64_tr_b16 v[88:89], v15 offset:57344
    buffer_load_dwordx4 v245, s[24:27], s60 offen lds
    s_add_u32 m0, s97, 14336
    ds_read_b64_tr_b16 v[90:91], v15 offset:59392
    s_waitcnt lgkmcnt(4)
    v_mfma_f32_16x16x32_bf16 a[236:239], a[240:243], v[80:83], a[236:239]
    ds_read_b64_tr_b16 v[92:93], v15 offset:61440
    s_add_u32 s60, s96, 197248
    buffer_load_dwordx4 v244, s[24:27], s60 offen lds
    s_add_u32 m0, s97, 15360
    ds_read_b64_tr_b16 v[94:95], v15 offset:63488
    s_waitcnt lgkmcnt(4)
    v_mfma_f32_16x16x32_bf16 a[236:239], a[240:243], v[84:87], a[236:239]
    buffer_load_dwordx4 v245, s[24:27], s60 offen lds
    s_waitcnt lgkmcnt(2)
    v_mfma_f32_16x16x32_bf16 a[236:239], a[240:243], v[88:91], a[236:239]
    s_waitcnt lgkmcnt(0)
    v_mfma_f32_16x16x32_bf16 a[236:239], a[240:243], v[92:95], a[236:239]
    s_lshl_b32 s86, s50, 6
    s_add_u32 s86, s86, 131328
    v_lshl_add_u32 v5, v2, 2, s86
    s_nop 4
    ds_write_b32 v5, a236
    s_waitcnt lgkmcnt(0)
    s_barrier
    ds_read_b128 v[176:179], v12 offset:0
    ds_read_b128 v[180:183], v12 offset:64
    ds_read_b128 v[184:187], v12 offset:128
    ds_read_b128 v[188:191], v12 offset:192
    s_mul_i32 s90, s63, 7
    s_add_u32 s91, s90, 6
    s_lshr_b32 s90, s90, 2
    s_lshr_b32 s91, s91, 2
    s_lshl_b32 s92, s63, 6
    s_lshl_b32 s86, s50, 4
    s_add_u32 s92, s92, s86
    s_mul_i32 s92, s92, 7168
    s_add_u32 s92, s92, 5242880
    v_add_u32 v18, 4096, v1
    s_lshl_b32 s86, s90, 4
    s_lshl_b32 s87, s91, 4
    s_add_u32 s87, s87, 15
    v_add_u32 v16, s86, v0
    v_min_u32 v16, s87, v16
    v_lshlrev_b32 v16, 2, v16
    s_lshl_b32 s75, s48, 10
    s_add_u32 s75, s75, 10240
    s_cmp_lg_u32 s50, 0
    s_cbranch_scc1 Lw29
    buffer_load_dword v17, v16, s[40:43], s75 offen sc1
Lw29:
    s_waitcnt lgkmcnt(3)
    v_pk_mul_f32 v[160:161], v[176:177], v[208:209] op_sel:[0,1] op_sel_hi:[1,1]
    v_pk_mul_f32 v[162:163], v[178:179], v[208:209] op_sel:[0,1] op_sel_hi:[1,1]
    v_pk_mul_f32 v[164:165], v[176:177], v[210:211] op_sel:[0,1] op_sel_hi:[1,1]
    v_pk_mul_f32 v[166:167], v[178:179], v[210:211] op_sel:[0,1] op_sel_hi:[1,1]
    s_add_u32 m0, s97, 65536
    s_add_u32 s60, s96, 768
    buffer_load_dwordx4 v244, s[24:27], s60 offen lds
    v_pk_fma_f32 v[212:213], v[212:213], v[208:209], v[160:161] op_sel:[0,0,0] op_sel_hi:[1,0,1]
    s_add_u32 m0, s97, 66560
    s_nop 0
    buffer_load_dwordx4 v245, s[24:27], s60 offen lds
    v_pk_fma_f32 v[214:215], v[214:215], v[208:209], v[162:163] op_sel:[0,0,0] op_sel_hi:[1,0,1]
    v_pk_fma_f32 v[228:229], v[228:229], v[210:211], v[164:165] op_sel:[0,0,0] op_sel_hi:[1,0,1]
    s_add_u32 m0, s97, 67584
    s_add_u32 s60, s96, 66304
    buffer_load_dwordx4 v244, s[24:27], s60 offen lds
    v_pk_fma_f32 v[230:231], v[230:231], v[210:211], v[166:167] op_sel:[0,0,0] op_sel_hi:[1,0,1]
    s_add_u32 m0, s97, 68608
    s_nop 0
    buffer_load_dwordx4 v245, s[24:27], s60 offen lds
    s_waitcnt lgkmcnt(2)
    v_pk_mul_f32 v[160:161], v[180:181], v[208:209] op_sel:[0,1] op_sel_hi:[1,1]
    v_pk_mul_f32 v[162:163], v[182:183], v[208:209] op_sel:[0,1] op_sel_hi:[1,1]
    s_add_u32 m0, s97, 69632
    s_add_u32 s60, s96, 131840
    buffer_load_dwordx4 v244, s[24:27], s60 offen lds
    v_pk_mul_f32 v[164:165], v[180:181], v[210:211] op_sel:[0,1] op_sel_hi:[1,1]
    v_pk_mul_f32 v[166:167], v[182:183], v[210:211] op_sel:[0,1] op_sel_hi:[1,1]
    s_add_u32 m0, s97, 70656
    s_nop 0
    buffer_load_dwordx4 v245, s[24:27], s60 offen lds
    v_pk_fma_f32 v[216:217], v[216:217], v[208:209], v[160:161] op_sel:[0,0,0] op_sel_hi:[1,0,1]
    s_add_u32 m0, s97, 71680
    s_add_u32 s60, s96, 197376
    buffer_load_dwordx4 v244, s[24:27], s60 offen lds
    v_pk_fma_f32 v[218:219], v[218:219], v[208:209], v[162:163] op_sel:[0,0,0] op_sel_hi:[1,0,1]
    v_pk_fma_f32 v[232:233], v[232:233], v[210:211], v[164:165] op_sel:[0,0,0] op_sel_hi:[1,0,1]
    s_add_u32 m0, s97, 72704
    s_nop 0
    buffer_load_dwordx4 v245, s[24:27], s60 offen lds
    v_pk_fma_f32 v[234:235], v[234:235], v[210:211], v[166:167] op_sel:[0,0,0] op_sel_hi:[1,0,1]
    s_waitcnt lgkmcnt(1)
    v_pk_mul_f32 v[160:161], v[184:185], v[208:209] op_sel:[0,1] op_sel_hi:[1,1]
    v_pk_mul_f32 v[162:163], v[186:187], v[208:209] op_sel:[0,1] op_sel_hi:[1,1]
    v_pk_mul_f32 v[164:165], v[184:185], v[210:211] op_sel:[0,1] op_sel_hi:[1,1]
    v_pk_mul_f32 v[166:167], v[186:187], v[210:211] op_sel:[0,1] op_sel_hi:[1,1]
    s_add_u32 m0, s97, 73728
    s_add_u32 s60, s96, 896
    buffer_load_dwordx4 v244, s[24:27], s60 offen lds
    v_pk_fma_f32 v[220:221], v[220:221], v[208:209], v[160:161] op_sel:[0,0,0] op_sel_hi:[1,0,1]
    s_add_u32 m0, s97, 74752
    s_nop 0
    buffer_load_dwordx4 v245, s[24:27], s60 offen lds
    v_pk_fma_f32 v[222:223], v[222:223], v[208:209], v[162:163] op_sel:[0,0,0] op_sel_hi:[1,0,1]
    v_pk_fma_f32 v[236:237], v[236:237], v[210:211], v[164:165] op_sel:[0,0,0] op_sel_hi:[1,0,1]
    s_add_u32 m0, s97, 75776
    s_add_u32 s60, s96, 66432
    buffer_load_dwordx4 v244, s[24:27], s60 offen lds
    v_pk_fma_f32 v[238:239], v[238:239], v[210:211], v[166:167] op_sel:[0,0,0] op_sel_hi:[1,0,1]
    s_add_u32 m0, s97, 76800
    s_nop 0
    buffer_load_dwordx4 v245, s[24:27], s60 offen lds
    s_waitcnt lgkmcnt(0)
    v_pk_mul_f32 v[160:161], v[188:189], v[208:209] op_sel:[0,1] op_sel_hi:[1,1]
    v_pk_mul_f32 v[162:163], v[190:191], v[208:209] op_sel:[0,1] op_sel_hi:[1,1]
    s_add_u32 m0, s97, 77824
    s_add_u32 s60, s96, 131968
    buffer_load_dwordx4 v244, s[24:27], s60 offen lds
    v_pk_mul_f32 v[164:165], v[188:189], v[210:211] op_sel:[0,1] op_sel_hi:[1,1]
    v_pk_mul_f32 v[166:167], v[190:191], v[210:211] op_sel:[0,1] op_sel_hi:[1,1]
    s_add_u32 m0, s97, 78848
    s_nop 0
    buffer_load_dwordx4 v245, s[24:27], s60 offen lds
    v_pk_fma_f32 v[224:225], v[224:225], v[208:209], v[160:161] op_sel:[0,0,0] op_sel_hi:[1,0,1]
    s_add_u32 m0, s97, 79872
    s_add_u32 s60, s96, 197504
    buffer_load_dwordx4 v244, s[24:27], s60 offen lds
    v_pk_fma_f32 v[226:227], v[226:227], v[208:209], v[162:163] op_sel:[0,0,0] op_sel_hi:[1,0,1]
    v_pk_fma_f32 v[240:241], v[240:241], v[210:211], v[164:165] op_sel:[0,0,0] op_sel_hi:[1,0,1]
    s_add_u32 m0, s97, 80896
    s_nop 0
    buffer_load_dwordx4 v245, s[24:27], s60 offen lds
    v_pk_fma_f32 v[242:243], v[242:243], v[210:211], v[166:167] op_sel:[0,0,0] op_sel_hi:[1,0,1]
    s_branch L_p3join
L_p3skip:
    s_waitcnt vmcnt(0) lgkmcnt(0)
    s_lshl_b32 s86, s100, 1
    s_add_u32 s86, s86, s101
    s_sub_u32 s86, s86, 14
    s_lshl_b32 s86, s86, 2
    s_add_u32 s86, s86, s50
    s_lshl_b32 s60, s86, 16
    v_bfe_u32 v12, v0, 2, 2
    v_lshlrev_b32 v12, 10, v12
    v_lshl_add_u32 v12, v3, 12, v12
    v_and_b32 v5, 3, v0
    v_lshl_add_u32 v12, v5, 7, v12
    v_lshrrev_b32 v13, 3, v0
    v_lshlrev_b32 v13, 12, v13
    v_bfe_u32 v5, v0, 1, 2
    v_lshl_add_u32 v13, v5, 10, v13
    v_and_b32 v5, 1, v0
    v_lshl_add_u32 v13, v5, 7, v13
    buffer_load_dword v16, v13, s[24:27], s60 offen offset:256
    s_add_u32 s60, s60, 32768
    buffer_load_dword v17, v13, s[24:27], s60 offen offset:256
    s_add_u32 s60, s60, 32768
    s_sub_u32 s60, s60, 65024
    buffer_load_dword v20, v12, s[24:27], s60 offen
    s_add_u32 s60, s60, 16384
    buffer_load_dword v21, v12, s[24:27], s60 offen
    s_add_u32 s60, s60, 16384
    buffer_load_dword v22, v12, s[24:27], s60 offen
    s_add_u32 s60, s60, 16384
    buffer_load_dword v23, v12, s[24:27], s60 offen
    s_add_u32 s60, s60, 16384
    v_lshrrev_b32 v12, 3, v0
    v_and_b32 v13, 7, v0
    v_xor_b32 v13, v13, v3
    v_lshlrev_b32 v13, 4, v13
    v_lshl_add_u32 v244, v12, 12, v13
    v_xor_b32 v245, 64, v244
    v_add_u32 v245, 32768, v245
    s_lshl_b32 s96, s62, 18
    s_lshl_b32 s86, s50, 10
    s_add_u32 s96, s96, s86
    s_lshl_b32 s97, s50, 14
    v_lshrrev_b32 v12, 1, v2
    v_xor_b32 v12, v12, v3
    v_lshlrev_b32 v12, 4, v12
    v_lshl_add_u32 v12, v2, 7, v12
    v_xor_b32 v13, 64, v12
    s_add_u32 s86, s50, 0
    s_and_b32 s86, s86, 3
    s_lshl_b32 s86, s86, 11
    s_add_u32 s86, s86, s97
    v_add_u32 v246, s86, v12
    v_add_u32 v247, s86, v13
    s_add_u32 s86, s50, 1
    s_and_b32 s86, s86, 3
    s_lshl_b32 s86, s86, 11
    s_add_u32 s86, s86, s97
    v_add_u32 v248, s86, v12
    v_add_u32 v249, s86, v13
    s_add_u32 s86, s50, 2
    s_and_b32 s86, s86, 3
    s_lshl_b32 s86, s86, 11
    s_add_u32 s86, s86, s97
    v_add_u32 v250, s86, v12
    v_add_u32 v251, s86, v13
    s_add_u32 s86, s50, 3
    s_and_b32 s86, s86, 3
    s_lshl_b32 s86, s86, 11
    s_add_u32 s86, s86, s97
    v_add_u32 v252, s86, v12
    v_add_u32 v253, s86, v13
    v_lshrrev_b32 v15, 3, v0
    v_lshl_add_u32 v15, v15, 10, v6
    s_lshl_b32 s68, s50, 13
    s_lshl_b32 s86, s5, 7
    s_add_u32 s68, s68, s86
    s_lshl_b32 s69, s50, 10
    s_add_u32 s69, s69, 49152
    s_add_u32 m0, s97, 0
    s_add_u32 s60, s96, 0
    buffer_load_dwordx4 v244, s[24:27], s60 offen lds
    s_add_u32 m0, s97, 1024
    s_nop 0
    buffer_load_dwordx4 v245, s[24:27], s60 offen lds
    s_add_u32 m0, s97, 2048
    s_add_u32 s60, s96, 65536
    buffer_load_dwordx4 v244, s[24:27], s60 offen lds
    s_add_u32 m0, s97, 3072
    s_nop 0
    buffer_load_dwordx4 v245, s[24:27], s60 offen lds
    s_add_u32 m0, s97, 4096
    s_add_u32 s60, s96, 131072
    buffer_load_dwordx4 v244, s[24:27], s60 offen lds
    s_add_u32 m0, s97, 5120
    s_nop 0
    buffer_load_dwordx4 v245, s[24:27], s60 offen lds
    s_add_u32 m0, s97, 6144
    s_add_u32 s60, s96, 196608
    buffer_load_dwordx4 v244, s[24:27], s60 offen lds
    s_add_u32 m0, s97, 7168
    s_nop 0
    buffer_load_dwordx4 v245, s[24:27], s60 offen lds
    s_add_u32 m0, s97, 8192
    s_add_u32 s60, s96, 128
    buffer_load_dwordx4 v244, s[24:27], s60 offen lds
    s_add_u32 m0, s97, 9216
    s_nop 0
    buffer_load_dwordx4 v245, s[24:27], s60 offen lds
    s_add_u32 m0, s97, 10240
    s_add_u32 s60, s96, 65664
    buffer_load_dwordx4 v244, s[24:27], s60 offen lds
    s_add_u32 m0, s97, 11264
    s_nop 0
    buffer_load_dwordx4 v245, s[24:27], s60 offen lds
    s_add_u32 m0, s97, 12288
    s_add_u32 s60, s96, 131200
    buffer_load_dwordx4 v244, s[24:27], s60 offen lds
    s_add_u32 m0, s97, 13312
    s_nop 0
    buffer_load_dwordx4 v245, s[24:27], s60 offen lds
    s_add_u32 m0, s97, 14336
    s_add_u32 s60, s96, 196736
    buffer_load_dwordx4 v244, s[24:27], s60 offen lds
    s_add_u32 m0, s97, 15360
    s_nop 0
    buffer_load_dwordx4 v245, s[24:27], s60 offen lds
    s_add_u32 m0, s69, 86016
    s_add_u32 s61, s68, 688128
    buffer_load_dwordx4 v15, s[32:35], s61 offen lds
    s_add_u32 m0, s69, 90112
    s_add_u32 s61, s68, 720896
    buffer_load_dwordx4 v15, s[32:35], s61 offen lds
    s_add_u32 m0, s69, 94208
    s_add_u32 s61, s68, 753664
    buffer_load_dwordx4 v15, s[32:35], s61 offen lds
    s_add_u32 m0, s69, 98304
    s_add_u32 s61, s68, 786432
    buffer_load_dwordx4 v15, s[32:35], s61 offen lds
    s_add_u32 m0, s69, 102400
    s_add_u32 s61, s68, 819200
    buffer_load_dwordx4 v15, s[32:35], s61 offen lds
    s_add_u32 m0, s69, 106496
    s_add_u32 s61, s68, 851968
    buffer_load_dwordx4 v15, s[32:35], s61 offen lds
    s_add_u32 m0, s69, 110592
    s_add_u32 s61, s68, 884736
    buffer_load_dwordx4 v15, s[32:35], s61 offen lds
    s_add_u32 m0, s97, 65536
    s_add_u32 s60, s96, 768
    buffer_load_dwordx4 v244, s[24:27], s60 offen lds
    s_add_u32 m0, s97, 66560
    s_nop 0
    buffer_load_dwordx4 v245, s[24:27], s60 offen lds
    s_add_u32 m0, s97, 67584
    s_add_u32 s60, s96, 66304
    buffer_load_dwordx4 v244, s[24:27], s60 offen lds
    s_add_u32 m0, s97, 68608
    s_nop 0
    buffer_load_dwordx4 v245, s[24:27], s60 offen lds
    s_add_u32 m0, s97, 69632
    s_add_u32 s60, s96, 131840
    buffer_load_dwordx4 v244, s[24:27], s60 offen lds
    s_add_u32 m0, s97, 70656
    s_nop 0
    buffer_load_dwordx4 v245, s[24:27], s60 offen lds
    s_add_u32 m0, s97, 71680
    s_add_u32 s60, s96, 197376
    buffer_load_dwordx4 v244, s[24:27], s60 offen lds
    s_add_u32 m0, s97, 72704
    s_nop 0
    buffer_load_dwordx4 v245, s[24:27], s60 offen lds
    s_add_u32 m0, s97, 73728
    s_add_u32 s60, s96, 896
    buffer_load_dwordx4 v244, s[24:27], s60 offen lds
    s_add_u32 m0, s97, 74752
    s_nop 0
    buffer_load_dwordx4 v245, s[24:27], s60 offen lds
    s_add_u32 m0, s97, 75776
    s_add_u32 s60, s96, 66432
    buffer_load_dwordx4 v244, s[24:27], s60 offen lds
    s_add_u32 m0, s97, 76800
    s_nop 0
    buffer_load_dwordx4 v245, s[24:27], s60 offen lds
    s_add_u32 m0, s97, 77824
    s_add_u32 s60, s96, 131968
    buffer_load_dwordx4 v244, s[24:27], s60 offen lds
    s_add_u32 m0, s97, 78848
    s_nop 0
    buffer_load_dwordx4 v245, s[24:27], s60 offen lds
    s_add_u32 m0, s97, 79872
    s_add_u32 s60, s96, 197504
    buffer_load_dwordx4 v244, s[24:27], s60 offen lds
    s_add_u32 m0, s97, 80896
    s_nop 0
    buffer_load_dwordx4 v245, s[24:27], s60 offen lds
    s_waitcnt vmcnt(31)
    ds_read_b128 a[0:3], v246 offset:0
    ds_read_b128 a[4:7], v248 offset:0
    ds_read_b128 a[8:11], v250 offset:0
    ds_read_b128 a[12:15], v252 offset:0
    ds_read_b128 a[16:19], v247 offset:0
    ds_read_b128 a[20:23], v249 offset:0
    ds_read_b128 a[24:27], v251 offset:0
    ds_read_b128 a[28:31], v253 offset:0
    s_waitcnt vmcnt(23)
    ds_read_b128 a[32:35], v246 offset:8192
    ds_read_b128 a[36:39], v248 offset:8192
    ds_read_b128 a[40:43], v250 offset:8192
    ds_read_b128 a[44:47], v252 offset:8192
    ds_read_b128 a[48:51], v247 offset:8192
    ds_read_b128 a[52:55], v249 offset:8192
    ds_read_b128 a[56:59], v251 offset:8192
    ds_read_b128 a[60:63], v253 offset:8192
    s_waitcnt lgkmcnt(8)
    s_add_u32 m0, s97, 0
    s_add_u32 s60, s96, 256
    buffer_load_dwordx4 v244, s[24:27], s60 offen lds
    s_add_u32 m0, s97, 1024
    s_nop 0
    buffer_load_dwordx4 v245, s[24:27], s60 offen lds
    s_add_u32 m0, s97, 2048
    s_add_u32 s60, s96, 65792
    buffer_load_dwordx4 v244, s[24:27], s60 offen lds
    s_add_u32 m0, s97, 3072
    s_nop 0
    buffer_load_dwordx4 v245, s[24:27], s60 offen lds
    s_add_u32 m0, s97, 4096
    s_add_u32 s60, s96, 131328
    buffer_load_dwordx4 v244, s[24:27], s60 offen lds
    s_add_u32 m0, s97, 5120
    s_nop 0
    buffer_load_dwordx4 v245, s[24:27], s60 offen lds
    s_add_u32 m0, s97, 6144
    s_add_u32 s60, s96, 196864
    buffer_load_dwordx4 v244, s[24:27], s60 offen lds
    s_add_u32 m0, s97, 7168
    s_nop 0
    buffer_load_dwordx4 v245, s[24:27], s60 offen lds
    s_waitcnt lgkmcnt(0)
    s_add_u32 m0, s97, 8192
    s_add_u32 s60, s96, 384
    buffer_load_dwordx4 v244, s[24:27], s60 offen lds
    s_add_u32 m0, s97, 9216
    s_nop 0
    buffer_load_dwordx4 v245, s[24:27], s60 offen lds
    s_add_u32 m0, s97, 10240
    s_add_u32 s60, s96, 65920
    buffer_load_dwordx4 v244, s[24:27], s60 offen lds
    s_add_u32 m0, s97, 11264
    s_nop 0
    buffer_load_dwordx4 v245, s[24:27], s60 offen lds
    s_add_u32 m0, s97, 12288
    s_add_u32 s60, s96, 131456
    buffer_load_dwordx4 v244, s[24:27], s60 offen lds
    s_add_u32 m0, s97, 13312
    s_nop 0
    buffer_load_dwordx4 v245, s[24:27], s60 offen lds
    s_add_u32 m0, s97, 14336
    s_add_u32 s60, s96, 196992
    buffer_load_dwordx4 v244, s[24:27], s60 offen lds
    s_add_u32 m0, s97, 15360
    s_nop 0
    buffer_load_dwordx4 v245, s[24:27], s60 offen lds
    s_waitcnt vmcnt(8)
    ds_read_b128 a[64:67], v246 offset:0
    ds_read_b128 a[68:71], v248 offset:0
    ds_read_b128 a[72:75], v250 offset:0
    ds_read_b128 a[76:79], v252 offset:0
    ds_read_b128 a[80:83], v247 offset:0
    ds_read_b128 a[84:87], v249 offset:0
    ds_read_b128 a[88:91], v251 offset:0
    ds_read_b128 a[92:95], v253 offset:0
    s_waitcnt vmcnt(0)
    ds_read_b128 a[96:99], v246 offset:8192
    ds_read_b128 a[100:103], v248 offset:8192
    ds_read_b128 a[104:107], v250 offset:8192
    ds_read_b128 a[108:111], v252 offset:8192
    ds_read_b128 a[112:115], v247 offset:8192
    ds_read_b128 a[116:119], v249 offset:8192
    ds_read_b128 a[120:123], v251 offset:8192
    ds_read_b128 a[124:127], v253 offset:8192
    s_waitcnt lgkmcnt(8)
    s_add_u32 m0, s97, 0
    s_add_u32 s60, s96, 512
    buffer_load_dwordx4 v244, s[24:27], s60 offen lds
    s_add_u32 m0, s97, 1024
    s_nop 0
    buffer_load_dwordx4 v245, s[24:27], s60 offen lds
    s_add_u32 m0, s97, 2048
    s_add_u32 s60, s96, 66048
    buffer_load_dwordx4 v244, s[24:27], s60 offen lds
    s_add_u32 m0, s97, 3072
    s_nop 0
    buffer_load_dwordx4 v245, s[24:27], s60 offen lds
    s_add_u32 m0, s97, 4096
    s_add_u32 s60, s96, 131584
    buffer_load_dwordx4 v244, s[24:27], s60 offen lds
    s_add_u32 m0, s97, 5120
    s_nop 0
    buffer_load_dwordx4 v245, s[24:27], s60 offen lds
    s_add_u32 m0, s97, 6144
    s_add_u32 s60, s96, 197120
    buffer_load_dwordx4 v244, s[24:27], s60 offen lds
    s_add_u32 m0, s97, 7168
    s_nop 0
    buffer_load_dwordx4 v245, s[24:27], s60 offen lds
    s_waitcnt lgkmcnt(0)
    s_add_u32 m0, s97, 8192
    s_add_u32 s60, s96, 640
    buffer_load_dwordx4 v244, s[24:27], s60 offen lds
    s_add_u32 m0, s97, 9216
    s_nop 0
    buffer_load_dwordx4 v245, s[24:27], s60 offen lds
    s_add_u32 m0, s97, 10240
    s_add_u32 s60, s96, 66176
    buffer_load_dwordx4 v244, s[24:27], s60 offen lds
    s_add_u32 m0, s97, 11264
    s_nop 0
    buffer_load_dwordx4 v245, s[24:27], s60 offen lds
    s_add_u32 m0, s97, 12288
    s_add_u32 s60, s96, 131712
    buffer_load_dwordx4 v244, s[24:27], s60 offen lds
    s_add_u32 m0, s97, 13312
    s_nop 0
    buffer_load_dwordx4 v245, s[24:27], s60 offen lds
    s_add_u32 m0, s97, 14336
    s_add_u32 s60, s96, 197248
    buffer_load_dwordx4 v244, s[24:27], s60 offen lds
    s_add_u32 m0, s97, 15360
    s_nop 0
    buffer_load_dwordx4 v245, s[24:27], s60 offen lds
    s_mul_i32 s90, s63, 7
    s_add_u32 s91, s90, 6
    s_lshr_b32 s90, s90, 2
    s_lshr_b32 s91, s91, 2
    s_lshl_b32 s92, s63, 6
    s_lshl_b32 s86, s50, 4
    s_add_u32 s92, s92, s86
    s_mul_i32 s92, s92, 7168
    s_add_u32 s92, s92, 5242880
    v_add_u32 v18, 4096, v1
    s_lshl_b32 s86, s90, 4
    s_lshl_b32 s87, s91, 4
    s_add_u32 s87, s87, 15
    v_add_u32 v16, s86, v0
    v_min_u32 v16, s87, v16
    v_lshlrev_b32 v16, 2, v16
    s_lshl_b32 s75, s48, 10
    s_add_u32 s75, s75, 10240
    buffer_load_dword v17, v16, s[40:43], s75 offen sc1
    s_mov_b32 s93, 18874368
    s_mov_b32 s94, 18874368
    v_lshlrev_b32 v13, 3, v0
    s_waitcnt vmcnt(0) lgkmcnt(0)
L_p3join:
    s_cmp_lg_u32 s50, 0
    s_cbranch_scc1 Lw30
    s_mov_b32 s51, 0
    s_waitcnt vmcnt(16)
    v_cmp_ne_u32 vcc, s4, v17
    s_nop 0
    s_cbranch_vccz Le32
Lk31:
    buffer_load_dword v17, v16, s[40:43], s75 offen sc1
    s_waitcnt vmcnt(0)
    v_cmp_ne_u32 vcc, s4, v17
    s_add_u32 s51, s51, 1
    s_cbranch_vccz Le32
    s_cmp_lt_u32 s51, 65536
    s_cbranch_scc1 Lk31
Le32:
Lw30:
    s_barrier
    v_mov_b32 v14, v18
    s_add_u32 s60, s92, 0
    buffer_load_dwordx4 v[128:131], v1, s[40:43], s60 offen offset:0 sc1
    buffer_load_dwordx4 v[132:135], v1, s[40:43], s60 offen offset:1024 sc1
    buffer_load_dwordx4 v[136:139], v1, s[40:43], s60 offen offset:2048 sc1
    buffer_load_dwordx4 v[140:143], v1, s[40:43], s60 offen offset:3072 sc1
    buffer_load_dwordx4 v[144:147], v14, s[40:43], s60 offen offset:0 sc1
    buffer_load_dwordx4 v[148:151], v14, s[40:43], s60 offen offset:1024 sc1
    buffer_load_dwordx4 v[152:155], v14, s[40:43], s60 offen offset:2048 sc1
    s_add_u32 s60, s92, 7168
    buffer_load_dwordx4 v[156:159], v1, s[40:43], s60 offen offset:0 sc1
    buffer_load_dwordx4 v[160:163], v1, s[40:43], s60 offen offset:1024 sc1
    buffer_load_dwordx4 v[164:167], v1, s[40:43], s60 offen offset:2048 sc1
    buffer_load_dwordx4 v[168:171], v1, s[40:43], s60 offen offset:3072 sc1
    buffer_load_dwordx4 v[172:175], v14, s[40:43], s60 offen offset:0 sc1
    buffer_load_dwordx4 v[176:179], v14, s[40:43], s60 offen offset:1024 sc1
    buffer_load_dwordx4 v[180:183], v14, s[40:43], s60 offen offset:2048 sc1
    v_mov_b32 v244, 0xc0135761
    v_mov_b32 v245, 0xc0135761
    s_add_u32 s60, s92, 14336
    v_pk_mul_f32 v[112:113], v[212:213], v[212:213]
    v_pk_mul_f32 v[114:115], v[214:215], v[214:215]
    v_pk_mul_f32 v[116:117], v[216:217], v[216:217]
    v_pk_mul_f32 v[118:119], v[218:219], v[218:219]
    v_pk_fma_f32 v[112:113], v[112:113], s[56:57], v[244:245]
    v_pk_fma_f32 v[114:115], v[114:115], s[56:57], v[244:245]
    v_pk_fma_f32 v[116:117], v[116:117], s[56:57], v[244:245]
    v_pk_fma_f32 v[118:119], v[118:119], s[56:57], v[244:245]
    v_pk_mul_f32 v[112:113], v[112:113], v[212:213]
    v_pk_mul_f32 v[114:115], v[114:115], v[214:215]
    v_pk_mul_f32 v[116:117], v[116:117], v[216:217]
    v_pk_mul_f32 v[118:119], v[118:119], v[218:219]
    buffer_load_dwordx4 v[184:187], v1, s[40:43], s60 offen offset:0 sc1
    v_exp_f32 v112, v112
    v_exp_f32 v114, v114
    v_exp_f32 v116, v116
    v_exp_f32 v118, v118
    v_exp_f32 v113, v113
    v_exp_f32 v115, v115
    v_exp_f32 v117, v117
    v_exp_f32 v119, v119
    v_pk_add_f32 v[112:113], v[112:113], s[58:59]
    v_pk_add_f32 v[114:115], v[114:115], s[58:59]
    v_pk_add_f32 v[116:117], v[116:117], s[58:59]
    v_pk_add_f32 v[118:119], v[118:119], s[58:59]
    v_rcp_f32 v112, v112
    v_rcp_f32 v114, v114
    v_rcp_f32 v116, v116
    v_rcp_f32 v118, v118
    v_rcp_f32 v113, v113
    v_rcp_f32 v115, v115
    v_rcp_f32 v117, v117
    v_rcp_f32 v119, v119
    v_pk_mul_f32 v[212:213], v[212:213], v[112:113]
    v_pk_mul_f32 v[214:215], v[214:215], v[114:115]
    v_pk_mul_f32 v[216:217], v[216:217], v[116:117]
    v_pk_mul_f32 v[218:219], v[218:219], v[118:119]
    buffer_load_dwordx4 v[188:191], v1, s[40:43], s60 offen offset:1024 sc1
    v_cvt_pk_bf16_f32 v212, v212, v213
    v_cvt_pk_bf16_f32 v213, v214, v215
    buffer_store_dwordx2 v[212:213], v13, s[40:43], s93 offen offset:0 sc1
    v_cvt_pk_bf16_f32 v216, v216, v217
    v_cvt_pk_bf16_f32 v217, v218, v219
    buffer_store_dwordx2 v[216:217], v13, s[40:43], s93 offen offset:512 sc1
    v_pk_mul_f32 v[112:113], v[220:221], v[220:221]
    v_pk_mul_f32 v[114:115], v[222:223], v[222:223]
    v_pk_mul_f32 v[116:117], v[224:225], v[224:225]
    v_pk_mul_f32 v[118:119], v[226:227], v[226:227]
    v_pk_fma_f32 v[112:113], v[112:113], s[56:57], v[244:245]
    v_pk_fma_f32 v[114:115], v[114:115], s[56:57], v[244:245]
    v_pk_fma_f32 v[116:117], v[116:117], s[56:57], v[244:245]
    v_pk_fma_f32 v[118:119], v[118:119], s[56:57], v[244:245]
    v_pk_mul_f32 v[112:113], v[112:113], v[220:221]
    v_pk_mul_f32 v[114:115], v[114:115], v[222:223]
    v_pk_mul_f32 v[116:117], v[116:117], v[224:225]
    v_pk_mul_f32 v[118:119], v[118:119], v[226:227]
    v_exp_f32 v112, v112
    v_exp_f32 v114, v114
    v_exp_f32 v116, v116
    v_exp_f32 v118, v118
    v_exp_f32 v113, v113
    v_exp_f32 v115, v115
    buffer_load_dwordx4 v[192:195], v1, s[40:43], s60 offen offset:2048 sc1
    v_exp_f32 v117, v117
    v_exp_f32 v119, v119
    v_pk_add_f32 v[112:113], v[112:113], s[58:59]
    v_pk_add_f32 v[114:115], v[114:115], s[58:59]
    v_pk_add_f32 v[116:117], v[116:117], s[58:59]
    v_pk_add_f32 v[118:119], v[118:119], s[58:59]
    v_rcp_f32 v112, v112
    v_rcp_f32 v114, v114
    v_rcp_f32 v116, v116
    v_rcp_f32 v118, v118
    v_rcp_f32 v113, v113
    v_rcp_f32 v115, v115
    v_rcp_f32 v117, v117
    v_rcp_f32 v119, v119
    v_pk_mul_f32 v[220:221], v[220:221], v[112:113]
    v_pk_mul_f32 v[222:223], v[222:223], v[114:115]
    v_pk_mul_f32 v[224:225], v[224:225], v[116:117]
    v_pk_mul_f32 v[226:227], v[226:227], v[118:119]
    v_cvt_pk_bf16_f32 v220, v220, v221
    v_cvt_pk_bf16_f32 v221, v222, v223
    buffer_store_dwordx2 v[220:221], v13, s[40:43], s93 offen offset:1024 sc1
    v_cvt_pk_bf16_f32 v224, v224, v225
    v_cvt_pk_bf16_f32 v225, v226, v227
    buffer_store_dwordx2 v[224:225], v13, s[40:43], s93 offen offset:1536 sc1
    buffer_load_dwordx4 v[196:199], v1, s[40:43], s60 offen offset:3072 sc1
    v_pk_mul_f32 v[112:113], v[228:229], v[228:229]
    v_pk_mul_f32 v[114:115], v[230:231], v[230:231]
    v_pk_mul_f32 v[116:117], v[232:233], v[232:233]
    v_pk_mul_f32 v[118:119], v[234:235], v[234:235]
    v_pk_fma_f32 v[112:113], v[112:113], s[56:57], v[244:245]
    v_pk_fma_f32 v[114:115], v[114:115], s[56:57], v[244:245]
    v_pk_fma_f32 v[116:117], v[116:117], s[56:57], v[244:245]
    v_pk_fma_f32 v[118:119], v[118:119], s[56:57], v[244:245]
    v_pk_mul_f32 v[112:113], v[112:113], v[228:229]
    v_pk_mul_f32 v[114:115], v[114:115], v[230:231]
    v_pk_mul_f32 v[116:117], v[116:117], v[232:233]
    v_pk_mul_f32 v[118:119], v[118:119], v[234:235]
    v_exp_f32 v112, v112
    v_exp_f32 v114, v114
    v_exp_f32 v116, v116
    v_exp_f32 v118, v118
    v_exp_f32 v113, v113
    v_exp_f32 v115, v115
    v_exp_f32 v117, v117
    v_exp_f32 v119, v119
    v_pk_add_f32 v[112:113], v[112:113], s[58:59]
    v_pk_add_f32 v[114:115], v[114:115], s[58:59]
    v_pk_add_f32 v[116:117], v[116:117], s[58:59]
    v_pk_add_f32 v[118:119], v[118:119], s[58:59]
    buffer_load_dwordx4 v[200:203], v14, s[40:43], s60 offen offset:0 sc1
    v_rcp_f32 v112, v112
    v_rcp_f32 v114, v114
    v_rcp_f32 v116, v116
    v_rcp_f32 v118, v118
    v_rcp_f32 v113, v113
    v_rcp_f32 v115, v115
    v_rcp_f32 v117, v117
    v_rcp_f32 v119, v119
    v_pk_mul_f32 v[228:229], v[228:229], v[112:113]
    v_pk_mul_f32 v[230:231], v[230:231], v[114:115]
    v_pk_mul_f32 v[232:233], v[232:233], v[116:117]
    v_pk_mul_f32 v[234:235], v[234:235], v[118:119]
    v_cvt_pk_bf16_f32 v228, v228, v229
    v_cvt_pk_bf16_f32 v229, v230, v231
    buffer_store_dwordx2 v[228:229], v13, s[40:43], s94 offen offset:0 sc1
    v_cvt_pk_bf16_f32 v232, v232, v233
    v_cvt_pk_bf16_f32 v233, v234, v235
    buffer_store_dwordx2 v[232:233], v13, s[40:43], s94 offen offset:512 sc1
    v_pk_mul_f32 v[112:113], v[236:237], v[236:237]
    v_pk_mul_f32 v[114:115], v[238:239], v[238:239]
    v_pk_mul_f32 v[116:117], v[240:241], v[240:241]
    v_pk_mul_f32 v[118:119], v[242:243], v[242:243]
    v_pk_fma_f32 v[112:113], v[112:113], s[56:57], v[244:245]
    v_pk_fma_f32 v[114:115], v[114:115], s[56:57], v[244:245]
    buffer_load_dwordx4 v[204:207], v14, s[40:43], s60 offen offset:1024 sc1
    v_pk_fma_f32 v[116:117], v[116:117], s[56:57], v[244:245]
    v_pk_fma_f32 v[118:119], v[118:119], s[56:57], v[244:245]
    v_pk_mul_f32 v[112:113], v[112:113], v[236:237]
    v_pk_mul_f32 v[114:115], v[114:115], v[238:239]
    v_pk_mul_f32 v[116:117], v[116:117], v[240:241]
    v_pk_mul_f32 v[118:119], v[118:119], v[242:243]
    v_exp_f32 v112, v112
    v_exp_f32 v114, v114
    v_exp_f32 v116, v116
    v_exp_f32 v118, v118
    v_exp_f32 v113, v113
    v_exp_f32 v115, v115
    v_exp_f32 v117, v117
    v_exp_f32 v119, v119
    v_pk_add_f32 v[112:113], v[112:113], s[58:59]
    v_pk_add_f32 v[114:115], v[114:115], s[58:59]
    v_pk_add_f32 v[116:117], v[116:117], s[58:59]
    v_pk_add_f32 v[118:119], v[118:119], s[58:59]
    v_rcp_f32 v112, v112
    v_rcp_f32 v114, v114
    v_rcp_f32 v116, v116
    v_rcp_f32 v118, v118
    v_rcp_f32 v113, v113
    v_rcp_f32 v115, v115
    buffer_load_dwordx4 v[208:211], v14, s[40:43], s60 offen offset:2048 sc1
    v_rcp_f32 v117, v117
    v_rcp_f32 v119, v119
    v_pk_mul_f32 v[236:237], v[236:237], v[112:113]
    v_pk_mul_f32 v[238:239], v[238:239], v[114:115]
    v_pk_mul_f32 v[240:241], v[240:241], v[116:117]
    v_pk_mul_f32 v[242:243], v[242:243], v[118:119]
    v_cvt_pk_bf16_f32 v236, v236, v237
    v_cvt_pk_bf16_f32 v237, v238, v239
    buffer_store_dwordx2 v[236:237], v13, s[40:43], s94 offen offset:1024 sc1
    v_cvt_pk_bf16_f32 v240, v240, v241
    v_cvt_pk_bf16_f32 v241, v242, v243
    buffer_store_dwordx2 v[240:241], v13, s[40:43], s94 offen offset:1536 sc1
    s_waitcnt vmcnt(28)
    v_mfma_f32_16x16x32_bf16 v[16:19], v[128:131], a[0:3], 0
    v_mfma_f32_16x16x32_bf16 v[44:47], v[128:131], a[4:7], 0
    v_mfma_f32_16x16x32_bf16 v[72:75], v[128:131], a[8:11], 0
    v_mfma_f32_16x16x32_bf16 v[100:103], v[128:131], a[12:15], 0
    s_waitcnt vmcnt(27)
    v_mfma_f32_16x16x32_bf16 v[20:23], v[132:135], a[0:3], 0
    v_mfma_f32_16x16x32_bf16 v[48:51], v[132:135], a[4:7], 0
    v_mfma_f32_16x16x32_bf16 v[76:79], v[132:135], a[8:11], 0
    v_mfma_f32_16x16x32_bf16 v[104:107], v[132:135], a[12:15], 0
    s_waitcnt vmcnt(26)
    v_mfma_f32_16x16x32_bf16 v[24:27], v[136:139], a[0:3], 0
    v_mfma_f32_16x16x32_bf16 v[52:55], v[136:139], a[4:7], 0
    v_mfma_f32_16x16x32_bf16 v[80:83], v[136:139], a[8:11], 0
    v_mfma_f32_16x16x32_bf16 v[108:111], v[136:139], a[12:15], 0
    s_waitcnt vmcnt(25)
    v_mfma_f32_16x16x32_bf16 v[28:31], v[140:143], a[0:3], 0
    v_mfma_f32_16x16x32_bf16 v[56:59], v[140:143], a[4:7], 0
    v_mfma_f32_16x16x32_bf16 v[84:87], v[140:143], a[8:11], 0
    v_mfma_f32_16x16x32_bf16 v[112:115], v[140:143], a[12:15], 0
    s_waitcnt vmcnt(24)
    v_mfma_f32_16x16x32_bf16 v[32:35], v[144:147], a[0:3], 0
    v_mfma_f32_16x16x32_bf16 v[60:63], v[144:147], a[4:7], 0
    v_mfma_f32_16x16x32_bf16 v[88:91], v[144:147], a[8:11], 0
    v_mfma_f32_16x16x32_bf16 v[116:119], v[144:147], a[12:15], 0
    s_waitcnt vmcnt(23)
    v_mfma_f32_16x16x32_bf16 v[36:39], v[148:151], a[0:3], 0
    v_mfma_f32_16x16x32_bf16 v[64:67], v[148:151], a[4:7], 0
    v_mfma_f32_16x16x32_bf16 v[92:95], v[148:151], a[8:11], 0
    v_mfma_f32_16x16x32_bf16 v[120:123], v[148:151], a[12:15], 0
    s_waitcnt vmcnt(22)
    v_mfma_f32_16x16x32_bf16 v[40:43], v[152:155], a[0:3], 0
    v_mfma_f32_16x16x32_bf16 v[68:71], v[152:155], a[4:7], 0
    v_mfma_f32_16x16x32_bf16 v[96:99], v[152:155], a[8:11], 0
    v_mfma_f32_16x16x32_bf16 v[124:127], v[152:155], a[12:15], 0
    s_waitcnt vmcnt(21)
    v_mfma_f32_16x16x32_bf16 v[16:19], v[156:159], a[16:19], v[16:19]
    v_mfma_f32_16x16x32_bf16 v[44:47], v[156:159], a[20:23], v[44:47]
    s_add_u32 s60, s92, 21504
    v_mfma_f32_16x16x32_bf16 v[72:75], v[156:159], a[24:27], v[72:75]
    buffer_load_dwordx4 v[128:131], v1, s[40:43], s60 offen offset:0 sc1
    v_mfma_f32_16x16x32_bf16 v[100:103], v[156:159], a[28:31], v[100:103]
    s_waitcnt vmcnt(21)
    v_mfma_f32_16x16x32_bf16 v[20:23], v[160:163], a[16:19], v[20:23]
    v_mfma_f32_16x16x32_bf16 v[48:51], v[160:163], a[20:23], v[48:51]
    buffer_load_dwordx4 v[132:135], v1, s[40:43], s60 offen offset:1024 sc1
    v_mfma_f32_16x16x32_bf16 v[76:79], v[160:163], a[24:27], v[76:79]
    ds_read_b128 a[128:131], v246 offset:0
    v_mfma_f32_16x16x32_bf16 v[104:107], v[160:163], a[28:31], v[104:107]
    s_waitcnt vmcnt(21)
    v_mfma_f32_16x16x32_bf16 v[24:27], v[164:167], a[16:19], v[24:27]
    buffer_load_dwordx4 v[136:139], v1, s[40:43], s60 offen offset:2048 sc1
    v_mfma_f32_16x16x32_bf16 v[52:55], v[164:167], a[20:23], v[52:55]
    ds_read_b128 a[132:135], v248 offset:0
    v_mfma_f32_16x16x32_bf16 v[80:83], v[164:167], a[24:27], v[80:83]
    v_mfma_f32_16x16x32_bf16 v[108:111], v[164:167], a[28:31], v[108:111]
    buffer_load_dwordx4 v[140:143], v1, s[40:43], s60 offen offset:3072 sc1
    s_waitcnt vmcnt(22)
    v_mfma_f32_16x16x32_bf16 v[28:31], v[168:171], a[16:19], v[28:31]
    ds_read_b128 a[136:139], v250 offset:0
    v_mfma_f32_16x16x32_bf16 v[56:59], v[168:171], a[20:23], v[56:59]
    v_mfma_f32_16x16x32_bf16 v[84:87], v[168:171], a[24:27], v[84:87]
    buffer_load_dwordx4 v[144:147], v14, s[40:43], s60 offen offset:0 sc1
    v_mfma_f32_16x16x32_bf16 v[112:115], v[168:171], a[28:31], v[112:115]
    ds_read_b128 a[140:143], v252 offset:0
    s_waitcnt vmcnt(22)
    v_mfma_f32_16x16x32_bf16 v[32:35], v[172:175], a[16:19], v[32:35]
    v_mfma_f32_16x16x32_bf16 v[60:63], v[172:175], a[20:23], v[60:63]
    buffer_load_dwordx4 v[148:151], v14, s[40:43], s60 offen offset:1024 sc1
    v_mfma_f32_16x16x32_bf16 v[88:91], v[172:175], a[24:27], v[88:91]
    ds_read_b128 a[144:147], v247 offset:0
    v_mfma_f32_16x16x32_bf16 v[116:119], v[172:175], a[28:31], v[116:119]
    s_waitcnt vmcnt(22)
    v_mfma_f32_16x16x32_bf16 v[36:39], v[176:179], a[16:19], v[36:39]
    buffer_load_dwordx4 v[152:155], v14, s[40:43], s60 offen offset:2048 sc1
    v_mfma_f32_16x16x32_bf16 v[64:67], v[176:179], a[20:23], v[64:67]
    ds_read_b128 a[148:151], v249 offset:0
    v_mfma_f32_16x16x32_bf16 v[92:95], v[176:179], a[24:27], v[92:95]
    v_mfma_f32_16x16x32_bf16 v[120:123], v[176:179], a[28:31], v[120:123]
    s_waitcnt vmcnt(22)
    v_mfma_f32_16x16x32_bf16 v[40:43], v[180:183], a[16:19], v[40:43]
    ds_read_b128 a[152:155], v251 offset:0
    v_mfma_f32_16x16x32_bf16 v[68:71], v[180:183], a[20:23], v[68:71]
    v_mfma_f32_16x16x32_bf16 v[96:99], v[180:183], a[24:27], v[96:99]
    v_mfma_f32_16x16x32_bf16 v[124:127], v[180:183], a[28:31], v[124:127]
    ds_read_b128 a[156:159], v253 offset:0
    s_waitcnt vmcnt(21)
    v_mfma_f32_16x16x32_bf16 v[16:19], v[184:187], a[32:35], v[16:19]
    v_mfma_f32_16x16x32_bf16 v[44:47], v[184:187], a[36:39], v[44:47]
    s_add_u32 s60, s92, 28672
    v_mfma_f32_16x16x32_bf16 v[72:75], v[184:187], a[40:43], v[72:75]
    buffer_load_dwordx4 v[156:159], v1, s[40:43], s60 offen offset:0 sc1
    v_mfma_f32_16x16x32_bf16 v[100:103], v[184:187], a[44:47], v[100:103]
    s_waitcnt vmcnt(21)
    v_mfma_f32_16x16x32_bf16 v[20:23], v[188:191], a[32:35], v[20:23]
    v_mfma_f32_16x16x32_bf16 v[48:51], v[188:191], a[36:39], v[48:51]
    buffer_load_dwordx4 v[160:163], v1, s[40:43], s60 offen offset:1024 sc1
    v_mfma_f32_16x16x32_bf16 v[76:79], v[188:191], a[40:43], v[76:79]
    ds_read_b128 a[160:163], v246 offset:8192
    v_mfma_f32_16x16x32_bf16 v[104:107], v[188:191], a[44:47], v[104:107]
    s_waitcnt vmcnt(19)
    v_mfma_f32_16x16x32_bf16 v[24:27], v[192:195], a[32:35], v[24:27]
    buffer_load_dwordx4 v[164:167], v1, s[40:43], s60 offen offset:2048 sc1
    v_mfma_f32_16x16x32_bf16 v[52:55], v[192:195], a[36:39], v[52:55]
    ds_read_b128 a[164:167], v248 offset:8192
    v_mfma_f32_16x16x32_bf16 v[80:83], v[192:195], a[40:43], v[80:83]
    v_mfma_f32_16x16x32_bf16 v[108:111], v[192:195], a[44:47], v[108:111]
    buffer_load_dwordx4 v[168:171], v1, s[40:43], s60 offen offset:3072 sc1
    s_waitcnt vmcnt(18)
    v_mfma_f32_16x16x32_bf16 v[28:31], v[196:199], a[32:35], v[28:31]
    ds_read_b128 a[168:171], v250 offset:8192
    v_mfma_f32_16x16x32_bf16 v[56:59], v[196:199], a[36:39], v[56:59]
    v_mfma_f32_16x16x32_bf16 v[84:87], v[196:199], a[40:43], v[84:87]
    buffer_load_dwordx4 v[172:175], v14, s[40:43], s60 offen offset:0 sc1
    v_mfma_f32_16x16x32_bf16 v[112:115], v[196:199], a[44:47], v[112:115]
    ds_read_b128 a[172:175], v252 offset:8192
    s_waitcnt vmcnt(18)
    v_mfma_f32_16x16x32_bf16 v[32:35], v[200:203], a[32:35], v[32:35]
    v_mfma_f32_16x16x32_bf16 v[60:63], v[200:203], a[36:39], v[60:63]
    buffer_load_dwordx4 v[176:179], v14, s[40:43], s60 offen offset:1024 sc1
    v_mfma_f32_16x16x32_bf16 v[88:91], v[200:203], a[40:43], v[88:91]
    ds_read_b128 a[176:179], v247 offset:8192
    v_mfma_f32_16x16x32_bf16 v[116:119], v[200:203], a[44:47], v[116:119]
    s_waitcnt vmcnt(16)
    v_mfma_f32_16x16x32_bf16 v[36:39], v[204:207], a[32:35], v[36:39]
    buffer_load_dwordx4 v[180:183], v14, s[40:43], s60 offen offset:2048 sc1
    v_mfma_f32_16x16x32_bf16 v[64:67], v[204:207], a[36:39], v[64:67]
    ds_read_b128 a[180:183], v249 offset:8192
    v_mfma_f32_16x16x32_bf16 v[92:95], v[204:207], a[40:43], v[92:95]
    v_mfma_f32_16x16x32_bf16 v[120:123], v[204:207], a[44:47], v[120:123]
    s_waitcnt vmcnt(16)
    v_mfma_f32_16x16x32_bf16 v[40:43], v[208:211], a[32:35], v[40:43]
    ds_read_b128 a[184:187], v251 offset:8192
    v_mfma_f32_16x16x32_bf16 v[68:71], v[208:211], a[36:39], v[68:71]
    v_mfma_f32_16x16x32_bf16 v[96:99], v[208:211], a[40:43], v[96:99]
    v_mfma_f32_16x16x32_bf16 v[124:127], v[208:211], a[44:47], v[124:127]
    ds_read_b128 a[188:191], v253 offset:8192
    s_waitcnt vmcnt(13)
    v_mfma_f32_16x16x32_bf16 v[16:19], v[128:131], a[48:51], v[16:19]
    v_mfma_f32_16x16x32_bf16 v[44:47], v[128:131], a[52:55], v[44:47]
    v_xor_b32 v246, 0x10000, v246
    s_add_u32 s60, s92, 35840
    v_mfma_f32_16x16x32_bf16 v[72:75], v[128:131], a[56:59], v[72:75]
    buffer_load_dwordx4 v[184:187], v1, s[40:43], s60 offen offset:0 sc1
    v_mfma_f32_16x16x32_bf16 v[100:103], v[128:131], a[60:63], v[100:103]
    v_xor_b32 v247, 0x10000, v247
    s_waitcnt vmcnt(13)
    v_mfma_f32_16x16x32_bf16 v[20:23], v[132:135], a[48:51], v[20:23]
    v_xor_b32 v248, 0x10000, v248
    v_mfma_f32_16x16x32_bf16 v[48:51], v[132:135], a[52:55], v[48:51]
    buffer_load_dwordx4 v[188:191], v1, s[40:43], s60 offen offset:1024 sc1
    v_mfma_f32_16x16x32_bf16 v[76:79], v[132:135], a[56:59], v[76:79]
    v_xor_b32 v249, 0x10000, v249
    v_mfma_f32_16x16x32_bf16 v[104:107], v[132:135], a[60:63], v[104:107]
    s_waitcnt vmcnt(13)
    v_mfma_f32_16x16x32_bf16 v[24:27], v[136:139], a[48:51], v[24:27]
    v_xor_b32 v250, 0x10000, v250
    buffer_load_dwordx4 v[192:195], v1, s[40:43], s60 offen offset:2048 sc1
    v_mfma_f32_16x16x32_bf16 v[52:55], v[136:139], a[52:55], v[52:55]
    v_xor_b32 v251, 0x10000, v251
    v_mfma_f32_16x16x32_bf16 v[80:83], v[136:139], a[56:59], v[80:83]
    v_mfma_f32_16x16x32_bf16 v[108:111], v[136:139], a[60:63], v[108:111]
    v_xor_b32 v252, 0x10000, v252
    buffer_load_dwordx4 v[196:199], v1, s[40:43], s60 offen offset:3072 sc1
    s_waitcnt vmcnt(14)
    v_mfma_f32_16x16x32_bf16 v[28:31], v[140:143], a[48:51], v[28:31]
    v_mfma_f32_16x16x32_bf16 v[56:59], v[140:143], a[52:55], v[56:59]
    v_xor_b32 v253, 0x10000, v253
    v_mfma_f32_16x16x32_bf16 v[84:87], v[140:143], a[56:59], v[84:87]
    buffer_load_dwordx4 v[200:203], v14, s[40:43], s60 offen offset:0 sc1
    v_mfma_f32_16x16x32_bf16 v[112:115], v[140:143], a[60:63], v[112:115]
    s_waitcnt vmcnt(14)
    v_mfma_f32_16x16x32_bf16 v[32:35], v[144:147], a[48:51], v[32:35]
    ds_read_b128 a[192:195], v246 offset:0
    v_mfma_f32_16x16x32_bf16 v[60:63], v[144:147], a[52:55], v[60:63]
    buffer_load_dwordx4 v[204:207], v14, s[40:43], s60 offen offset:1024 sc1
    v_mfma_f32_16x16x32_bf16 v[88:91], v[144:147], a[56:59], v[88:91]
    ds_read_b128 a[196:199], v248 offset:0
    v_mfma_f32_16x16x32_bf16 v[116:119], v[144:147], a[60:63], v[116:119]
    ds_read_b128 a[200:203], v250 offset:0
    s_waitcnt vmcnt(14)
    v_mfma_f32_16x16x32_bf16 v[36:39], v[148:151], a[48:51], v[36:39]
    buffer_load_dwordx4 v[208:211], v14, s[40:43], s60 offen offset:2048 sc1
    v_mfma_f32_16x16x32_bf16 v[64:67], v[148:151], a[52:55], v[64:67]
    ds_read_b128 a[204:207], v252 offset:0
    v_mfma_f32_16x16x32_bf16 v[92:95], v[148:151], a[56:59], v[92:95]
    v_mfma_f32_16x16x32_bf16 v[120:123], v[148:151], a[60:63], v[120:123]
    ds_read_b128 a[208:211], v247 offset:0
    s_waitcnt vmcnt(14)
    v_mfma_f32_16x16x32_bf16 v[40:43], v[152:155], a[48:51], v[40:43]
    ds_read_b128 a[212:215], v249 offset:0
    v_mfma_f32_16x16x32_bf16 v[68:71], v[152:155], a[52:55], v[68:71]
    v_mfma_f32_16x16x32_bf16 v[96:99], v[152:155], a[56:59], v[96:99]
    ds_read_b128 a[216:219], v251 offset:0
    v_mfma_f32_16x16x32_bf16 v[124:127], v[152:155], a[60:63], v[124:127]
    ds_read_b128 a[220:223], v253 offset:0
    s_waitcnt vmcnt(13)
    v_mfma_f32_16x16x32_bf16 v[16:19], v[156:159], a[64:67], v[16:19]
    v_mfma_f32_16x16x32_bf16 v[44:47], v[156:159], a[68:71], v[44:47]
    s_add_u32 s60, s92, 43008
    v_mfma_f32_16x16x32_bf16 v[72:75], v[156:159], a[72:75], v[72:75]
    buffer_load_dwordx4 v[128:131], v1, s[40:43], s60 offen offset:0 sc1
    v_mfma_f32_16x16x32_bf16 v[100:103], v[156:159], a[76:79], v[100:103]
    s_waitcnt vmcnt(13)
    v_mfma_f32_16x16x32_bf16 v[20:23], v[160:163], a[64:67], v[20:23]
    v_mfma_f32_16x16x32_bf16 v[48:51], v[160:163], a[68:71], v[48:51]
    buffer_load_dwordx4 v[132:135], v1, s[40:43], s60 offen offset:1024 sc1
    v_mfma_f32_16x16x32_bf16 v[76:79], v[160:163], a[72:75], v[76:79]
    ds_read_b128 a[224:227], v246 offset:8192
    v_mfma_f32_16x16x32_bf16 v[104:107], v[160:163], a[76:79], v[104:107]
    s_waitcnt vmcnt(13)
    v_mfma_f32_16x16x32_bf16 v[24:27], v[164:167], a[64:67], v[24:27]
    buffer_load_dwordx4 v[136:139], v1, s[40:43], s60 offen offset:2048 sc1
    v_mfma_f32_16x16x32_bf16 v[52:55], v[164:167], a[68:71], v[52:55]
    ds_read_b128 a[228:231], v248 offset:8192
    v_mfma_f32_16x16x32_bf16 v[80:83], v[164:167], a[72:75], v[80:83]
    v_mfma_f32_16x16x32_bf16 v[108:111], v[164:167], a[76:79], v[108:111]
    buffer_load_dwordx4 v[140:143], v1, s[40:43], s60 offen offset:3072 sc1
    s_waitcnt vmcnt(14)
    v_mfma_f32_16x16x32_bf16 v[28:31], v[168:171], a[64:67], v[28:31]
    ds_read_b128 a[232:235], v250 offset:8192
    v_mfma_f32_16x16x32_bf16 v[56:59], v[168:171], a[68:71], v[56:59]
    v_mfma_f32_16x16x32_bf16 v[84:87], v[168:171], a[72:75], v[84:87]
    buffer_load_dwordx4 v[144:147], v14, s[40:43], s60 offen offset:0 sc1
    v_mfma_f32_16x16x32_bf16 v[112:115], v[168:171], a[76:79], v[112:115]
    ds_read_b128 a[236:239], v252 offset:8192
    s_waitcnt vmcnt(14)
    v_mfma_f32_16x16x32_bf16 v[32:35], v[172:175], a[64:67], v[32:35]
    v_mfma_f32_16x16x32_bf16 v[60:63], v[172:175], a[68:71], v[60:63]
    buffer_load_dwordx4 v[148:151], v14, s[40:43], s60 offen offset:1024 sc1
    v_mfma_f32_16x16x32_bf16 v[88:91], v[172:175], a[72:75], v[88:91]
    ds_read_b128 a[240:243], v247 offset:8192
    v_mfma_f32_16x16x32_bf16 v[116:119], v[172:175], a[76:79], v[116:119]
    s_waitcnt vmcnt(14)
    v_mfma_f32_16x16x32_bf16 v[36:39], v[176:179], a[64:67], v[36:39]
    buffer_load_dwordx4 v[152:155], v14, s[40:43], s60 offen offset:2048 sc1
    v_mfma_f32_16x16x32_bf16 v[64:67], v[176:179], a[68:71], v[64:67]
    ds_read_b128 a[244:247], v249 offset:8192
    v_mfma_f32_16x16x32_bf16 v[92:95], v[176:179], a[72:75], v[92:95]
    v_mfma_f32_16x16x32_bf16 v[120:123], v[176:179], a[76:79], v[120:123]
    s_waitcnt vmcnt(14)
    v_mfma_f32_16x16x32_bf16 v[40:43], v[180:183], a[64:67], v[40:43]
    ds_read_b128 a[248:251], v251 offset:8192
    v_mfma_f32_16x16x32_bf16 v[68:71], v[180:183], a[68:71], v[68:71]
    v_mfma_f32_16x16x32_bf16 v[96:99], v[180:183], a[72:75], v[96:99]
    v_mfma_f32_16x16x32_bf16 v[124:127], v[180:183], a[76:79], v[124:127]
    ds_read_b128 a[252:255], v253 offset:8192
    s_waitcnt vmcnt(13)
    v_mfma_f32_16x16x32_bf16 v[16:19], v[184:187], a[80:83], v[16:19]
    v_mfma_f32_16x16x32_bf16 v[44:47], v[184:187], a[84:87], v[44:47]
    s_add_u32 s60, s92, 50176
    v_mfma_f32_16x16x32_bf16 v[72:75], v[184:187], a[88:91], v[72:75]
    buffer_load_dwordx4 v[156:159], v1, s[40:43], s60 offen offset:0 sc1
    v_mfma_f32_16x16x32_bf16 v[100:103], v[184:187], a[92:95], v[100:103]
    s_waitcnt vmcnt(13)
    v_mfma_f32_16x16x32_bf16 v[20:23], v[188:191], a[80:83], v[20:23]
    v_mfma_f32_16x16x32_bf16 v[48:51], v[188:191], a[84:87], v[48:51]
    buffer_load_dwordx4 v[160:163], v1, s[40:43], s60 offen offset:1024 sc1
    v_mfma_f32_16x16x32_bf16 v[76:79], v[188:191], a[88:91], v[76:79]
    v_mfma_f32_16x16x32_bf16 v[104:107], v[188:191], a[92:95], v[104:107]
    s_waitcnt vmcnt(13)
    v_mfma_f32_16x16x32_bf16 v[24:27], v[192:195], a[80:83], v[24:27]
    buffer_load_dwordx4 v[164:167], v1, s[40:43], s60 offen offset:2048 sc1
    v_mfma_f32_16x16x32_bf16 v[52:55], v[192:195], a[84:87], v[52:55]
    v_mfma_f32_16x16x32_bf16 v[80:83], v[192:195], a[88:91], v[80:83]
    v_mfma_f32_16x16x32_bf16 v[108:111], v[192:195], a[92:95], v[108:111]
    buffer_load_dwordx4 v[168:171], v1, s[40:43], s60 offen offset:3072 sc1
    s_waitcnt vmcnt(14)
    v_mfma_f32_16x16x32_bf16 v[28:31], v[196:199], a[80:83], v[28:31]
    v_mfma_f32_16x16x32_bf16 v[56:59], v[196:199], a[84:87], v[56:59]
    v_mfma_f32_16x16x32_bf16 v[84:87], v[196:199], a[88:91], v[84:87]
    buffer_load_dwordx4 v[172:175], v14, s[40:43], s60 offen offset:0 sc1
    v_mfma_f32_16x16x32_bf16 v[112:115], v[196:199], a[92:95], v[112:115]
    s_waitcnt vmcnt(14)
    v_mfma_f32_16x16x32_bf16 v[32:35], v[200:203], a[80:83], v[32:35]
    v_mfma_f32_16x16x32_bf16 v[60:63], v[200:203], a[84:87], v[60:63]
    buffer_load_dwordx4 v[176:179], v14, s[40:43], s60 offen offset:1024 sc1
    v_mfma_f32_16x16x32_bf16 v[88:91], v[200:203], a[88:91], v[88:91]
    v_mfma_f32_16x16x32_bf16 v[116:119], v[200:203], a[92:95], v[116:119]
    s_waitcnt vmcnt(14)
    v_mfma_f32_16x16x32_bf16 v[36:39], v[204:207], a[80:83], v[36:39]
    buffer_load_dwordx4 v[180:183], v14, s[40:43], s60 offen offset:2048 sc1
    v_mfma_f32_16x16x32_bf16 v[64:67], v[204:207], a[84:87], v[64:67]
    v_mfma_f32_16x16x32_bf16 v[92:95], v[204:207], a[88:91], v[92:95]
    v_mfma_f32_16x16x32_bf16 v[120:123], v[204:207], a[92:95], v[120:123]
    s_waitcnt vmcnt(14)
    v_mfma_f32_16x16x32_bf16 v[40:43], v[208:211], a[80:83], v[40:43]
    v_mfma_f32_16x16x32_bf16 v[68:71], v[208:211], a[84:87], v[68:71]
    v_mfma_f32_16x16x32_bf16 v[96:99], v[208:211], a[88:91], v[96:99]
    v_mfma_f32_16x16x32_bf16 v[124:127], v[208:211], a[92:95], v[124:127]
    s_waitcnt lgkmcnt(0)
    s_barrier
    s_cmp_lg_u32 s50, 0
    s_cbranch_scc1 Lw33
    s_mov_b64 exec, 0x2000000
    v_mov_b32 v5, s4
    buffer_store_dword v5, v4, s[40:43], 0 offen sc1
    s_mov_b64 exec, -1
Lw33:
    s_waitcnt vmcnt(13)
    v_mfma_f32_16x16x32_bf16 v[16:19], v[128:131], a[96:99], v[16:19]
    v_mfma_f32_16x16x32_bf16 v[44:47], v[128:131], a[100:103], v[44:47]
    s_add_u32 s60, s92, 57344
    v_mfma_f32_16x16x32_bf16 v[72:75], v[128:131], a[104:107], v[72:75]
    buffer_load_dwordx4 v[184:187], v1, s[40:43], s60 offen offset:0 sc1
    v_mfma_f32_16x16x32_bf16 v[100:103], v[128:131], a[108:111], v[100:103]
    s_waitcnt vmcnt(13)
    v_mfma_f32_16x16x32_bf16 v[20:23], v[132:135], a[96:99], v[20:23]
    v_mfma_f32_16x16x32_bf16 v[48:51], v[132:135], a[100:103], v[48:51]
    buffer_load_dwordx4 v[188:191], v1, s[40:43], s60 offen offset:1024 sc1
    v_mfma_f32_16x16x32_bf16 v[76:79], v[132:135], a[104:107], v[76:79]
    v_mfma_f32_16x16x32_bf16 v[104:107], v[132:135], a[108:111], v[104:107]
    s_waitcnt vmcnt(13)
    v_mfma_f32_16x16x32_bf16 v[24:27], v[136:139], a[96:99], v[24:27]
    buffer_load_dwordx4 v[192:195], v1, s[40:43], s60 offen offset:2048 sc1
    v_mfma_f32_16x16x32_bf16 v[52:55], v[136:139], a[100:103], v[52:55]
    v_mfma_f32_16x16x32_bf16 v[80:83], v[136:139], a[104:107], v[80:83]
    v_mfma_f32_16x16x32_bf16 v[108:111], v[136:139], a[108:111], v[108:111]
    buffer_load_dwordx4 v[196:199], v1, s[40:43], s60 offen offset:3072 sc1
    s_waitcnt vmcnt(14)
    v_mfma_f32_16x16x32_bf16 v[28:31], v[140:143], a[96:99], v[28:31]
    v_mfma_f32_16x16x32_bf16 v[56:59], v[140:143], a[100:103], v[56:59]
    v_mfma_f32_16x16x32_bf16 v[84:87], v[140:143], a[104:107], v[84:87]
    buffer_load_dwordx4 v[200:203], v14, s[40:43], s60 offen offset:0 sc1
    v_mfma_f32_16x16x32_bf16 v[112:115], v[140:143], a[108:111], v[112:115]
    s_waitcnt vmcnt(14)
    v_mfma_f32_16x16x32_bf16 v[32:35], v[144:147], a[96:99], v[32:35]
    v_mfma_f32_16x16x32_bf16 v[60:63], v[144:147], a[100:103], v[60:63]
    buffer_load_dwordx4 v[204:207], v14, s[40:43], s60 offen offset:1024 sc1
    v_mfma_f32_16x16x32_bf16 v[88:91], v[144:147], a[104:107], v[88:91]
    v_mfma_f32_16x16x32_bf16 v[116:119], v[144:147], a[108:111], v[116:119]
    s_waitcnt vmcnt(14)
    v_mfma_f32_16x16x32_bf16 v[36:39], v[148:151], a[96:99], v[36:39]
    buffer_load_dwordx4 v[208:211], v14, s[40:43], s60 offen offset:2048 sc1
    v_mfma_f32_16x16x32_bf16 v[64:67], v[148:151], a[100:103], v[64:67]
    v_mfma_f32_16x16x32_bf16 v[92:95], v[148:151], a[104:107], v[92:95]
    v_mfma_f32_16x16x32_bf16 v[120:123], v[148:151], a[108:111], v[120:123]
    s_waitcnt vmcnt(14)
    v_mfma_f32_16x16x32_bf16 v[40:43], v[152:155], a[96:99], v[40:43]
    v_mfma_f32_16x16x32_bf16 v[68:71], v[152:155], a[100:103], v[68:71]
    v_mfma_f32_16x16x32_bf16 v[96:99], v[152:155], a[104:107], v[96:99]
    v_mfma_f32_16x16x32_bf16 v[124:127], v[152:155], a[108:111], v[124:127]
    s_waitcnt vmcnt(13)
    v_mfma_f32_16x16x32_bf16 v[16:19], v[156:159], a[112:115], v[16:19]
    v_mfma_f32_16x16x32_bf16 v[44:47], v[156:159], a[116:119], v[44:47]
    s_add_u32 s60, s92, 64512
    v_mfma_f32_16x16x32_bf16 v[72:75], v[156:159], a[120:123], v[72:75]
    buffer_load_dwordx4 v[128:131], v1, s[40:43], s60 offen offset:0 sc1
    v_mfma_f32_16x16x32_bf16 v[100:103], v[156:159], a[124:127], v[100:103]
    s_waitcnt vmcnt(13)
    v_mfma_f32_16x16x32_bf16 v[20:23], v[160:163], a[112:115], v[20:23]
    v_mfma_f32_16x16x32_bf16 v[48:51], v[160:163], a[116:119], v[48:51]
    buffer_load_dwordx4 v[132:135], v1, s[40:43], s60 offen offset:1024 sc1
    v_mfma_f32_16x16x32_bf16 v[76:79], v[160:163], a[120:123], v[76:79]
    v_mfma_f32_16x16x32_bf16 v[104:107], v[160:163], a[124:127], v[104:107]
    s_waitcnt vmcnt(13)
    v_mfma_f32_16x16x32_bf16 v[24:27], v[164:167], a[112:115], v[24:27]
    buffer_load_dwordx4 v[136:139], v1, s[40:43], s60 offen offset:2048 sc1
    v_mfma_f32_16x16x32_bf16 v[52:55], v[164:167], a[116:119], v[52:55]
    v_mfma_f32_16x16x32_bf16 v[80:83], v[164:167], a[120:123], v[80:83]
    v_mfma_f32_16x16x32_bf16 v[108:111], v[164:167], a[124:127], v[108:111]
    buffer_load_dwordx4 v[140:143], v1, s[40:43], s60 offen offset:3072 sc1
    s_waitcnt vmcnt(14)
    v_mfma_f32_16x16x32_bf16 v[28:31], v[168:171], a[112:115], v[28:31]
    v_mfma_f32_16x16x32_bf16 v[56:59], v[168:171], a[116:119], v[56:59]
    v_mfma_f32_16x16x32_bf16 v[84:87], v[168:171], a[120:123], v[84:87]
    buffer_load_dwordx4 v[144:147], v14, s[40:43], s60 offen offset:0 sc1
    v_mfma_f32_16x16x32_bf16 v[112:115], v[168:171], a[124:127], v[112:115]
    s_waitcnt vmcnt(14)
    v_mfma_f32_16x16x32_bf16 v[32:35], v[172:175], a[112:115], v[32:35]
    v_mfma_f32_16x16x32_bf16 v[60:63], v[172:175], a[116:119], v[60:63]
    buffer_load_dwordx4 v[148:151], v14, s[40:43], s60 offen offset:1024 sc1
    v_mfma_f32_16x16x32_bf16 v[88:91], v[172:175], a[120:123], v[88:91]
    v_mfma_f32_16x16x32_bf16 v[116:119], v[172:175], a[124:127], v[116:119]
    s_waitcnt vmcnt(14)
    v_mfma_f32_16x16x32_bf16 v[36:39], v[176:179], a[112:115], v[36:39]
    buffer_load_dwordx4 v[152:155], v14, s[40:43], s60 offen offset:2048 sc1
    v_mfma_f32_16x16x32_bf16 v[64:67], v[176:179], a[116:119], v[64:67]
    v_mfma_f32_16x16x32_bf16 v[92:95], v[176:179], a[120:123], v[92:95]
    v_mfma_f32_16x16x32_bf16 v[120:123], v[176:179], a[124:127], v[120:123]
    s_waitcnt vmcnt(14)
    v_mfma_f32_16x16x32_bf16 v[40:43], v[180:183], a[112:115], v[40:43]
    v_mfma_f32_16x16x32_bf16 v[68:71], v[180:183], a[116:119], v[68:71]
    v_mfma_f32_16x16x32_bf16 v[96:99], v[180:183], a[120:123], v[96:99]
    v_mfma_f32_16x16x32_bf16 v[124:127], v[180:183], a[124:127], v[124:127]
    s_waitcnt vmcnt(13)
    v_mfma_f32_16x16x32_bf16 v[16:19], v[184:187], a[128:131], v[16:19]
    v_mfma_f32_16x16x32_bf16 v[44:47], v[184:187], a[132:135], v[44:47]
    s_add_u32 s60, s92, 71680
    v_mfma_f32_16x16x32_bf16 v[72:75], v[184:187], a[136:139], v[72:75]
    v_add_u32 v8, 114688, v8
    buffer_load_dwordx4 v[156:159], v1, s[40:43], s60 offen offset:0 sc1
    v_mfma_f32_16x16x32_bf16 v[100:103], v[184:187], a[140:143], v[100:103]
    s_waitcnt vmcnt(13)
    v_mfma_f32_16x16x32_bf16 v[20:23], v[188:191], a[128:131], v[20:23]
    v_add_u32 v9, 114688, v9
    v_mfma_f32_16x16x32_bf16 v[48:51], v[188:191], a[132:135], v[48:51]
    buffer_load_dwordx4 v[160:163], v1, s[40:43], s60 offen offset:1024 sc1
    v_mfma_f32_16x16x32_bf16 v[76:79], v[188:191], a[136:139], v[76:79]
    v_add_u32 v10, 114688, v10
    v_mfma_f32_16x16x32_bf16 v[104:107], v[188:191], a[140:143], v[104:107]
    s_waitcnt vmcnt(13)
    v_mfma_f32_16x16x32_bf16 v[24:27], v[192:195], a[128:131], v[24:27]
    buffer_load_dwordx4 v[164:167], v1, s[40:43], s60 offen offset:2048 sc1
    v_mfma_f32_16x16x32_bf16 v[52:55], v[192:195], a[132:135], v[52:55]
    v_add_u32 v11, 114688, v11
    v_mfma_f32_16x16x32_bf16 v[80:83], v[192:195], a[136:139], v[80:83]
    v_mfma_f32_16x16x32_bf16 v[108:111], v[192:195], a[140:143], v[108:111]
    ds_read_b64_tr_b16 a[0:1], v8 offset:20480
    buffer_load_dwordx4 v[168:171], v1, s[40:43], s60 offen offset:3072 sc1
    s_waitcnt vmcnt(14)
    v_mfma_f32_16x16x32_bf16 v[28:31], v[196:199], a[128:131], v[28:31]
    v_mfma_f32_16x16x32_bf16 v[56:59], v[196:199], a[132:135], v[56:59]
    ds_read_b64_tr_b16 a[2:3], v8 offset:22528
    v_mfma_f32_16x16x32_bf16 v[84:87], v[196:199], a[136:139], v[84:87]
    buffer_load_dwordx4 v[172:175], v14, s[40:43], s60 offen offset:0 sc1
    v_mfma_f32_16x16x32_bf16 v[112:115], v[196:199], a[140:143], v[112:115]
    s_waitcnt vmcnt(14)
    v_mfma_f32_16x16x32_bf16 v[32:35], v[200:203], a[128:131], v[32:35]
    ds_read_b64_tr_b16 a[4:5], v9 offset:20480
    v_mfma_f32_16x16x32_bf16 v[60:63], v[200:203], a[132:135], v[60:63]
    buffer_load_dwordx4 v[176:179], v14, s[40:43], s60 offen offset:1024 sc1
    v_mfma_f32_16x16x32_bf16 v[88:91], v[200:203], a[136:139], v[88:91]
    ds_read_b64_tr_b16 a[6:7], v9 offset:22528
    v_mfma_f32_16x16x32_bf16 v[116:119], v[200:203], a[140:143], v[116:119]
    s_waitcnt vmcnt(14)
    v_mfma_f32_16x16x32_bf16 v[36:39], v[204:207], a[128:131], v[36:39]
    ds_read_b64_tr_b16 a[8:9], v10 offset:20480
    buffer_load_dwordx4 v[180:183], v14, s[40:43], s60 offen offset:2048 sc1
    v_mfma_f32_16x16x32_bf16 v[64:67], v[204:207], a[132:135], v[64:67]
    v_mfma_f32_16x16x32_bf16 v[92:95], v[204:207], a[136:139], v[92:95]
    v_mfma_f32_16x16x32_bf16 v[120:123], v[204:207], a[140:143], v[120:123]
    ds_read_b64_tr_b16 a[10:11], v10 offset:22528
    s_waitcnt vmcnt(14)
    v_mfma_f32_16x16x32_bf16 v[40:43], v[208:211], a[128:131], v[40:43]
    v_mfma_f32_16x16x32_bf16 v[68:71], v[208:211], a[132:135], v[68:71]
    ds_read_b64_tr_b16 a[12:13], v11 offset:20480
    v_mfma_f32_16x16x32_bf16 v[96:99], v[208:211], a[136:139], v[96:99]
    v_mfma_f32_16x16x32_bf16 v[124:127], v[208:211], a[140:143], v[124:127]
    ds_read_b64_tr_b16 a[14:15], v11 offset:22528
    s_waitcnt vmcnt(13)
    v_mfma_f32_16x16x32_bf16 v[16:19], v[128:131], a[144:147], v[16:19]
    ds_read_b64_tr_b16 a[16:17], v8 offset:24576
    v_mfma_f32_16x16x32_bf16 v[44:47], v[128:131], a[148:151], v[44:47]
    ds_read_b64_tr_b16 a[18:19], v8 offset:26624
    s_add_u32 s60, s92, 78848
    v_mfma_f32_16x16x32_bf16 v[72:75], v[128:131], a[152:155], v[72:75]
    ds_read_b64_tr_b16 a[20:21], v9 offset:24576
    buffer_load_dwordx4 v[184:187], v1, s[40:43], s60 offen offset:0 sc1
    v_mfma_f32_16x16x32_bf16 v[100:103], v[128:131], a[156:159], v[100:103]
    ds_read_b64_tr_b16 a[22:23], v9 offset:26624
    s_waitcnt vmcnt(13)
    v_mfma_f32_16x16x32_bf16 v[20:23], v[132:135], a[144:147], v[20:23]
    ds_read_b64_tr_b16 a[24:25], v10 offset:24576
    v_mfma_f32_16x16x32_bf16 v[48:51], v[132:135], a[148:151], v[48:51]
    ds_read_b64_tr_b16 a[26:27], v10 offset:26624
    ds_read_b64_tr_b16 a[28:29], v11 offset:24576
    buffer_load_dwordx4 v[188:191], v1, s[40:43], s60 offen offset:1024 sc1
    v_mfma_f32_16x16x32_bf16 v[76:79], v[132:135], a[152:155], v[76:79]
    ds_read_b64_tr_b16 a[30:31], v11 offset:26624
    v_mfma_f32_16x16x32_bf16 v[104:107], v[132:135], a[156:159], v[104:107]
    v_lshrrev_b32 v249, 3, v0
    s_waitcnt vmcnt(13)
    v_mfma_f32_16x16x32_bf16 v[24:27], v[136:139], a[144:147], v[24:27]
    v_lshl_add_u32 v249, v249, 10, v6
    buffer_load_dwordx4 v[192:195], v1, s[40:43], s60 offen offset:2048 sc1
    v_mfma_f32_16x16x32_bf16 v[52:55], v[136:139], a[148:151], v[52:55]
    s_lshl_b32 s95, s62, 2
    v_mfma_f32_16x16x32_bf16 v[80:83], v[136:139], a[152:155], v[80:83]
    s_add_u32 s95, s95, s50
    v_mfma_f32_16x16x32_bf16 v[108:111], v[136:139], a[156:159], v[108:111]
    s_lshl_b32 s88, s3, 2
    s_add_u32 s88, s88, s50
    buffer_load_dwordx4 v[196:199], v1, s[40:43], s60 offen offset:3072 sc1
    s_waitcnt vmcnt(14)
    v_mfma_f32_16x16x32_bf16 v[28:31], v[140:143], a[144:147], v[28:31]
    s_lshr_b32 s64, s62, 1
    v_mfma_f32_16x16x32_bf16 v[56:59], v[140:143], a[148:151], v[56:59]
    s_lshl_b32 s64, s64, 7
    v_mfma_f32_16x16x32_bf16 v[84:87], v[140:143], a[152:155], v[84:87]
    s_add_u32 s64, s64, 18432
    buffer_load_dwordx4 v[200:203], v14, s[40:43], s60 offen offset:0 sc1
    v_mfma_f32_16x16x32_bf16 v[112:115], v[140:143], a[156:159], v[112:115]
    v_add_u32 v250, s90, v0
    s_waitcnt vmcnt(14)
    v_mfma_f32_16x16x32_bf16 v[32:35], v[144:147], a[144:147], v[32:35]
    v_min_u32 v250, s91, v250
    v_lshlrev_b32 v250, 2, v250
    v_mfma_f32_16x16x32_bf16 v[60:63], v[144:147], a[148:151], v[60:63]
    s_mul_i32 s65, s95, 56
    buffer_load_dwordx4 v[204:207], v14, s[40:43], s60 offen offset:1024 sc1
    v_mfma_f32_16x16x32_bf16 v[88:91], v[144:147], a[152:155], v[88:91]
    s_mul_i32 s87, s63, 7
    v_mfma_f32_16x16x32_bf16 v[116:119], v[144:147], a[156:159], v[116:119]
    s_add_u32 s65, s65, s87
    s_waitcnt vmcnt(14)
    v_mfma_f32_16x16x32_bf16 v[36:39], v[148:151], a[144:147], v[36:39]
    s_lshl_b32 s65, s65, 9
    buffer_load_dwordx4 v[208:211], v14, s[40:43], s60 offen offset:2048 sc1
    v_mfma_f32_16x16x32_bf16 v[64:67], v[148:151], a[148:151], v[64:67]
    s_add_u32 s65, s65, 9437184
    v_mfma_f32_16x16x32_bf16 v[92:95], v[148:151], a[152:155], v[92:95]
    s_lshl_b32 s66, s95, 5
    v_lshlrev_b32 v244, 1, v2
    v_mfma_f32_16x16x32_bf16 v[120:123], v[148:151], a[156:159], v[120:123]
    s_lshl_b32 s67, s88, 4
    s_waitcnt vmcnt(14)
    v_mfma_f32_16x16x32_bf16 v[40:43], v[152:155], a[144:147], v[40:43]
    s_lshl_b32 s87, s5, 1
    v_mfma_f32_16x16x32_bf16 v[68:71], v[152:155], a[148:151], v[68:71]
    s_add_u32 s67, s67, s87
    v_mfma_f32_16x16x32_bf16 v[96:99], v[152:155], a[152:155], v[96:99]
    s_lshl_b32 s67, s67, 10
    v_mfma_f32_16x16x32_bf16 v[124:127], v[152:155], a[156:159], v[124:127]
    s_add_u32 s67, s67, 1048576
    s_mul_i32 s78, s88, 28672
    s_waitcnt vmcnt(13)
    v_mfma_f32_16x16x32_bf16 v[16:19], v[156:159], a[160:163], v[16:19]
    ds_read_b64_tr_b16 a[32:33], v8 offset:28672
    v_mfma_f32_16x16x32_bf16 v[44:47], v[156:159], a[164:167], v[44:47]
    ds_read_b64_tr_b16 a[34:35], v8 offset:30720
    s_add_u32 s60, s92, 86016
    v_mfma_f32_16x16x32_bf16 v[72:75], v[156:159], a[168:171], v[72:75]
    ds_read_b64_tr_b16 a[36:37], v9 offset:28672
    buffer_load_dwordx4 v[128:131], v1, s[40:43], s60 offen offset:0 sc1
    v_mfma_f32_16x16x32_bf16 v[100:103], v[156:159], a[172:175], v[100:103]
    ds_read_b64_tr_b16 a[38:39], v9 offset:30720
    s_waitcnt vmcnt(13)
    v_mfma_f32_16x16x32_bf16 v[20:23], v[160:163], a[160:163], v[20:23]
    ds_read_b64_tr_b16 a[40:41], v10 offset:28672
    v_mfma_f32_16x16x32_bf16 v[48:51], v[160:163], a[164:167], v[48:51]
    ds_read_b64_tr_b16 a[42:43], v10 offset:30720
    buffer_load_dwordx4 v[132:135], v1, s[40:43], s60 offen offset:1024 sc1
    v_mfma_f32_16x16x32_bf16 v[76:79], v[160:163], a[168:171], v[76:79]
    ds_read_b64_tr_b16 a[44:45], v11 offset:28672
    ds_read_b64_tr_b16 a[46:47], v11 offset:30720
    v_mfma_f32_16x16x32_bf16 v[104:107], v[160:163], a[172:175], v[104:107]
    s_add_u32 s78, s78, 13631488
    s_waitcnt vmcnt(13)
    v_mfma_f32_16x16x32_bf16 v[24:27], v[164:167], a[160:163], v[24:27]
    s_mul_i32 s79, s95, 28
    buffer_load_dwordx4 v[136:139], v1, s[40:43], s60 offen offset:2048 sc1
    v_mfma_f32_16x16x32_bf16 v[52:55], v[164:167], a[164:167], v[52:55]
    s_mul_i32 s87, s63, 7
    v_mfma_f32_16x16x32_bf16 v[80:83], v[164:167], a[168:171], v[80:83]
    s_lshr_b32 s87, s87, 1
    v_mfma_f32_16x16x32_bf16 v[108:111], v[164:167], a[172:175], v[108:111]
    s_add_u32 s79, s79, s87
    buffer_load_dwordx4 v[140:143], v1, s[40:43], s60 offen offset:3072 sc1
    s_waitcnt vmcnt(14)
    v_mfma_f32_16x16x32_bf16 v[28:31], v[168:171], a[160:163], v[28:31]
    s_lshl_b32 s79, s79, 10
    v_mfma_f32_16x16x32_bf16 v[56:59], v[168:171], a[164:167], v[56:59]
    s_add_u32 s79, s79, 13631488
    s_add_u32 s86, s50, 1
    v_mfma_f32_16x16x32_bf16 v[84:87], v[168:171], a[168:171], v[84:87]
    s_and_b32 s86, s86, 3
    buffer_load_dwordx4 v[144:147], v14, s[40:43], s60 offen offset:0 sc1
    v_mfma_f32_16x16x32_bf16 v[112:115], v[168:171], a[172:175], v[112:115]
    s_mul_i32 s86, s86, 21504
    s_waitcnt vmcnt(14)
    v_mfma_f32_16x16x32_bf16 v[32:35], v[172:175], a[160:163], v[32:35]
    s_add_u32 s86, s86, 0
    v_mfma_f32_16x16x32_bf16 v[60:63], v[172:175], a[164:167], v[60:63]
    v_add_u32 v246, s86, v1
    buffer_load_dwordx4 v[148:151], v14, s[40:43], s60 offen offset:1024 sc1
    v_mfma_f32_16x16x32_bf16 v[88:91], v[172:175], a[168:171], v[88:91]
    s_add_u32 s86, s50, 2
    v_mfma_f32_16x16x32_bf16 v[116:119], v[172:175], a[172:175], v[116:119]
    s_and_b32 s86, s86, 3
    s_waitcnt vmcnt(14)
    v_mfma_f32_16x16x32_bf16 v[36:39], v[176:179], a[160:163], v[36:39]
    s_mul_i32 s86, s86, 21504
    s_add_u32 s86, s86, 7168
    buffer_load_dwordx4 v[152:155], v14, s[40:43], s60 offen offset:2048 sc1
    v_mfma_f32_16x16x32_bf16 v[64:67], v[176:179], a[164:167], v[64:67]
    v_add_u32 v247, s86, v1
    v_mfma_f32_16x16x32_bf16 v[92:95], v[176:179], a[168:171], v[92:95]
    s_add_u32 s86, s50, 3
    v_mfma_f32_16x16x32_bf16 v[120:123], v[176:179], a[172:175], v[120:123]
    s_and_b32 s86, s86, 3
    s_waitcnt vmcnt(14)
    v_mfma_f32_16x16x32_bf16 v[40:43], v[180:183], a[160:163], v[40:43]
    s_mul_i32 s86, s86, 21504
    v_mfma_f32_16x16x32_bf16 v[68:71], v[180:183], a[164:167], v[68:71]
    s_add_u32 s86, s86, 14336
    v_mfma_f32_16x16x32_bf16 v[96:99], v[180:183], a[168:171], v[96:99]
    v_add_u32 v248, s86, v1
    v_mfma_f32_16x16x32_bf16 v[124:127], v[180:183], a[172:175], v[124:127]
    s_mul_i32 s86, s50, 21504
    v_add_u32 v255, s86, v1
    s_waitcnt vmcnt(13)
    v_mfma_f32_16x16x32_bf16 v[16:19], v[184:187], a[176:179], v[16:19]
    v_mfma_f32_16x16x32_bf16 v[44:47], v[184:187], a[180:183], v[44:47]
    s_add_u32 s60, s92, 93184
    v_mfma_f32_16x16x32_bf16 v[72:75], v[184:187], a[184:187], v[72:75]
    buffer_load_dwordx4 v[156:159], v1, s[40:43], s60 offen offset:0 sc1
    v_mfma_f32_16x16x32_bf16 v[100:103], v[184:187], a[188:191], v[100:103]
    ds_read_b64_tr_b16 a[48:49], v8 offset:32768
    s_waitcnt vmcnt(13)
    v_mfma_f32_16x16x32_bf16 v[20:23], v[188:191], a[176:179], v[20:23]
    v_mfma_f32_16x16x32_bf16 v[48:51], v[188:191], a[180:183], v[48:51]
    buffer_load_dwordx4 v[160:163], v1, s[40:43], s60 offen offset:1024 sc1
    v_mfma_f32_16x16x32_bf16 v[76:79], v[188:191], a[184:187], v[76:79]
    ds_read_b64_tr_b16 a[50:51], v8 offset:34816
    v_mfma_f32_16x16x32_bf16 v[104:107], v[188:191], a[188:191], v[104:107]
    s_waitcnt vmcnt(13)
    v_mfma_f32_16x16x32_bf16 v[24:27], v[192:195], a[176:179], v[24:27]
    buffer_load_dwordx4 v[164:167], v1, s[40:43], s60 offen offset:2048 sc1
    v_mfma_f32_16x16x32_bf16 v[52:55], v[192:195], a[180:183], v[52:55]
    v_mfma_f32_16x16x32_bf16 v[80:83], v[192:195], a[184:187], v[80:83]
    ds_read_b64_tr_b16 a[52:53], v9 offset:32768
    v_mfma_f32_16x16x32_bf16 v[108:111], v[192:195], a[188:191], v[108:111]
    buffer_load_dwordx4 v[168:171], v1, s[40:43], s60 offen offset:3072 sc1
    s_waitcnt vmcnt(14)
    v_mfma_f32_16x16x32_bf16 v[28:31], v[196:199], a[176:179], v[28:31]
    v_mfma_f32_16x16x32_bf16 v[56:59], v[196:199], a[180:183], v[56:59]
    ds_read_b64_tr_b16 a[54:55], v9 offset:34816
    v_mfma_f32_16x16x32_bf16 v[84:87], v[196:199], a[184:187], v[84:87]
    buffer_load_dwordx4 v[172:175], v14, s[40:43], s60 offen offset:0 sc1
    v_mfma_f32_16x16x32_bf16 v[112:115], v[196:199], a[188:191], v[112:115]
    s_waitcnt vmcnt(14)
    v_mfma_f32_16x16x32_bf16 v[32:35], v[200:203], a[176:179], v[32:35]
    v_mfma_f32_16x16x32_bf16 v[60:63], v[200:203], a[180:183], v[60:63]
    ds_read_b64_tr_b16 a[56:57], v10 offset:32768
    buffer_load_dwordx4 v[176:179], v14, s[40:43], s60 offen offset:1024 sc1
    v_mfma_f32_16x16x32_bf16 v[88:91], v[200:203], a[184:187], v[88:91]
    v_mfma_f32_16x16x32_bf16 v[116:119], v[200:203], a[188:191], v[116:119]
    s_waitcnt vmcnt(14)
    v_mfma_f32_16x16x32_bf16 v[36:39], v[204:207], a[176:179], v[36:39]
    ds_read_b64_tr_b16 a[58:59], v10 offset:34816
    buffer_load_dwordx4 v[180:183], v14, s[40:43], s60 offen offset:2048 sc1
    v_mfma_f32_16x16x32_bf16 v[64:67], v[204:207], a[180:183], v[64:67]
    v_mfma_f32_16x16x32_bf16 v[92:95], v[204:207], a[184:187], v[92:95]
    v_mfma_f32_16x16x32_bf16 v[120:123], v[204:207], a[188:191], v[120:123]
    s_waitcnt vmcnt(14)
    v_mfma_f32_16x16x32_bf16 v[40:43], v[208:211], a[176:179], v[40:43]
    ds_read_b64_tr_b16 a[60:61], v11 offset:32768
    v_mfma_f32_16x16x32_bf16 v[68:71], v[208:211], a[180:183], v[68:71]
    v_mfma_f32_16x16x32_bf16 v[96:99], v[208:211], a[184:187], v[96:99]
    v_mfma_f32_16x16x32_bf16 v[124:127], v[208:211], a[188:191], v[124:127]
    ds_read_b64_tr_b16 a[62:63], v11 offset:34816
    s_waitcnt vmcnt(13)
    v_mfma_f32_16x16x32_bf16 v[16:19], v[128:131], a[192:195], v[16:19]
    v_mfma_f32_16x16x32_bf16 v[44:47], v[128:131], a[196:199], v[44:47]
    s_add_u32 s60, s92, 100352
    v_mfma_f32_16x16x32_bf16 v[72:75], v[128:131], a[200:203], v[72:75]
    buffer_load_dwordx4 v[184:187], v1, s[40:43], s60 offen offset:0 sc1
    v_mfma_f32_16x16x32_bf16 v[100:103], v[128:131], a[204:207], v[100:103]
    ds_read_b64_tr_b16 a[64:65], v8 offset:36864
    s_waitcnt vmcnt(13)
    v_mfma_f32_16x16x32_bf16 v[20:23], v[132:135], a[192:195], v[20:23]
    v_mfma_f32_16x16x32_bf16 v[48:51], v[132:135], a[196:199], v[48:51]
    buffer_load_dwordx4 v[188:191], v1, s[40:43], s60 offen offset:1024 sc1
    v_mfma_f32_16x16x32_bf16 v[76:79], v[132:135], a[200:203], v[76:79]
    ds_read_b64_tr_b16 a[66:67], v8 offset:38912
    v_mfma_f32_16x16x32_bf16 v[104:107], v[132:135], a[204:207], v[104:107]
    s_waitcnt vmcnt(13)
    v_mfma_f32_16x16x32_bf16 v[24:27], v[136:139], a[192:195], v[24:27]
    buffer_load_dwordx4 v[192:195], v1, s[40:43], s60 offen offset:2048 sc1
    v_mfma_f32_16x16x32_bf16 v[52:55], v[136:139], a[196:199], v[52:55]
    v_mfma_f32_16x16x32_bf16 v[80:83], v[136:139], a[200:203], v[80:83]
    ds_read_b64_tr_b16 a[68:69], v9 offset:36864
    v_mfma_f32_16x16x32_bf16 v[108:111], v[136:139], a[204:207], v[108:111]
    buffer_load_dwordx4 v[196:199], v1, s[40:43], s60 offen offset:3072 sc1
    s_waitcnt vmcnt(14)
    v_mfma_f32_16x16x32_bf16 v[28:31], v[140:143], a[192:195], v[28:31]
    v_mfma_f32_16x16x32_bf16 v[56:59], v[140:143], a[196:199], v[56:59]
    ds_read_b64_tr_b16 a[70:71], v9 offset:38912
    v_mfma_f32_16x16x32_bf16 v[84:87], v[140:143], a[200:203], v[84:87]
    buffer_load_dwordx4 v[200:203], v14, s[40:43], s60 offen offset:0 sc1
    v_mfma_f32_16x16x32_bf16 v[112:115], v[140:143], a[204:207], v[112:115]
    s_waitcnt vmcnt(14)
    v_mfma_f32_16x16x32_bf16 v[32:35], v[144:147], a[192:195], v[32:35]
    v_mfma_f32_16x16x32_bf16 v[60:63], v[144:147], a[196:199], v[60:63]
    ds_read_b64_tr_b16 a[72:73], v10 offset:36864
    buffer_load_dwordx4 v[204:207], v14, s[40:43], s60 offen offset:1024 sc1
    v_mfma_f32_16x16x32_bf16 v[88:91], v[144:147], a[200:203], v[88:91]
    v_mfma_f32_16x16x32_bf16 v[116:119], v[144:147], a[204:207], v[116:119]
    s_waitcnt vmcnt(14)
    v_mfma_f32_16x16x32_bf16 v[36:39], v[148:151], a[192:195], v[36:39]
    ds_read_b64_tr_b16 a[74:75], v10 offset:38912
    buffer_load_dwordx4 v[208:211], v14, s[40:43], s60 offen offset:2048 sc1
    v_mfma_f32_16x16x32_bf16 v[64:67], v[148:151], a[196:199], v[64:67]
    v_mfma_f32_16x16x32_bf16 v[92:95], v[148:151], a[200:203], v[92:95]
    v_mfma_f32_16x16x32_bf16 v[120:123], v[148:151], a[204:207], v[120:123]
    s_waitcnt vmcnt(14)
    v_mfma_f32_16x16x32_bf16 v[40:43], v[152:155], a[192:195], v[40:43]
    ds_read_b64_tr_b16 a[76:77], v11 offset:36864
    v_mfma_f32_16x16x32_bf16 v[68:71], v[152:155], a[196:199], v[68:71]
    v_mfma_f32_16x16x32_bf16 v[96:99], v[152:155], a[200:203], v[96:99]
    v_mfma_f32_16x16x32_bf16 v[124:127], v[152:155], a[204:207], v[124:127]
    ds_read_b64_tr_b16 a[78:79], v11 offset:38912
    s_waitcnt vmcnt(13)
    v_mfma_f32_16x16x32_bf16 v[16:19], v[156:159], a[208:211], v[16:19]
    v_mfma_f32_16x16x32_bf16 v[44:47], v[156:159], a[212:215], v[44:47]
    s_add_u32 s60, s92, 107520
    v_mfma_f32_16x16x32_bf16 v[72:75], v[156:159], a[216:219], v[72:75]
    buffer_load_dwordx4 v[128:131], v1, s[40:43], s60 offen offset:0 sc1
    v_mfma_f32_16x16x32_bf16 v[100:103], v[156:159], a[220:223], v[100:103]
    ds_read_b64_tr_b16 a[80:81], v8 offset:40960
    s_waitcnt vmcnt(13)
    v_mfma_f32_16x16x32_bf16 v[20:23], v[160:163], a[208:211], v[20:23]
    v_mfma_f32_16x16x32_bf16 v[48:51], v[160:163], a[212:215], v[48:51]
    buffer_load_dwordx4 v[132:135], v1, s[40:43], s60 offen offset:1024 sc1
    v_mfma_f32_16x16x32_bf16 v[76:79], v[160:163], a[216:219], v[76:79]
    ds_read_b64_tr_b16 a[82:83], v8 offset:43008
    v_mfma_f32_16x16x32_bf16 v[104:107], v[160:163], a[220:223], v[104:107]
    s_waitcnt vmcnt(13)
    v_mfma_f32_16x16x32_bf16 v[24:27], v[164:167], a[208:211], v[24:27]
    buffer_load_dwordx4 v[136:139], v1, s[40:43], s60 offen offset:2048 sc1
    v_mfma_f32_16x16x32_bf16 v[52:55], v[164:167], a[212:215], v[52:55]
    ds_read_b64_tr_b16 a[84:85], v9 offset:40960
    v_mfma_f32_16x16x32_bf16 v[80:83], v[164:167], a[216:219], v[80:83]
    v_mfma_f32_16x16x32_bf16 v[108:111], v[164:167], a[220:223], v[108:111]
    buffer_load_dwordx4 v[140:143], v1, s[40:43], s60 offen offset:3072 sc1
    s_waitcnt vmcnt(14)
    v_mfma_f32_16x16x32_bf16 v[28:31], v[168:171], a[208:211], v[28:31]
    ds_read_b64_tr_b16 a[86:87], v9 offset:43008
    v_mfma_f32_16x16x32_bf16 v[56:59], v[168:171], a[212:215], v[56:59]
    v_mfma_f32_16x16x32_bf16 v[84:87], v[168:171], a[216:219], v[84:87]
    buffer_load_dwordx4 v[144:147], v14, s[40:43], s60 offen offset:0 sc1
    v_mfma_f32_16x16x32_bf16 v[112:115], v[168:171], a[220:223], v[112:115]
    ds_read_b64_tr_b16 a[88:89], v10 offset:40960
    s_waitcnt vmcnt(14)
    v_mfma_f32_16x16x32_bf16 v[32:35], v[172:175], a[208:211], v[32:35]
    v_mfma_f32_16x16x32_bf16 v[60:63], v[172:175], a[212:215], v[60:63]
    buffer_load_dwordx4 v[148:151], v14, s[40:43], s60 offen offset:1024 sc1
    v_mfma_f32_16x16x32_bf16 v[88:91], v[172:175], a[216:219], v[88:91]
    ds_read_b64_tr_b16 a[90:91], v10 offset:43008
    v_mfma_f32_16x16x32_bf16 v[116:119], v[172:175], a[220:223], v[116:119]
    s_waitcnt vmcnt(14)
    v_mfma_f32_16x16x32_bf16 v[36:39], v[176:179], a[208:211], v[36:39]
    buffer_load_dwordx4 v[152:155], v14, s[40:43], s60 offen offset:2048 sc1
    v_mfma_f32_16x16x32_bf16 v[64:67], v[176:179], a[212:215], v[64:67]
    ds_read_b64_tr_b16 a[92:93], v11 offset:40960
    v_mfma_f32_16x16x32_bf16 v[92:95], v[176:179], a[216:219], v[92:95]
    v_mfma_f32_16x16x32_bf16 v[120:123], v[176:179], a[220:223], v[120:123]
    s_waitcnt vmcnt(14)
    v_mfma_f32_16x16x32_bf16 v[40:43], v[180:183], a[208:211], v[40:43]
    ds_read_b64_tr_b16 a[94:95], v11 offset:43008
    v_mfma_f32_16x16x32_bf16 v[68:71], v[180:183], a[212:215], v[68:71]
    v_mfma_f32_16x16x32_bf16 v[96:99], v[180:183], a[216:219], v[96:99]
    v_mfma_f32_16x16x32_bf16 v[124:127], v[180:183], a[220:223], v[124:127]
    buffer_load_dword v254, v250, s[40:43], s64 offen sc1
    s_waitcnt vmcnt(14)
    v_mfma_f32_16x16x32_bf16 v[16:19], v[184:187], a[224:227], v[16:19]
    v_mfma_f32_16x16x32_bf16 v[44:47], v[184:187], a[228:231], v[44:47]
    ds_read_b64_tr_b16 a[96:97], v8 offset:45056
    v_mfma_f32_16x16x32_bf16 v[72:75], v[184:187], a[232:235], v[72:75]
    ds_read_b64_tr_b16 a[98:99], v8 offset:47104
    v_mfma_f32_16x16x32_bf16 v[100:103], v[184:187], a[236:239], v[100:103]
    s_waitcnt vmcnt(13)
    v_mfma_f32_16x16x32_bf16 v[20:23], v[188:191], a[224:227], v[20:23]
    ds_read_b64_tr_b16 a[100:101], v9 offset:45056
    v_mfma_f32_16x16x32_bf16 v[48:51], v[188:191], a[228:231], v[48:51]
    ds_read_b64_tr_b16 a[102:103], v9 offset:47104
    v_mfma_f32_16x16x32_bf16 v[76:79], v[188:191], a[232:235], v[76:79]
    ds_read_b64_tr_b16 a[104:105], v10 offset:45056
    v_mfma_f32_16x16x32_bf16 v[104:107], v[188:191], a[236:239], v[104:107]
    s_waitcnt vmcnt(12)
    v_mfma_f32_16x16x32_bf16 v[24:27], v[192:195], a[224:227], v[24:27]
    ds_read_b64_tr_b16 a[106:107], v10 offset:47104
    v_mfma_f32_16x16x32_bf16 v[52:55], v[192:195], a[228:231], v[52:55]
    ds_read_b64_tr_b16 a[108:109], v11 offset:45056
    v_mfma_f32_16x16x32_bf16 v[80:83], v[192:195], a[232:235], v[80:83]
    v_mfma_f32_16x16x32_bf16 v[108:111], v[192:195], a[236:239], v[108:111]
    ds_read_b64_tr_b16 a[110:111], v11 offset:47104
    s_waitcnt vmcnt(11)
    v_mfma_f32_16x16x32_bf16 v[28:31], v[196:199], a[224:227], v[28:31]
    s_add_u32 m0, s69, 36864
    v_mfma_f32_16x16x32_bf16 v[56:59], v[196:199], a[228:231], v[56:59]
    s_add_u32 s61, s68, 294912
    v_mfma_f32_16x16x32_bf16 v[84:87], v[196:199], a[232:235], v[84:87]
    v_mfma_f32_16x16x32_bf16 v[112:115], v[196:199], a[236:239], v[112:115]
    buffer_load_dwordx4 v249, s[32:35], s61 offen lds
    s_waitcnt vmcnt(11)
    v_mfma_f32_16x16x32_bf16 v[32:35], v[200:203], a[224:227], v[32:35]
    s_add_u32 m0, s69, 40960
    v_mfma_f32_16x16x32_bf16 v[60:63], v[200:203], a[228:231], v[60:63]
    v_mfma_f32_16x16x32_bf16 v[88:91], v[200:203], a[232:235], v[88:91]
    s_add_u32 s61, s68, 327680
    v_mfma_f32_16x16x32_bf16 v[116:119], v[200:203], a[236:239], v[116:119]
    buffer_load_dwordx4 v249, s[32:35], s61 offen lds
    s_waitcnt vmcnt(11)
    v_mfma_f32_16x16x32_bf16 v[36:39], v[204:207], a[224:227], v[36:39]
    s_add_u32 m0, s69, 45056
    v_mfma_f32_16x16x32_bf16 v[64:67], v[204:207], a[228:231], v[64:67]
    v_mfma_f32_16x16x32_bf16 v[92:95], v[204:207], a[232:235], v[92:95]
    s_add_u32 s61, s68, 360448
    v_mfma_f32_16x16x32_bf16 v[120:123], v[204:207], a[236:239], v[120:123]
    buffer_load_dwordx4 v249, s[32:35], s61 offen lds
    s_waitcnt vmcnt(11)
    v_mfma_f32_16x16x32_bf16 v[40:43], v[208:211], a[224:227], v[40:43]
    v_mfma_f32_16x16x32_bf16 v[68:71], v[208:211], a[228:231], v[68:71]
    s_add_u32 m0, s69, 49152
    v_mfma_f32_16x16x32_bf16 v[96:99], v[208:211], a[232:235], v[96:99]
    s_add_u32 s61, s68, 393216
    v_mfma_f32_16x16x32_bf16 v[124:127], v[208:211], a[236:239], v[124:127]
    buffer_load_dwordx4 v249, s[32:35], s61 offen lds
    s_mov_b32 s51, 0
    s_waitcnt vmcnt(4)
    v_cmp_ne_u32 vcc, s4, v254
    s_nop 0
    s_cbranch_vccz Le35
Lk34:
    buffer_load_dword v254, v250, s[40:43], s64 offen sc1
    s_waitcnt vmcnt(0)
    v_cmp_ne_u32 vcc, s4, v254
    s_add_u32 s51, s51, 1
    s_cbranch_vccz Le35
    s_cmp_lt_u32 s51, 65536
    s_cbranch_scc1 Lk34
Le35:
    v_mfma_f32_16x16x32_bf16 v[44:47], v[128:131], a[244:247], v[44:47]
    v_mfma_f32_16x16x32_bf16 v[48:51], v[132:135], a[244:247], v[48:51]
    v_mfma_f32_16x16x32_bf16 v[52:55], v[136:139], a[244:247], v[52:55]
    buffer_load_dwordx2 v[212:213], v13, s[40:43], s65 offen offset:0 sc1
    v_mfma_f32_16x16x32_bf16 v[56:59], v[140:143], a[244:247], v[56:59]
    v_mfma_f32_16x16x32_bf16 v[60:63], v[144:147], a[244:247], v[60:63]
    buffer_load_dwordx2 v[214:215], v13, s[40:43], s65 offen offset:512 sc1
    v_mfma_f32_16x16x32_bf16 v[64:67], v[148:151], a[244:247], v[64:67]
    v_mfma_f32_16x16x32_bf16 v[68:71], v[152:155], a[244:247], v[68:71]
    v_mfma_f32_16x16x32_bf16 v[72:75], v[128:131], a[248:251], v[72:75]
    buffer_load_dwordx2 v[216:217], v13, s[40:43], s65 offen offset:1024 sc1
    v_mfma_f32_16x16x32_bf16 v[76:79], v[132:135], a[248:251], v[76:79]
    v_mfma_f32_16x16x32_bf16 v[80:83], v[136:139], a[248:251], v[80:83]
    buffer_load_dwordx2 v[218:219], v13, s[40:43], s65 offen offset:1536 sc1
    v_mfma_f32_16x16x32_bf16 v[84:87], v[140:143], a[248:251], v[84:87]
    ds_write_b128 v246, v[44:47] offset:0
    v_mfma_f32_16x16x32_bf16 v[88:91], v[144:147], a[248:251], v[88:91]
    ds_write_b128 v246, v[48:51] offset:1024
    v_mfma_f32_16x16x32_bf16 v[92:95], v[148:151], a[248:251], v[92:95]
    buffer_load_dwordx2 v[220:221], v13, s[40:43], s65 offen offset:2048 sc1
    v_mfma_f32_16x16x32_bf16 v[96:99], v[152:155], a[248:251], v[96:99]
    ds_write_b128 v246, v[52:55] offset:2048
    v_mfma_f32_16x16x32_bf16 v[100:103], v[128:131], a[252:255], v[100:103]
    ds_write_b128 v246, v[56:59] offset:3072
    v_mfma_f32_16x16x32_bf16 v[104:107], v[132:135], a[252:255], v[104:107]
    ds_write_b128 v246, v[60:63] offset:4096
    v_mfma_f32_16x16x32_bf16 v[108:111], v[136:139], a[252:255], v[108:111]
    ds_write_b128 v246, v[64:67] offset:5120
    v_mfma_f32_16x16x32_bf16 v[112:115], v[140:143], a[252:255], v[112:115]
    buffer_load_dwordx2 v[222:223], v13, s[40:43], s65 offen offset:2560 sc1
    v_mfma_f32_16x16x32_bf16 v[116:119], v[144:147], a[252:255], v[116:119]
    ds_write_b128 v246, v[68:71] offset:6144
    ds_write_b128 v247, v[72:75] offset:0
    v_mfma_f32_16x16x32_bf16 v[120:123], v[148:151], a[252:255], v[120:123]
    ds_write_b128 v247, v[76:79] offset:1024
    v_mfma_f32_16x16x32_bf16 v[124:127], v[152:155], a[252:255], v[124:127]
    ds_write_b128 v247, v[80:83] offset:2048
    v_mfma_f32_16x16x32_bf16 v[16:19], v[128:131], a[240:243], v[16:19]
    buffer_load_dwordx2 v[224:225], v13, s[40:43], s65 offen offset:3072 sc1
    v_mfma_f32_16x16x32_bf16 v[20:23], v[132:135], a[240:243], v[20:23]
    ds_write_b128 v247, v[84:87] offset:3072
    v_mfma_f32_16x16x32_bf16 v[24:27], v[136:139], a[240:243], v[24:27]
    ds_write_b128 v247, v[88:91] offset:4096
    v_mfma_f32_16x16x32_bf16 v[28:31], v[140:143], a[240:243], v[28:31]
    ds_write_b128 v247, v[92:95] offset:5120
    v_mfma_f32_16x16x32_bf16 v[32:35], v[144:147], a[240:243], v[32:35]
    ds_write_b128 v247, v[96:99] offset:6144
    v_mfma_f32_16x16x32_bf16 v[36:39], v[148:151], a[240:243], v[36:39]
    buffer_load_ushort v226, v244, s[28:31], s66 offen
    v_mfma_f32_16x16x32_bf16 v[40:43], v[152:155], a[240:243], v[40:43]
    ds_write_b128 v248, v[100:103] offset:0
    ds_write_b128 v248, v[104:107] offset:1024
    ds_write_b128 v248, v[108:111] offset:2048
    ds_write_b128 v248, v[112:115] offset:3072
    ds_write_b128 v248, v[116:119] offset:4096
    ds_write_b128 v248, v[120:123] offset:5120
    ds_write_b128 v248, v[124:127] offset:6144
    s_add_u32 m0, s69, 53248
    s_add_u32 s61, s68, 425984
    buffer_load_dwordx4 v249, s[32:35], s61 offen lds
    s_add_u32 m0, s69, 57344
    s_add_u32 s61, s68, 458752
    buffer_load_dwordx4 v249, s[32:35], s61 offen lds
    s_add_u32 m0, s69, 61440
    s_add_u32 s61, s68, 491520
    buffer_load_dwordx4 v249, s[32:35], s61 offen lds
    s_add_u32 m0, s69, 65536
    s_add_u32 s61, s68, 524288
    buffer_load_dwordx4 v249, s[32:35], s61 offen lds
    s_waitcnt lgkmcnt(0)
    s_barrier
    ds_read_b128 v[44:47], v255 offset:0
    ds_read_b128 v[72:75], v255 offset:7168
    ds_read_b128 v[100:103], v255 offset:14336
    ds_read_b128 v[48:51], v255 offset:1024
    ds_read_b128 v[76:79], v255 offset:8192
    ds_read_b128 v[104:107], v255 offset:15360
    ds_read_b128 v[52:55], v255 offset:2048
    ds_read_b128 v[80:83], v255 offset:9216
    ds_read_b128 v[108:111], v255 offset:16384
    ds_read_b128 v[56:59], v255 offset:3072
    ds_read_b128 v[84:87], v255 offset:10240
    ds_read_b128 v[112:115], v255 offset:17408
    ds_read_b128 v[60:63], v255 offset:4096
    ds_read_b128 v[88:91], v255 offset:11264
    ds_read_b128 v[116:119], v255 offset:18432
    ds_read_b128 v[64:67], v255 offset:5120
    ds_read_b128 v[92:95], v255 offset:12288
    ds_read_b128 v[120:123], v255 offset:19456
    ds_read_b128 v[68:71], v255 offset:6144
    ds_read_b128 v[96:99], v255 offset:13312
    ds_read_b128 v[124:127], v255 offset:20480
    s_add_u32 m0, s69, 69632
    s_add_u32 s61, s68, 557056
    buffer_load_dwordx4 v249, s[32:35], s61 offen lds
    s_add_u32 m0, s69, 73728
    s_add_u32 s61, s68, 589824
    buffer_load_dwordx4 v249, s[32:35], s61 offen lds
    s_add_u32 m0, s69, 77824
    s_add_u32 s61, s68, 622592
    buffer_load_dwordx4 v249, s[32:35], s61 offen lds
    s_add_u32 m0, s69, 81920
    s_add_u32 s61, s68, 655360
    buffer_load_dwordx4 v249, s[32:35], s61 offen lds
    s_waitcnt vmcnt(8)
    v_lshlrev_b32 v226, 16, v226
    v_lshlrev_b32 v128, 16, v212
    v_and_b32 v129, 0xffff0000, v212
    v_pk_add_f32 v[16:17], v[16:17], v[226:227] op_sel_hi:[1,0]
    v_lshlrev_b32 v130, 16, v213
    v_and_b32 v131, 0xffff0000, v213
    v_pk_add_f32 v[18:19], v[18:19], v[226:227] op_sel_hi:[1,0]
    v_lshlrev_b32 v132, 16, v214
    v_and_b32 v133, 0xffff0000, v214
    v_pk_add_f32 v[20:21], v[20:21], v[226:227] op_sel_hi:[1,0]
    v_lshlrev_b32 v134, 16, v215
    v_and_b32 v135, 0xffff0000, v215
    v_pk_add_f32 v[22:23], v[22:23], v[226:227] op_sel_hi:[1,0]
    v_lshlrev_b32 v136, 16, v216
    v_and_b32 v137, 0xffff0000, v216
    v_pk_add_f32 v[24:25], v[24:25], v[226:227] op_sel_hi:[1,0]
    v_lshlrev_b32 v138, 16, v217
    v_and_b32 v139, 0xffff0000, v217
    v_pk_add_f32 v[26:27], v[26:27], v[226:227] op_sel_hi:[1,0]
    v_lshlrev_b32 v140, 16, v218
    v_and_b32 v141, 0xffff0000, v218
    v_pk_add_f32 v[28:29], v[28:29], v[226:227] op_sel_hi:[1,0]
    v_lshlrev_b32 v142, 16, v219
    v_and_b32 v143, 0xffff0000, v219
    v_pk_add_f32 v[30:31], v[30:31], v[226:227] op_sel_hi:[1,0]
    v_lshlrev_b32 v144, 16, v220
    v_and_b32 v145, 0xffff0000, v220
    v_pk_add_f32 v[32:33], v[32:33], v[226:227] op_sel_hi:[1,0]
    v_lshlrev_b32 v146, 16, v221
    v_and_b32 v147, 0xffff0000, v221
    v_pk_add_f32 v[34:35], v[34:35], v[226:227] op_sel_hi:[1,0]
    v_lshlrev_b32 v148, 16, v222
    v_and_b32 v149, 0xffff0000, v222
    v_pk_add_f32 v[36:37], v[36:37], v[226:227] op_sel_hi:[1,0]
    v_lshlrev_b32 v150, 16, v223
    v_and_b32 v151, 0xffff0000, v223
    v_pk_add_f32 v[38:39], v[38:39], v[226:227] op_sel_hi:[1,0]
    v_lshlrev_b32 v152, 16, v224
    v_and_b32 v153, 0xffff0000, v224
    v_pk_add_f32 v[40:41], v[40:41], v[226:227] op_sel_hi:[1,0]
    v_lshlrev_b32 v154, 16, v225
    v_and_b32 v155, 0xffff0000, v225
    v_pk_add_f32 v[42:43], v[42:43], v[226:227] op_sel_hi:[1,0]
    buffer_load_dwordx4 v[228:231], v1, s[40:43], s67 offen sc1
    buffer_load_dwordx4 v[232:235], v1, s[40:43], s67 offen offset:1024 sc1
    s_waitcnt lgkmcnt(15)
    v_pk_add_f32 v[16:17], v[16:17], v[44:45]
    v_pk_add_f32 v[18:19], v[18:19], v[46:47]
    v_pk_add_f32 v[16:17], v[16:17], v[72:73]
    v_pk_add_f32 v[18:19], v[18:19], v[74:75]
    v_pk_add_f32 v[16:17], v[16:17], v[100:101]
    v_pk_add_f32 v[18:19], v[18:19], v[102:103]
    v_pk_mul_f32 v[16:17], v[16:17], v[128:129]
    v_pk_mul_f32 v[18:19], v[18:19], v[130:131]
    v_cvt_pk_bf16_f32 v176, v16, v17
    v_cvt_pk_bf16_f32 v177, v18, v19
    v_pk_add_f32 v[20:21], v[20:21], v[48:49]
    v_pk_add_f32 v[22:23], v[22:23], v[50:51]
    v_pk_add_f32 v[20:21], v[20:21], v[76:77]
    v_pk_add_f32 v[22:23], v[22:23], v[78:79]
    v_pk_add_f32 v[20:21], v[20:21], v[104:105]
    v_pk_add_f32 v[22:23], v[22:23], v[106:107]
    v_pk_mul_f32 v[20:21], v[20:21], v[132:133]
    v_pk_mul_f32 v[22:23], v[22:23], v[134:135]
    v_cvt_pk_bf16_f32 v178, v20, v21
    v_cvt_pk_bf16_f32 v179, v22, v23
    s_waitcnt lgkmcnt(14)
    v_pk_add_f32 v[24:25], v[24:25], v[52:53]
    v_pk_add_f32 v[26:27], v[26:27], v[54:55]
    s_waitcnt lgkmcnt(13)
    v_pk_add_f32 v[24:25], v[24:25], v[80:81]
    v_pk_add_f32 v[26:27], v[26:27], v[82:83]
    s_waitcnt lgkmcnt(12)
    v_pk_add_f32 v[24:25], v[24:25], v[108:109]
    v_pk_add_f32 v[26:27], v[26:27], v[110:111]
    v_pk_mul_f32 v[24:25], v[24:25], v[136:137]
    v_pk_mul_f32 v[26:27], v[26:27], v[138:139]
    v_cvt_pk_bf16_f32 v180, v24, v25
    v_cvt_pk_bf16_f32 v181, v26, v27
    s_waitcnt lgkmcnt(11)
    v_pk_add_f32 v[28:29], v[28:29], v[56:57]
    v_pk_add_f32 v[30:31], v[30:31], v[58:59]
    s_waitcnt lgkmcnt(10)
    v_pk_add_f32 v[28:29], v[28:29], v[84:85]
    v_pk_add_f32 v[30:31], v[30:31], v[86:87]
    s_waitcnt lgkmcnt(9)
    v_pk_add_f32 v[28:29], v[28:29], v[112:113]
    v_pk_add_f32 v[30:31], v[30:31], v[114:115]
    v_pk_mul_f32 v[28:29], v[28:29], v[140:141]
    v_pk_mul_f32 v[30:31], v[30:31], v[142:143]
    v_cvt_pk_bf16_f32 v182, v28, v29
    v_cvt_pk_bf16_f32 v183, v30, v31
    s_waitcnt lgkmcnt(8)
    v_pk_add_f32 v[32:33], v[32:33], v[60:61]
    v_pk_add_f32 v[34:35], v[34:35], v[62:63]
    s_waitcnt lgkmcnt(7)
    v_pk_add_f32 v[32:33], v[32:33], v[88:89]
    v_pk_add_f32 v[34:35], v[34:35], v[90:91]
    s_waitcnt lgkmcnt(6)
    v_pk_add_f32 v[32:33], v[32:33], v[116:117]
    v_pk_add_f32 v[34:35], v[34:35], v[118:119]
    v_pk_mul_f32 v[32:33], v[32:33], v[144:145]
    v_pk_mul_f32 v[34:35], v[34:35], v[146:147]
    v_cvt_pk_bf16_f32 v184, v32, v33
    v_cvt_pk_bf16_f32 v185, v34, v35
    s_waitcnt lgkmcnt(5)
    v_pk_add_f32 v[36:37], v[36:37], v[64:65]
    v_pk_add_f32 v[38:39], v[38:39], v[66:67]
    s_waitcnt lgkmcnt(4)
    v_pk_add_f32 v[36:37], v[36:37], v[92:93]
    v_pk_add_f32 v[38:39], v[38:39], v[94:95]
    s_waitcnt lgkmcnt(3)
    v_pk_add_f32 v[36:37], v[36:37], v[120:121]
    v_pk_add_f32 v[38:39], v[38:39], v[122:123]
    v_pk_mul_f32 v[36:37], v[36:37], v[148:149]
    v_pk_mul_f32 v[38:39], v[38:39], v[150:151]
    v_cvt_pk_bf16_f32 v186, v36, v37
    v_cvt_pk_bf16_f32 v187, v38, v39
    s_waitcnt lgkmcnt(2)
    v_pk_add_f32 v[40:41], v[40:41], v[68:69]
    v_pk_add_f32 v[42:43], v[42:43], v[70:71]
    s_waitcnt lgkmcnt(1)
    v_pk_add_f32 v[40:41], v[40:41], v[96:97]
    v_pk_add_f32 v[42:43], v[42:43], v[98:99]
    s_waitcnt lgkmcnt(0)
    v_pk_add_f32 v[40:41], v[40:41], v[124:125]
    v_pk_add_f32 v[42:43], v[42:43], v[126:127]
    v_pk_mul_f32 v[40:41], v[40:41], v[152:153]
    v_pk_mul_f32 v[42:43], v[42:43], v[154:155]
    v_cvt_pk_bf16_f32 v188, v40, v41
    v_cvt_pk_bf16_f32 v189, v42, v43
    s_bitcmp1_b32 s63, 0
    s_cbranch_scc1 Lo36
    buffer_store_dwordx4 v[176:179], v1, s[40:43], s79 offen offset:0 sc1
    buffer_store_dwordx4 v[180:183], v1, s[40:43], s79 offen offset:1024 sc1
    buffer_store_dwordx4 v[184:187], v1, s[40:43], s79 offen offset:2048 sc1
    buffer_store_dwordx2 v[188:189], v13, s[40:43], s79 offen offset:3072 sc1
    s_branch Le37
Lo36:
    buffer_store_dwordx2 v[176:177], v13, s[40:43], s79 offen offset:512 sc1
    buffer_store_dwordx4 v[178:181], v1, s[40:43], s79 offen offset:1024 sc1
    buffer_store_dwordx4 v[182:185], v1, s[40:43], s79 offen offset:2048 sc1
    buffer_store_dwordx4 v[186:189], v1, s[40:43], s79 offen offset:3072 sc1
Le37:
    v_bfe_u32 v240, v0, 4, 1
    v_bfe_u32 v5, v0, 5, 1
    v_lshl_add_u32 v240, v240, 1, v5
    v_lshlrev_b32 v240, 4, v240
    v_lshl_add_u32 v240, v2, 10, v240
    s_lshl_b32 s92, s88, 14
    s_lshl_b32 s87, s5, 7
    s_add_u32 s92, s92, s87
    s_lshl_b32 s66, s3, 7
    s_add_u32 s66, s66, 20480
    v_and_b32 v243, 7, v0
    v_lshlrev_b32 v243, 2, v243
    s_waitcnt vmcnt(0)
    s_barrier
    s_cmp_lg_u32 s50, 0
    s_cbranch_scc1 Lw38
    s_mov_b64 exec, 0x4000000
    v_mov_b32 v5, s4
    buffer_store_dword v5, v4, s[40:43], 0 offen sc1
    s_mov_b64 exec, -1
Lw38:
    s_add_u32 m0, s69, 0
    s_add_u32 s61, s68, 0
    buffer_load_dwordx4 v249, s[32:35], s61 offen lds
    s_add_u32 m0, s69, 4096
    s_add_u32 s61, s68, 32768
    buffer_load_dwordx4 v249, s[32:35], s61 offen lds
    s_add_u32 m0, s69, 8192
    s_add_u32 s61, s68, 65536
    buffer_load_dwordx4 v249, s[32:35], s61 offen lds
    s_add_u32 m0, s69, 12288
    s_add_u32 s61, s68, 98304
    buffer_load_dwordx4 v249, s[32:35], s61 offen lds
    s_add_u32 m0, s69, 16384
    s_add_u32 s61, s68, 131072
    buffer_load_dwordx4 v249, s[32:35], s61 offen lds
    s_add_u32 m0, s69, 20480
    s_add_u32 s61, s68, 163840
    buffer_load_dwordx4 v249, s[32:35], s61 offen lds
    s_add_u32 m0, s69, 24576
    s_add_u32 s61, s68, 196608
    buffer_load_dwordx4 v249, s[32:35], s61 offen lds
    s_add_u32 m0, s69, 28672
    s_add_u32 s61, s68, 229376
    buffer_load_dwordx4 v249, s[32:35], s61 offen lds
    s_add_u32 m0, s69, 32768
    s_add_u32 s61, s68, 262144
    buffer_load_dwordx4 v249, s[32:35], s61 offen lds
    ds_read_b64_tr_b16 a[112:113], v8 offset:0
    ds_read_b64_tr_b16 a[114:115], v8 offset:2048
    ds_read_b64_tr_b16 a[116:117], v9 offset:0
    ds_read_b64_tr_b16 a[118:119], v9 offset:2048
    ds_read_b64_tr_b16 a[120:121], v10 offset:0
    ds_read_b64_tr_b16 a[122:123], v10 offset:2048
    ds_read_b64_tr_b16 a[124:125], v11 offset:0
    ds_read_b64_tr_b16 a[126:127], v11 offset:2048
    ds_read_b64_tr_b16 a[128:129], v8 offset:4096
    ds_read_b64_tr_b16 a[130:131], v8 offset:6144
    ds_read_b64_tr_b16 a[132:133], v9 offset:4096
    ds_read_b64_tr_b16 a[134:135], v9 offset:6144
    ds_read_b64_tr_b16 a[136:137], v10 offset:4096
    ds_read_b64_tr_b16 a[138:139], v10 offset:6144
    ds_read_b64_tr_b16 a[140:141], v11 offset:4096
    ds_read_b64_tr_b16 a[142:143], v11 offset:6144
    ds_read_b64_tr_b16 a[144:145], v8 offset:8192
    ds_read_b64_tr_b16 a[146:147], v8 offset:10240
    ds_read_b64_tr_b16 a[148:149], v9 offset:8192
    ds_read_b64_tr_b16 a[150:151], v9 offset:10240
    ds_read_b64_tr_b16 a[152:153], v10 offset:8192
    ds_read_b64_tr_b16 a[154:155], v10 offset:10240
    ds_read_b64_tr_b16 a[156:157], v11 offset:8192
    ds_read_b64_tr_b16 a[158:159], v11 offset:10240
    ds_read_b64_tr_b16 a[160:161], v8 offset:12288
    ds_read_b64_tr_b16 a[162:163], v8 offset:14336
    ds_read_b64_tr_b16 a[164:165], v9 offset:12288
    ds_read_b64_tr_b16 a[166:167], v9 offset:14336
    ds_read_b64_tr_b16 a[168:169], v10 offset:12288
    ds_read_b64_tr_b16 a[170:171], v10 offset:14336
    ds_read_b64_tr_b16 a[172:173], v11 offset:12288
    ds_read_b64_tr_b16 a[174:175], v11 offset:14336
    ds_read_b64_tr_b16 a[176:177], v8 offset:16384
    ds_read_b64_tr_b16 a[178:179], v8 offset:18432
    ds_read_b64_tr_b16 a[180:181], v9 offset:16384
    ds_read_b64_tr_b16 a[182:183], v9 offset:18432
    ds_read_b64_tr_b16 a[184:185], v10 offset:16384
    ds_read_b64_tr_b16 a[186:187], v10 offset:18432
    ds_read_b64_tr_b16 a[188:189], v11 offset:16384
    ds_read_b64_tr_b16 a[190:191], v11 offset:18432
    v_subrev_u32 v8, 65536, v8
    v_subrev_u32 v9, 65536, v9
    v_subrev_u32 v10, 65536, v10
    v_subrev_u32 v11, 65536, v11
    ds_read_b64_tr_b16 a[192:193], v8 offset:36864
    ds_read_b64_tr_b16 a[194:195], v8 offset:38912
    ds_read_b64_tr_b16 a[196:197], v9 offset:36864
    ds_read_b64_tr_b16 a[198:199], v9 offset:38912
    ds_read_b64_tr_b16 a[200:201], v10 offset:36864
    ds_read_b64_tr_b16 a[202:203], v10 offset:38912
    ds_read_b64_tr_b16 a[204:205], v11 offset:36864
    ds_read_b64_tr_b16 a[206:207], v11 offset:38912
    ds_read_b64_tr_b16 a[208:209], v8 offset:40960
    ds_read_b64_tr_b16 a[210:211], v8 offset:43008
    ds_read_b64_tr_b16 a[212:213], v9 offset:40960
    ds_read_b64_tr_b16 a[214:215], v9 offset:43008
    ds_read_b64_tr_b16 a[216:217], v10 offset:40960
    ds_read_b64_tr_b16 a[218:219], v10 offset:43008
    ds_read_b64_tr_b16 a[220:221], v11 offset:40960
    ds_read_b64_tr_b16 a[222:223], v11 offset:43008
    ds_read_b64_tr_b16 a[224:225], v8 offset:45056
    ds_read_b64_tr_b16 a[226:227], v8 offset:47104
    ds_read_b64_tr_b16 a[228:229], v9 offset:45056
    ds_read_b64_tr_b16 a[230:231], v9 offset:47104
    ds_read_b64_tr_b16 a[232:233], v10 offset:45056
    ds_read_b64_tr_b16 a[234:235], v10 offset:47104
    ds_read_b64_tr_b16 a[236:237], v11 offset:45056
    ds_read_b64_tr_b16 a[238:239], v11 offset:47104
    ds_read_b64_tr_b16 a[240:241], v8 offset:49152
    ds_read_b64_tr_b16 a[242:243], v8 offset:51200
    ds_read_b64_tr_b16 a[244:245], v9 offset:49152
    ds_read_b64_tr_b16 a[246:247], v9 offset:51200
    ds_read_b64_tr_b16 a[248:249], v10 offset:49152
    ds_read_b64_tr_b16 a[250:251], v10 offset:51200
    ds_read_b64_tr_b16 a[252:253], v11 offset:49152
    ds_read_b64_tr_b16 a[254:255], v11 offset:51200
    v_lshlrev_b32 v128, 16, v228
    v_and_b32 v129, 0xffff0000, v228
    v_lshlrev_b32 v130, 16, v229
    v_and_b32 v131, 0xffff0000, v229
    v_lshlrev_b32 v132, 16, v230
    v_and_b32 v133, 0xffff0000, v230
    v_lshlrev_b32 v134, 16, v231
    v_and_b32 v135, 0xffff0000, v231
    v_lshlrev_b32 v136, 16, v232
    v_and_b32 v137, 0xffff0000, v232
    v_lshlrev_b32 v138, 16, v233
    v_and_b32 v139, 0xffff0000, v233
    v_lshlrev_b32 v140, 16, v234
    v_and_b32 v141, 0xffff0000, v234
    v_lshlrev_b32 v142, 16, v235
    v_and_b32 v143, 0xffff0000, v235
    s_cmp_lg_u32 s50, 0
    s_cbranch_scc1 Lw39
    s_mov_b32 s51, 0
Lp40:
    buffer_load_dword v12, v243, s[40:43], s66 offen sc1
    s_waitcnt vmcnt(0)
    v_cmp_ne_u32 vcc, s4, v12
    s_add_u32 s51, s51, 1
    s_cbranch_vccz Le41
    s_cmp_lt_u32 s51, 65536
    s_cbranch_scc1 Lp40
Le41:
Lw39:
    s_barrier
    s_add_u32 s60, s78, 20480
    buffer_load_dwordx4 v[100:103], v1, s[40:43], s60 offen offset:1024 sc1
    s_add_u32 s60, s78, 20480
    buffer_load_dwordx4 v[104:107], v1, s[40:43], s60 offen offset:2048 sc1
    s_add_u32 s60, s78, 20480
    buffer_load_dwordx4 v[108:111], v1, s[40:43], s60 offen offset:3072 sc1
    s_add_u32 s60, s78, 24576
    buffer_load_dwordx2 v[112:113], v13, s[40:43], s60 offen offset:0 sc1
    buffer_load_dwordx2 v[114:115], v13, s[40:43], s60 offen offset:512 sc1
    s_add_u32 s60, s78, 24576
    buffer_load_dwordx4 v[116:119], v1, s[40:43], s60 offen offset:1024 sc1
    s_add_u32 s60, s78, 24576
    buffer_load_dwordx4 v[120:123], v1, s[40:43], s60 offen offset:2048 sc1
    s_add_u32 s60, s78, 24576
    buffer_load_dwordx4 v[124:127], v1, s[40:43], s60 offen offset:3072 sc1
    s_add_u32 s60, s78, 16384
    buffer_load_dwordx4 v[80:83], v1, s[40:43], s60 offen offset:0 sc1
    s_add_u32 s60, s78, 16384
    buffer_load_dwordx2 v[84:85], v13, s[40:43], s60 offen offset:1024 sc1
    buffer_load_dwordx2 v[86:87], v13, s[40:43], s60 offen offset:1536 sc1
    s_add_u32 s60, s78, 16384
    buffer_load_dwordx4 v[88:91], v1, s[40:43], s60 offen offset:2048 sc1
    s_or_b32 s86, s2, s50
    s_cmp_lg_u32 s86, 0
    s_cbranch_scc1 Lz42
    v_mov_b32 v145, s4
    s_mov_b32 s86, 36864
    s_mov_b64 exec, 1
    buffer_store_dword v145, off, s[40:43], s86 sc1
    s_mov_b64 exec, -1
Lz42:
    s_waitcnt vmcnt(11)
    v_mfma_f32_16x16x32_bf16 v[128:131], a[0:3], v[100:103], v[128:131]
    v_mfma_f32_16x16x32_bf16 v[132:135], a[4:7], v[100:103], v[132:135]
    s_add_u32 s60, s78, 16384
    v_mfma_f32_16x16x32_bf16 v[136:139], a[8:11], v[100:103], v[136:139]
    v_mfma_f32_16x16x32_bf16 v[140:143], a[12:15], v[100:103], v[140:143]
    buffer_load_dwordx4 v[92:95], v1, s[40:43], s60 offen offset:3072 sc1
    s_waitcnt vmcnt(11)
    v_mfma_f32_16x16x32_bf16 v[128:131], a[16:19], v[104:107], v[128:131]
    v_mfma_f32_16x16x32_bf16 v[132:135], a[20:23], v[104:107], v[132:135]
    s_add_u32 s60, s78, 20480
    v_mfma_f32_16x16x32_bf16 v[136:139], a[24:27], v[104:107], v[136:139]
    v_mfma_f32_16x16x32_bf16 v[140:143], a[28:31], v[104:107], v[140:143]
    buffer_load_dwordx4 v[96:99], v1, s[40:43], s60 offen offset:0 sc1
    s_waitcnt vmcnt(11)
    v_mfma_f32_16x16x32_bf16 v[128:131], a[32:35], v[108:111], v[128:131]
    v_mfma_f32_16x16x32_bf16 v[132:135], a[36:39], v[108:111], v[132:135]
    s_add_u32 s60, s78, 8192
    v_mfma_f32_16x16x32_bf16 v[136:139], a[40:43], v[108:111], v[136:139]
    v_mfma_f32_16x16x32_bf16 v[140:143], a[44:47], v[108:111], v[140:143]
    buffer_load_dwordx4 v[52:55], v1, s[40:43], s60 offen offset:1024 sc1
    s_waitcnt vmcnt(10)
    v_mfma_f32_16x16x32_bf16 v[128:131], a[48:51], v[112:115], v[128:131]
    v_mfma_f32_16x16x32_bf16 v[132:135], a[52:55], v[112:115], v[132:135]
    s_add_u32 s60, s78, 8192
    v_mfma_f32_16x16x32_bf16 v[136:139], a[56:59], v[112:115], v[136:139]
    buffer_load_dwordx2 v[56:57], v13, s[40:43], s60 offen offset:2048 sc1
    v_mfma_f32_16x16x32_bf16 v[140:143], a[60:63], v[112:115], v[140:143]
    buffer_load_dwordx2 v[58:59], v13, s[40:43], s60 offen offset:2560 sc1
    s_waitcnt vmcnt(11)
    v_mfma_f32_16x16x32_bf16 v[128:131], a[64:67], v[116:119], v[128:131]
    v_mfma_f32_16x16x32_bf16 v[132:135], a[68:71], v[116:119], v[132:135]
    s_add_u32 s60, s78, 8192
    v_mfma_f32_16x16x32_bf16 v[136:139], a[72:75], v[116:119], v[136:139]
    v_mfma_f32_16x16x32_bf16 v[140:143], a[76:79], v[116:119], v[140:143]
    buffer_load_dwordx4 v[60:63], v1, s[40:43], s60 offen offset:3072 sc1
    s_waitcnt vmcnt(11)
    v_mfma_f32_16x16x32_bf16 v[128:131], a[80:83], v[120:123], v[128:131]
    v_mfma_f32_16x16x32_bf16 v[132:135], a[84:87], v[120:123], v[132:135]
    s_add_u32 s60, s78, 12288
    v_mfma_f32_16x16x32_bf16 v[136:139], a[88:91], v[120:123], v[136:139]
    v_mfma_f32_16x16x32_bf16 v[140:143], a[92:95], v[120:123], v[140:143]
    buffer_load_dwordx4 v[64:67], v1, s[40:43], s60 offen offset:0 sc1
    s_waitcnt vmcnt(11)
    v_mfma_f32_16x16x32_bf16 v[128:131], a[96:99], v[124:127], v[128:131]
    v_mfma_f32_16x16x32_bf16 v[132:135], a[100:103], v[124:127], v[132:135]
    s_add_u32 s60, s78, 12288
    v_mfma_f32_16x16x32_bf16 v[136:139], a[104:107], v[124:127], v[136:139]
    v_mfma_f32_16x16x32_bf16 v[140:143], a[108:111], v[124:127], v[140:143]
    buffer_load_dwordx4 v[68:71], v1, s[40:43], s60 offen offset:1024 sc1
    s_waitcnt vmcnt(11) lgkmcnt(15)
    v_mfma_f32_16x16x32_bf16 v[128:131], a[112:115], v[80:83], v[128:131]
    v_mfma_f32_16x16x32_bf16 v[132:135], a[116:119], v[80:83], v[132:135]
    s_add_u32 s60, s78, 12288
    v_mfma_f32_16x16x32_bf16 v[136:139], a[120:123], v[80:83], v[136:139]
    v_mfma_f32_16x16x32_bf16 v[140:143], a[124:127], v[80:83], v[140:143]
    buffer_load_dwordx4 v[72:75], v1, s[40:43], s60 offen offset:2048 sc1
    s_waitcnt vmcnt(10)
    v_mfma_f32_16x16x32_bf16 v[128:131], a[128:131], v[84:87], v[128:131]
    s_add_u32 s60, s78, 12288
    buffer_load_dwordx4 v[76:79], v1, s[40:43], s60 offen offset:3072 sc1
    v_mfma_f32_16x16x32_bf16 v[132:135], a[132:135], v[84:87], v[132:135]
    ds_read_b64_tr_b16 a[112:113], v8 offset:53248
    ds_read_b64_tr_b16 a[114:115], v8 offset:55296
    ds_read_b64_tr_b16 a[116:117], v9 offset:53248
    v_mfma_f32_16x16x32_bf16 v[136:139], a[136:139], v[84:87], v[136:139]
    ds_read_b64_tr_b16 a[118:119], v9 offset:55296
    ds_read_b64_tr_b16 a[120:121], v10 offset:53248
    v_mfma_f32_16x16x32_bf16 v[140:143], a[140:143], v[84:87], v[140:143]
    ds_read_b64_tr_b16 a[122:123], v10 offset:55296
    ds_read_b64_tr_b16 a[124:125], v11 offset:53248
    ds_read_b64_tr_b16 a[126:127], v11 offset:55296
    s_waitcnt vmcnt(10)
    v_mfma_f32_16x16x32_bf16 v[128:131], a[144:147], v[88:91], v[128:131]
    s_add_u32 s60, s78, 0
    buffer_load_dwordx4 v[16:19], v1, s[40:43], s60 offen offset:0 sc1
    v_mfma_f32_16x16x32_bf16 v[132:135], a[148:151], v[88:91], v[132:135]
    ds_read_b64_tr_b16 a[128:129], v8 offset:57344
    ds_read_b64_tr_b16 a[130:131], v8 offset:59392
    ds_read_b64_tr_b16 a[132:133], v9 offset:57344
    v_mfma_f32_16x16x32_bf16 v[136:139], a[152:155], v[88:91], v[136:139]
    ds_read_b64_tr_b16 a[134:135], v9 offset:59392
    ds_read_b64_tr_b16 a[136:137], v10 offset:57344
    v_mfma_f32_16x16x32_bf16 v[140:143], a[156:159], v[88:91], v[140:143]
    ds_read_b64_tr_b16 a[138:139], v10 offset:59392
    ds_read_b64_tr_b16 a[140:141], v11 offset:57344
    ds_read_b64_tr_b16 a[142:143], v11 offset:59392
    s_waitcnt vmcnt(10)
    v_mfma_f32_16x16x32_bf16 v[128:131], a[160:163], v[92:95], v[128:131]
    s_add_u32 s60, s78, 0
    buffer_load_dwordx4 v[20:23], v1, s[40:43], s60 offen offset:1024 sc1
    v_mfma_f32_16x16x32_bf16 v[132:135], a[164:167], v[92:95], v[132:135]
    ds_read_b64_tr_b16 a[144:145], v8 offset:61440
    ds_read_b64_tr_b16 a[146:147], v8 offset:63488
    ds_read_b64_tr_b16 a[148:149], v9 offset:61440
    v_mfma_f32_16x16x32_bf16 v[136:139], a[168:171], v[92:95], v[136:139]
    ds_read_b64_tr_b16 a[150:151], v9 offset:63488
    ds_read_b64_tr_b16 a[152:153], v10 offset:61440
    v_mfma_f32_16x16x32_bf16 v[140:143], a[172:175], v[92:95], v[140:143]
    ds_read_b64_tr_b16 a[154:155], v10 offset:63488
    ds_read_b64_tr_b16 a[156:157], v11 offset:61440
    ds_read_b64_tr_b16 a[158:159], v11 offset:63488
    s_barrier
    s_waitcnt vmcnt(10)
    v_mfma_f32_16x16x32_bf16 v[128:131], a[176:179], v[96:99], v[128:131]
    s_add_u32 s60, s78, 0
    buffer_load_dwordx4 v[24:27], v1, s[40:43], s60 offen offset:2048 sc1
    v_mfma_f32_16x16x32_bf16 v[132:135], a[180:183], v[96:99], v[132:135]
    ds_read_b64_tr_b16 a[160:161], v8 offset:0
    ds_read_b64_tr_b16 a[162:163], v8 offset:2048
    ds_read_b64_tr_b16 a[164:165], v9 offset:0
    v_mfma_f32_16x16x32_bf16 v[136:139], a[184:187], v[96:99], v[136:139]
    ds_read_b64_tr_b16 a[166:167], v9 offset:2048
    ds_read_b64_tr_b16 a[168:169], v10 offset:0
    v_mfma_f32_16x16x32_bf16 v[140:143], a[188:191], v[96:99], v[140:143]
    ds_read_b64_tr_b16 a[170:171], v10 offset:2048
    ds_read_b64_tr_b16 a[172:173], v11 offset:0
    ds_read_b64_tr_b16 a[174:175], v11 offset:2048
    s_waitcnt vmcnt(10)
    v_mfma_f32_16x16x32_bf16 v[128:131], a[192:195], v[52:55], v[128:131]
    s_add_u32 s60, s78, 0
    buffer_load_dwordx2 v[28:29], v13, s[40:43], s60 offen offset:3072 sc1
    v_mfma_f32_16x16x32_bf16 v[132:135], a[196:199], v[52:55], v[132:135]
    buffer_load_dwordx2 v[30:31], v13, s[40:43], s60 offen offset:3584 sc1
    ds_read_b64_tr_b16 a[176:177], v8 offset:4096
    ds_read_b64_tr_b16 a[178:179], v8 offset:6144
    v_mfma_f32_16x16x32_bf16 v[136:139], a[200:203], v[52:55], v[136:139]
    ds_read_b64_tr_b16 a[180:181], v9 offset:4096
    ds_read_b64_tr_b16 a[182:183], v9 offset:6144
    ds_read_b64_tr_b16 a[184:185], v10 offset:4096
    v_mfma_f32_16x16x32_bf16 v[140:143], a[204:207], v[52:55], v[140:143]
    ds_read_b64_tr_b16 a[186:187], v10 offset:6144
    ds_read_b64_tr_b16 a[188:189], v11 offset:4096
    ds_read_b64_tr_b16 a[190:191], v11 offset:6144
    s_waitcnt vmcnt(10)
    v_mfma_f32_16x16x32_bf16 v[128:131], a[208:211], v[56:59], v[128:131]
    s_add_u32 s60, s78, 4096
    buffer_load_dwordx4 v[32:35], v1, s[40:43], s60 offen offset:0 sc1
    v_mfma_f32_16x16x32_bf16 v[132:135], a[212:215], v[56:59], v[132:135]
    ds_read_b64_tr_b16 a[192:193], v8 offset:8192
    ds_read_b64_tr_b16 a[194:195], v8 offset:10240
    ds_read_b64_tr_b16 a[196:197], v9 offset:8192
    v_mfma_f32_16x16x32_bf16 v[136:139], a[216:219], v[56:59], v[136:139]
    ds_read_b64_tr_b16 a[198:199], v9 offset:10240
    ds_read_b64_tr_b16 a[200:201], v10 offset:8192
    v_mfma_f32_16x16x32_bf16 v[140:143], a[220:223], v[56:59], v[140:143]
    ds_read_b64_tr_b16 a[202:203], v10 offset:10240
    ds_read_b64_tr_b16 a[204:205], v11 offset:8192
    ds_read_b64_tr_b16 a[206:207], v11 offset:10240
    s_waitcnt vmcnt(10) lgkmcnt(15)
    v_mfma_f32_16x16x32_bf16 v[128:131], a[224:227], v[60:63], v[128:131]
    s_add_u32 s60, s78, 4096
    buffer_load_dwordx4 v[36:39], v1, s[40:43], s60 offen offset:1024 sc1
    v_mfma_f32_16x16x32_bf16 v[132:135], a[228:231], v[60:63], v[132:135]
    ds_read_b64_tr_b16 a[208:209], v8 offset:12288
    ds_read_b64_tr_b16 a[210:211], v8 offset:14336
    ds_read_b64_tr_b16 a[212:213], v9 offset:12288
    v_mfma_f32_16x16x32_bf16 v[136:139], a[232:235], v[60:63], v[136:139]
    ds_read_b64_tr_b16 a[214:215], v9 offset:14336
    ds_read_b64_tr_b16 a[216:217], v10 offset:12288
    v_mfma_f32_16x16x32_bf16 v[140:143], a[236:239], v[60:63], v[140:143]
    ds_read_b64_tr_b16 a[218:219], v10 offset:14336
    ds_read_b64_tr_b16 a[220:221], v11 offset:12288
    ds_read_b64_tr_b16 a[222:223], v11 offset:14336
    s_waitcnt vmcnt(10)
    v_mfma_f32_16x16x32_bf16 v[128:131], a[240:243], v[64:67], v[128:131]
    s_add_u32 s60, s78, 4096
    buffer_load_dwordx4 v[40:43], v1, s[40:43], s60 offen offset:2048 sc1
    v_mfma_f32_16x16x32_bf16 v[132:135], a[244:247], v[64:67], v[132:135]
    ds_read_b64_tr_b16 a[224:225], v8 offset:16384
    ds_read_b64_tr_b16 a[226:227], v8 offset:18432
    ds_read_b64_tr_b16 a[228:229], v9 offset:16384
    v_mfma_f32_16x16x32_bf16 v[136:139], a[248:251], v[64:67], v[136:139]
    ds_read_b64_tr_b16 a[230:231], v9 offset:18432
    ds_read_b64_tr_b16 a[232:233], v10 offset:16384
    v_mfma_f32_16x16x32_bf16 v[140:143], a[252:255], v[64:67], v[140:143]
    ds_read_b64_tr_b16 a[234:235], v10 offset:18432
    ds_read_b64_tr_b16 a[236:237], v11 offset:16384
    ds_read_b64_tr_b16 a[238:239], v11 offset:18432
    s_waitcnt vmcnt(10)
    v_mfma_f32_16x16x32_bf16 v[128:131], a[112:115], v[68:71], v[128:131]
    s_add_u32 s60, s78, 4096
    buffer_load_dwordx4 v[44:47], v1, s[40:43], s60 offen offset:3072 sc1
    v_mfma_f32_16x16x32_bf16 v[132:135], a[116:119], v[68:71], v[132:135]
    ds_read_b64_tr_b16 a[240:241], v8 offset:20480
    ds_read_b64_tr_b16 a[242:243], v8 offset:22528
    ds_read_b64_tr_b16 a[244:245], v9 offset:20480
    v_mfma_f32_16x16x32_bf16 v[136:139], a[120:123], v[68:71], v[136:139]
    ds_read_b64_tr_b16 a[246:247], v9 offset:22528
    ds_read_b64_tr_b16 a[248:249], v10 offset:20480
    v_mfma_f32_16x16x32_bf16 v[140:143], a[124:127], v[68:71], v[140:143]
    ds_read_b64_tr_b16 a[250:251], v10 offset:22528
    ds_read_b64_tr_b16 a[252:253], v11 offset:20480
    ds_read_b64_tr_b16 a[254:255], v11 offset:22528
    s_waitcnt vmcnt(10)
    v_mfma_f32_16x16x32_bf16 v[128:131], a[128:131], v[72:75], v[128:131]
    s_add_u32 s60, s78, 8192
    buffer_load_dwordx4 v[48:51], v1, s[40:43], s60 offen offset:0 sc1
    v_mfma_f32_16x16x32_bf16 v[132:135], a[132:135], v[72:75], v[132:135]
    ds_read_b64_tr_b16 a[112:113], v8 offset:24576
    ds_read_b64_tr_b16 a[114:115], v8 offset:26624
    ds_read_b64_tr_b16 a[116:117], v9 offset:24576
    v_mfma_f32_16x16x32_bf16 v[136:139], a[136:139], v[72:75], v[136:139]
    ds_read_b64_tr_b16 a[118:119], v9 offset:26624
    ds_read_b64_tr_b16 a[120:121], v10 offset:24576
    v_mfma_f32_16x16x32_bf16 v[140:143], a[140:143], v[72:75], v[140:143]
    ds_read_b64_tr_b16 a[122:123], v10 offset:26624
    ds_read_b64_tr_b16 a[124:125], v11 offset:24576
    ds_read_b64_tr_b16 a[126:127], v11 offset:26624
    s_waitcnt vmcnt(10)
    v_mfma_f32_16x16x32_bf16 v[128:131], a[144:147], v[76:79], v[128:131]
    ds_read_b64_tr_b16 a[128:129], v8 offset:28672
    ds_read_b64_tr_b16 a[130:131], v8 offset:30720
    v_mfma_f32_16x16x32_bf16 v[132:135], a[148:151], v[76:79], v[132:135]
    ds_read_b64_tr_b16 a[132:133], v9 offset:28672
    ds_read_b64_tr_b16 a[134:135], v9 offset:30720
    v_mfma_f32_16x16x32_bf16 v[136:139], a[152:155], v[76:79], v[136:139]
    ds_read_b64_tr_b16 a[136:137], v10 offset:28672
    ds_read_b64_tr_b16 a[138:139], v10 offset:30720
    v_mfma_f32_16x16x32_bf16 v[140:143], a[156:159], v[76:79], v[140:143]
    ds_read_b64_tr_b16 a[140:141], v11 offset:28672
    ds_read_b64_tr_b16 a[142:143], v11 offset:30720
    s_waitcnt vmcnt(9)
    v_mfma_f32_16x16x32_bf16 v[128:131], a[160:163], v[16:19], v[128:131]
    ds_read_b64_tr_b16 a[144:145], v8 offset:32768
    ds_read_b64_tr_b16 a[146:147], v8 offset:34816
    v_mfma_f32_16x16x32_bf16 v[132:135], a[164:167], v[16:19], v[132:135]
    ds_read_b64_tr_b16 a[148:149], v9 offset:32768
    ds_read_b64_tr_b16 a[150:151], v9 offset:34816
    v_mfma_f32_16x16x32_bf16 v[136:139], a[168:171], v[16:19], v[136:139]
    ds_read_b64_tr_b16 a[152:153], v10 offset:32768
    ds_read_b64_tr_b16 a[154:155], v10 offset:34816
    v_mfma_f32_16x16x32_bf16 v[140:143], a[172:175], v[16:19], v[140:143]
    ds_read_b64_tr_b16 a[156:157], v11 offset:32768
    ds_read_b64_tr_b16 a[158:159], v11 offset:34816
    s_waitcnt vmcnt(8) lgkmcnt(15)
    v_mfma_f32_16x16x32_bf16 v[128:131], a[176:179], v[20:23], v[128:131]
    v_mfma_f32_16x16x32_bf16 v[132:135], a[180:183], v[20:23], v[132:135]
    v_mfma_f32_16x16x32_bf16 v[136:139], a[184:187], v[20:23], v[136:139]
    v_mfma_f32_16x16x32_bf16 v[140:143], a[188:191], v[20:23], v[140:143]
    s_waitcnt vmcnt(7)
    v_mfma_f32_16x16x32_bf16 v[128:131], a[192:195], v[24:27], v[128:131]
    v_mfma_f32_16x16x32_bf16 v[132:135], a[196:199], v[24:27], v[132:135]
    v_mfma_f32_16x16x32_bf16 v[136:139], a[200:203], v[24:27], v[136:139]
    v_mfma_f32_16x16x32_bf16 v[140:143], a[204:207], v[24:27], v[140:143]
    s_waitcnt vmcnt(5)
    v_mfma_f32_16x16x32_bf16 v[128:131], a[208:211], v[28:31], v[128:131]
    v_mfma_f32_16x16x32_bf16 v[132:135], a[212:215], v[28:31], v[132:135]
    v_mfma_f32_16x16x32_bf16 v[136:139], a[216:219], v[28:31], v[136:139]
    v_mfma_f32_16x16x32_bf16 v[140:143], a[220:223], v[28:31], v[140:143]
    s_waitcnt vmcnt(4)
    v_mfma_f32_16x16x32_bf16 v[128:131], a[224:227], v[32:35], v[128:131]
    v_mfma_f32_16x16x32_bf16 v[132:135], a[228:231], v[32:35], v[132:135]
    v_mfma_f32_16x16x32_bf16 v[136:139], a[232:235], v[32:35], v[136:139]
    v_mfma_f32_16x16x32_bf16 v[140:143], a[236:239], v[32:35], v[140:143]
    s_waitcnt vmcnt(3)
    v_mfma_f32_16x16x32_bf16 v[128:131], a[240:243], v[36:39], v[128:131]
    v_mfma_f32_16x16x32_bf16 v[132:135], a[244:247], v[36:39], v[132:135]
    v_mfma_f32_16x16x32_bf16 v[136:139], a[248:251], v[36:39], v[136:139]
    v_mfma_f32_16x16x32_bf16 v[140:143], a[252:255], v[36:39], v[140:143]
    s_waitcnt vmcnt(2)
    v_mfma_f32_16x16x32_bf16 v[128:131], a[112:115], v[40:43], v[128:131]
    v_mfma_f32_16x16x32_bf16 v[132:135], a[116:119], v[40:43], v[132:135]
    v_mfma_f32_16x16x32_bf16 v[136:139], a[120:123], v[40:43], v[136:139]
    v_mfma_f32_16x16x32_bf16 v[140:143], a[124:127], v[40:43], v[140:143]
    s_waitcnt vmcnt(1) lgkmcnt(14)
    v_mfma_f32_16x16x32_bf16 v[128:131], a[128:131], v[44:47], v[128:131]
    s_waitcnt lgkmcnt(12)
    v_mfma_f32_16x16x32_bf16 v[132:135], a[132:135], v[44:47], v[132:135]
    s_waitcnt lgkmcnt(10)
    v_mfma_f32_16x16x32_bf16 v[136:139], a[136:139], v[44:47], v[136:139]
    s_waitcnt lgkmcnt(8)
    v_mfma_f32_16x16x32_bf16 v[140:143], a[140:143], v[44:47], v[140:143]
    s_waitcnt vmcnt(0) lgkmcnt(6)
    v_mfma_f32_16x16x32_bf16 v[128:131], a[144:147], v[48:51], v[128:131]
    s_waitcnt lgkmcnt(4)
    v_mfma_f32_16x16x32_bf16 v[132:135], a[148:151], v[48:51], v[132:135]
    s_waitcnt lgkmcnt(2)
    v_mfma_f32_16x16x32_bf16 v[136:139], a[152:155], v[48:51], v[136:139]
    s_waitcnt lgkmcnt(0)
    v_mfma_f32_16x16x32_bf16 v[140:143], a[156:159], v[48:51], v[140:143]
    s_nop 1
    v_cvt_pk_bf16_f32 v160, v128, v129
    v_cvt_pk_bf16_f32 v161, v130, v131
    v_cvt_pk_bf16_f32 v162, v132, v133
    v_cvt_pk_bf16_f32 v163, v134, v135
    v_cvt_pk_bf16_f32 v164, v136, v137
    v_cvt_pk_bf16_f32 v165, v138, v139
    v_cvt_pk_bf16_f32 v166, v140, v141
    v_cvt_pk_bf16_f32 v167, v142, v143
    v_permlane16_swap_b32 v160, v162
    v_permlane16_swap_b32 v161, v163
    buffer_store_dwordx4 v[160:163], v240, s[36:39], s92 offen offset:0 nt
    v_permlane16_swap_b32 v164, v166
    v_permlane16_swap_b32 v165, v167
    buffer_store_dwordx4 v[164:167], v240, s[36:39], s92 offen offset:64 nt
L_end:
    s_endpgm
.section .rodata,"a"
.p2align 6
.amdhsa_kernel sequential_preLN__linear_attn_block__mixer_gmlp__prompt_kernel
  .amdhsa_next_free_vgpr 512
  .amdhsa_next_free_sgpr 102
  .amdhsa_accum_offset 256
  .amdhsa_group_segment_fixed_size 0
  .amdhsa_kernarg_size 88
  .amdhsa_user_sgpr_count 2
  .amdhsa_user_sgpr_kernarg_segment_ptr 1
  .amdhsa_system_sgpr_workgroup_id_x 1
  .amdhsa_float_denorm_mode_32 3
  .amdhsa_float_denorm_mode_16_64 3
.end_amdhsa_kernel
```
